```python
import torch

def _softmax(x, axis=-1):
    return torch.softmax(x, dim=axis)
def _gelu(x):
    return torch.nn.functional.gelu(x, approximate="tanh")
def _silu(x):
    return torch.nn.functional.silu(x)
def _sigmoid(x):
    return torch.sigmoid(x)
def _layernorm(x, axis=-1, eps=1e-5):
    m = x.mean(dim=axis, keepdim=True)
    v = x.var(dim=axis, keepdim=True, unbiased=False)
    return (x - m) / torch.sqrt(v + eps)
def _scatter_add(tgt, idx, src, axis=0):
    return tgt.clone().index_add_(axis, idx, src)
def _segment_sum(src, seg, n):
    out = torch.zeros((n,) + src.shape[1:], dtype=src.dtype)
    return out.index_add_(0, seg, src)
def _pad(x, pw):
    flat = tuple(v for pair in reversed(pw) for v in pair)
    return torch.nn.functional.pad(x, flat)

kernel_name = 'parallel_sum__sliding_local_dilated__glu_gated_reglu__prompt'

def setup_inputs():

    _w = (lambda a: (lambda t: t.to(torch.bfloat16) if t.is_floating_point() else t)(torch.as_tensor(a)))
    def _A_setup():
        B, S, D = 1, 2048, 512
        return {
            "x": _w((lambda *s: torch.randn(*s, dtype=torch.bfloat16) * 0.05)(B, S, D)),
            "wqkv": _w((lambda *s: torch.randn(*s, dtype=torch.bfloat16) * 0.05)(D, 3 * D)),
            "wo": _w((lambda *s: torch.randn(*s, dtype=torch.bfloat16) * 0.05)(D, D)),
        }
    _A_in = _A_setup()

    def _B_setup():
        B, S, D, F = 1, 2048, 512, 1792
        return {
            "x": _w((lambda *s: torch.randn(*s, dtype=torch.bfloat16) * 0.05)(B, S, D)),
            "W_gate": _w((lambda *s: torch.randn(*s, dtype=torch.bfloat16) * 0.8)(D, F) * (2.0 / D) ** 0.5),
            "W_up": _w((lambda *s: torch.randn(*s, dtype=torch.bfloat16) * 0.8)(D, F) * (2.0 / D) ** 0.5),
            "W_down": _w((lambda *s: torch.randn(*s, dtype=torch.bfloat16) * 0.8)(F, D) * (1.0 / F) ** 0.5),
        }
    _B_in = _B_setup()

    return {
        "A_x": _A_in["x"],
        "A_wqkv": _A_in["wqkv"],
        "A_wo": _A_in["wo"],
        "B_x": _B_in["x"],
        "B_W_gate": _B_in["W_gate"],
        "B_W_up": _B_in["W_up"],
        "B_W_down": _B_in["W_down"],
    }

def reference(A_x, A_wqkv, A_wo, B_x, B_W_gate, B_W_up, B_W_down):
    def _A_ref(x, wqkv, wo):
        B, S, D = x.shape
        H = 32; Dh = D // H
        W, dil = 8, 2
        qkv = (lambda x, *d: x.permute(*d))((x @ wqkv).reshape(B, S, 3, H, Dh), 2, 0, 3, 1, 4)
        q, k, v = qkv[0], qkv[1], qkv[2]
        scale = Dh ** -0.5
        pos = torch.arange(S)
        off = torch.arange(W) * dil
        idx = pos[:, None] - off[None, :]
        mask = idx >= 0
        idx_c = torch.where(mask, idx, 0).reshape(-1)
        kg = k[:, :, idx_c, :].reshape(B, H, S, W, Dh)
        vg = v[:, :, idx_c, :].reshape(B, H, S, W, Dh)
        logits = torch.einsum("bhsd,bhswd->bhsw", q, kg) * scale
        logits = torch.where(mask[None, None, :, :], logits, -1e9)
        attn = _softmax(logits, axis=-1)
        o = torch.einsum("bhsw,bhswd->bhsd", attn, vg)
        return (lambda x, *d: x.permute(*d))(o, 0, 2, 1, 3).reshape(B, S, D) @ wo

    def _B_ref(x, W_gate, W_up, W_down):
        gate = torch.einsum("bsd,df->bsf", x, W_gate)
        up = torch.einsum("bsd,df->bsf", x, W_up)
        gate = gate * (lambda x, dt: x.to(dt))(gate > 0, gate.dtype)
        h = gate * up
        return torch.einsum("bsf,fd->bsd", h, W_down)

    x = A_x
    xn = _layernorm(x, axis=-1)
    return x + _A_ref(xn, A_wqkv, A_wo) + _B_ref(xn, B_W_gate, B_W_up, B_W_down)
```

```asm
; @launch grid=(256,1,1) block=(256,1,1) lds=163840
.amdgcn_target "amdgcn-amd-amdhsa--gfx950"
.text
.globl parallel_sum__sliding_local_dilated__glu_gated_reglu__prompt_kernel
.p2align 8
.type parallel_sum__sliding_local_dilated__glu_gated_reglu__prompt_kernel,@function
parallel_sum__sliding_local_dilated__glu_gated_reglu__prompt_kernel:
    s_cmp_ge_u32 s2, 256
    s_cbranch_scc1 L_end
    s_load_dwordx2 s[8:9], s[0:1], 0
    s_load_dwordx4 s[40:43], s[0:1], 32
    s_load_dwordx2 s[16:17], s[0:1], 8
    s_load_dwordx2 s[24:25], s[0:1], 16
    s_load_dwordx2 s[20:21], s[0:1], 48
    s_load_dwordx2 s[32:33], s[0:1], 56
    s_load_dwordx2 s[36:37], s[0:1], 64
    s_load_dwordx2 s[28:29], s[0:1], 72
    v_lshrrev_b32 v1, 6, v0
    v_and_b32 v80, 63, v0
    v_readfirstlane_b32 s3, v1
    s_lshr_b32 s73, s2, 3
    s_bfe_u32 s72, s2, 0x20001
    s_and_b32 s51, s73, 3
    s_getpc_b64 s[44:45]
L_pc:
    s_mov_b32 s46, L_codeend-L_pc
    s_mov_b32 s47, 0x20000
    s_lshl_b32 s74, s73, 2
    s_add_u32 s74, s74, s3
    s_lshl_b32 s74, s74, 9
    v_lshlrev_b32 v66, 7, v80
    v_cmp_gt_u32 vcc, 4, v80
    v_add_u32 v66, s74, v66
    v_mov_b32 v67, 2146435072
    v_cndmask_b32 v66, v67, v66, vcc
    buffer_load_dword v11, v66, s[44:47], 0 offen
    s_lshl_b32 s4, s72, 2
    s_add_u32 s4, s4, s51
    s_and_b32 s5, s2, 1
    s_lshl_b32 s5, s5, 3
    s_lshr_b32 s60, s73, 2
    s_add_u32 s5, s5, s60
    s_lshl_b32 s72, s72, 1
    s_add_u32 s6, s72, s5
    s_and_b32 s6, s6, 7
    s_lshl_b32 s64, s6, 7
    s_mul_i32 s61, s3, 40960
    s_lshl_b32 s59, s4, 17
    s_lshl_b32 s72, s3, 15
    s_add_u32 s59, s59, s72
    s_mov_b32 s10, 2097152
    s_mov_b32 s11, 0x20000
    v_lshrrev_b32 v66, 4, v80
    v_lshrrev_b32 v68, 3, v80
    v_lshlrev_b32 v68, 10, v68
    v_and_b32 v69, 7, v80
    v_xor_b32 v66, v69, v66
    v_add_u32 v68, s59, v68
    v_lshl_add_u32 v48, v66, 4, v68
    v_xor_b32 v49, 64, v48
    v_add_u32 v50, 14336, v48
    v_add_u32 v51, 21504, v49
    v_add_u32 v49, 7168, v49
    s_add_u32 m0, s61, 8192
    s_waitcnt lgkmcnt(0)
    buffer_load_dwordx4 v48, s[8:11], s64 offen offset:0 lds
    buffer_load_dwordx4 v49, s[8:11], s64 offen offset:1024 lds
    buffer_load_dwordx4 v50, s[8:11], s64 offen offset:2048 lds
    buffer_load_dwordx4 v51, s[8:11], s64 offen offset:3072 lds
    s_and_b32 s7, s2, 7
    s_lshl_b32 s7, s7, 2
    s_add_u32 s7, s7, s51
    v_lshlrev_b32 v0, 4, v80
    s_bitcmp1_b32 s5, 1
    s_cbranch_scc1 L_typeA
    s_lshr_b32 s0, s5, 2
    s_and_b32 s73, s5, 1
    s_cmp_ge_u32 s3, 2
    s_cselect_b32 s12, s42, s40
    s_cselect_b32 s13, s43, s41
    s_cselect_b32 s74, 64, 0
    s_mul_i32 s72, s0, 896
    s_mul_i32 s73, s73, 384
    s_add_u32 s72, s72, s73
    s_and_b32 s73, s3, 1
    s_lshl_b32 s73, s73, 7
    s_add_u32 s72, s72, s73
    s_movk_i32 s50, 3584
    s_mov_b32 s14, 1839104
    s_mov_b32 s63, 5
    s_sub_u32 s12, s12, 4096
    s_subb_u32 s13, s13, 0
    s_mov_b32 s15, 0x20000
    s_add_u32 s72, s72, 4096
    s_mov_b32 s52, s72
    v_lshrrev_b32 v66, 3, v80
    v_mul_lo_u32 v66, v66, s50
    v_bfe_u32 v67, v80, 4, 1
    v_lshlrev_b32 v67, s63, v67
    v_and_b32 v68, 0x70, v0
    v_xor_b32 v67, v67, v68
    v_xor_b32 v67, s74, v67
    v_add3_u32 v66, v66, v67, s72
    s_lshl_b32 s73, s50, 3
    s_xor_b32 s72, s51, 0
    s_mul_i32 s72, s72, s73
    s_sub_u32 s72, s72, 0
    v_add_u32 v16, s72, v66
    s_lshr_b32 s74, s50, 1
    s_mul_i32 s40, s64, s74
    s_lshl_b32 s63, s50, 5
    s_add_u32 s63, s63, s40
    s_add_u32 m0, s61, 0
    s_nop 0
    buffer_load_dwordx4 v16, s[12:15], s40 offen offset:0 lds
    s_add_u32 m0, s61, 4096
    s_nop 0
    buffer_load_dwordx4 v16, s[12:15], s63 offen lds
    s_xor_b32 s72, s51, 1
    s_mul_i32 s72, s72, s73
    s_sub_u32 s72, s72, 1024
    v_add_u32 v17, s72, v66
    s_xor_b32 s72, s51, 2
    s_mul_i32 s72, s72, s73
    s_sub_u32 s72, s72, 2048
    v_add_u32 v18, s72, v66
    s_xor_b32 s72, s51, 3
    s_mul_i32 s72, s72, s73
    s_sub_u32 s72, s72, 3072
    v_add_u32 v19, s72, v66
    s_add_u32 s65, s64, 128
    s_and_b32 s65, s65, 0x380
    s_add_u32 s66, s65, 128
    s_and_b32 s66, s66, 0x380
    s_add_u32 s67, s66, 128
    s_and_b32 s67, s67, 0x380
    s_add_u32 s68, s67, 128
    s_and_b32 s68, s68, 0x380
    s_add_u32 s69, s68, 128
    s_and_b32 s69, s69, 0x380
    s_add_u32 s70, s69, 128
    s_and_b32 s70, s70, 0x380
    s_add_u32 s71, s70, 128
    s_and_b32 s71, s71, 0x380
    s_mul_i32 s41, s65, s74
    s_mul_i32 s42, s66, s74
    s_mul_i32 s43, s67, s74
    s_mul_i32 s44, s68, s74
    s_mul_i32 s45, s69, s74
    s_mul_i32 s46, s70, s74
    s_mul_i32 s47, s71, s74
    s_lshl_b32 s50, s50, 5
    s_mov_b32 s62, 0xffff0000
    s_mov_b32 s100, 0
    v_mov_b32 v65, 0x3f803f80
    s_mov_b32 s18, 1576960
    s_mov_b32 s19, 0x20000
    s_mov_b32 s26, 524288
    s_mov_b32 s27, 0x20000
    s_mov_b32 s22, 1835008
    s_mov_b32 s23, 0x20000
    s_mov_b32 s34, 2097152
    s_mov_b32 s35, 0x20000
    s_mov_b32 s38, 256
    s_mov_b32 s39, 0x20000
    s_mov_b32 s30, 10551296
    s_mov_b32 s31, 0x20000
    v_and_b32 v66, 31, v80
    v_lshlrev_b32 v67, 7, v66
    v_add_u32 v67, s61, v67
    v_bfe_u32 v68, v80, 1, 3
    v_lshrrev_b32 v69, 5, v80
    v_xor_b32 v68, v68, v69
    v_xor_b32 v68, s51, v68
    v_lshl_add_u32 v52, v68, 4, v67
    v_xor_b32 v53, 32, v52
    v_xor_b32 v54, 64, v52
    v_xor_b32 v55, 96, v52
    v_bfe_u32 v81, v80, 2, 2
    v_and_b32 v82, 3, v80
    v_lshlrev_b32 v82, 3, v82
    v_bfe_u32 v69, v80, 3, 1
    v_bfe_u32 v68, v80, 4, 1
    v_lshrrev_b32 v66, 5, v80
    v_lshl_add_u32 v66, v66, 3, v81
    v_lshl_add_u32 v66, v66, 7, v82
    v_mul_u32_u24 v67, 81984, v68
    v_add_u32 v67, v67, v66
    v_lshl_add_u32 v1, v69, 5, v67
    v_xor_b32 v2, 32, v1
    v_xor_b32 v3, 64, v1
    v_xor_b32 v4, 96, v1
    v_add_u32 v5, 40960, v1
    v_add_u32 v6, 40960, v2
    v_add_u32 v7, 40960, v3
    v_add_u32 v8, 40960, v4
    v_lshrrev_b32 v66, 5, v80
    v_lshl_add_u32 v66, v66, 2, v81
    v_lshl_add_u32 v66, v66, 7, v82
    v_add_u32 v66, s61, v66
    v_lshl_add_u32 v66, v68, 5, v66
    s_and_b32 s73, s3, 1
    v_xor_b32 v67, s73, v69
    v_lshl_add_u32 v26, v67, 6, v66
    v_xor_b32 v27, 64, v26
    v_lshrrev_b32 v66, 3, v80
    v_lshlrev_b32 v66, 10, v66
    v_lshlrev_b32 v67, 6, v68
    v_and_b32 v69, 0x70, v0
    v_xor_b32 v67, v67, v69
    v_add_u32 v24, v66, v67
    v_add_u32 v25, 7168, v24
    s_bitcmp1_b32 s3, 0
    s_cselect_b32 s48, s41, s40
    s_cselect_b32 s49, s43, s42
    s_cselect_b32 s80, s45, s44
    s_cselect_b32 s81, s47, s46
    s_cselect_b32 s72, 128, 0
    s_sub_u32 s72, 256, s72
    s_add_u32 s48, s48, s72
    s_add_u32 s49, s49, s72
    s_add_u32 s80, s80, s72
    s_add_u32 s81, s81, s72
    v_mov_b32 v72, 0
    v_mov_b32 v73, 0
    v_mov_b32 v74, 0
    v_mov_b32 v75, 0
    s_lshl_b32 s72, s4, 12
    s_lshl_b32 s73, s3, 10
    s_add_u32 s72, s72, s73
    s_add_u32 s72, s72, 10485760
    s_cmp_eq_u32 s5, 0
    s_cselect_b32 s72, s72, 2146435072
    v_add_u32 v76, s72, v0
    s_lshl_b32 s1, s4, 2
    s_or_b32 s73, s5, s3
    s_cmp_eq_u32 s73, 0
    s_cselect_b32 s72, s1, 0x1000
    v_lshlrev_b32 v31, 12, v80
    v_add_u32 v31, s72, v31
    v_mov_b32 v30, 1
    s_lshr_b32 s72, s5, 2
    s_lshl_b32 s72, s72, 1
    s_and_b32 s73, s5, 1
    s_add_u32 s72, s72, s73
    s_lshl_b32 s72, s72, 4
    s_add_u32 s72, s72, s4
    s_lshl_b32 s72, s72, 2
    s_add_u32 s72, s72, s3
    s_lshl_b32 s72, s72, 10
    v_lshlrev_b32 v67, 7, v80
    v_add_u32 v83, s72, v67
    v_cmp_gt_u32 vcc, 8, v80
    v_mov_b32 v66, 2146435072
    s_lshr_b32 s72, s72, 2
    v_cndmask_b32 v83, v66, v83, vcc
    s_mul_i32 s72, s72, 14
    v_cmp_gt_u32 vcc, 28, v80
    v_add_u32 v84, s72, v67
    s_nop 0
    v_cndmask_b32 v84, v66, v84, vcc
    s_lshl_b32 s59, s4, 2
    s_add_u32 s59, s59, s3
    s_mul_i32 s59, s59, 147456
    s_mul_i32 s72, s0, 28672
    s_add_u32 s52, s59, s72
    s_and_b32 s73, s5, 1
    s_mul_i32 s73, s73, 12288
    s_add_u32 s52, s52, s73
    s_add_u32 s52, s52, 32768
    s_add_u32 s59, s52, 8192
    s_lshl_b32 s72, s60, 7
    s_mul_i32 s53, s3, 458752
    s_add_u32 s53, s53, s72
    s_lshl_b32 s54, s3, 17
    s_add_u32 s54, s54, s72
    s_lshl_b32 s72, s7, 1
    s_lshr_b32 s73, s3, 1
    s_add_u32 s74, s72, s73
    s_xor_b32 s63, s74, 1
    s_mul_i32 s74, s74, 147456
    s_mul_i32 s63, s63, 147456
    s_mul_i32 s72, s3, 28672
    s_add_u32 s72, s72, 32768
    s_add_u32 s55, s74, s72
    s_add_u32 s56, s63, s72
    s_lshl_b32 s72, s3, 13
    s_add_u32 s57, s74, s72
    s_add_u32 s58, s63, s72
    s_lshr_b32 s72, s7, 2
    s_mul_i32 s73, s72, 52
    s_lshr_b32 s73, s73, 8
    s_mul_i32 s73, s73, 5
    s_sub_u32 s72, s72, s73
    s_lshr_b32 s73, s72, 1
    s_add_u32 s73, s73, s72
    s_lshl_b32 s75, s73, 12
    s_add_u32 s72, s72, 1
    s_cmp_eq_u32 s72, 5
    s_cselect_b32 s72, 0, s72
    s_lshr_b32 s73, s72, 1
    s_add_u32 s73, s73, s72
    s_lshl_b32 s76, s73, 12
    s_add_u32 s72, s72, 1
    s_cmp_eq_u32 s72, 5
    s_cselect_b32 s72, 0, s72
    s_lshr_b32 s73, s72, 1
    s_add_u32 s73, s73, s72
    s_lshl_b32 s77, s73, 12
    s_add_u32 s72, s72, 1
    s_cmp_eq_u32 s72, 5
    s_cselect_b32 s72, 0, s72
    s_lshr_b32 s73, s72, 1
    s_add_u32 s73, s73, s72
    s_lshl_b32 s78, s73, 12
    s_add_u32 s72, s72, 1
    s_cmp_eq_u32 s72, 5
    s_cselect_b32 s72, 0, s72
    s_lshr_b32 s73, s72, 1
    s_add_u32 s73, s73, s72
    s_lshl_b32 s79, s73, 12
    s_add_u32 m0, s61, 12288
    s_nop 0
    buffer_load_dwordx4 v48, s[8:11], s65 offen offset:0 lds
    buffer_load_dwordx4 v49, s[8:11], s65 offen offset:1024 lds
    buffer_load_dwordx4 v50, s[8:11], s65 offen offset:2048 lds
    buffer_load_dwordx4 v51, s[8:11], s65 offen offset:3072 lds
    s_add_u32 m0, s61, 16384
    s_nop 0
    buffer_load_dwordx4 v48, s[8:11], s66 offen offset:0 lds
    buffer_load_dwordx4 v49, s[8:11], s66 offen offset:1024 lds
    buffer_load_dwordx4 v50, s[8:11], s66 offen offset:2048 lds
    buffer_load_dwordx4 v51, s[8:11], s66 offen offset:3072 lds
    s_add_u32 m0, s61, 20480
    s_nop 0
    buffer_load_dwordx4 v48, s[8:11], s67 offen offset:0 lds
    buffer_load_dwordx4 v49, s[8:11], s67 offen offset:1024 lds
    buffer_load_dwordx4 v50, s[8:11], s67 offen offset:2048 lds
    buffer_load_dwordx4 v51, s[8:11], s67 offen offset:3072 lds
    s_waitcnt vmcnt(14)
    ds_read_b128 v[128:131], v52 offset:8192
    ds_read_b128 v[132:135], v53 offset:8192
    ds_read_b128 v[136:139], v54 offset:8192
    ds_read_b128 v[140:143], v55 offset:8192
    s_waitcnt vmcnt(8)
    ds_read_b128 v[144:147], v52 offset:12288
    ds_read_b128 v[148:151], v53 offset:12288
    ds_read_b128 v[152:155], v54 offset:12288
    ds_read_b128 v[156:159], v55 offset:12288
    s_add_u32 m0, s61, 24576
    s_nop 0
    buffer_load_dwordx4 v48, s[8:11], s68 offen offset:0 lds
    s_waitcnt lgkmcnt(6)
    v_dot2_f32_bf16 v60, v128, v65, 0
    v_dot2_f32_bf16 v62, v128, v128, 0
    v_dot2_f32_bf16 v61, v129, v65, 0
    v_dot2_f32_bf16 v63, v129, v129, 0
    v_dot2_f32_bf16 v60, v130, v65, v60
    v_dot2_f32_bf16 v62, v130, v130, v62
    v_dot2_f32_bf16 v61, v131, v65, v61
    v_dot2_f32_bf16 v63, v131, v131, v63
    v_dot2_f32_bf16 v60, v132, v65, v60
    buffer_load_dwordx4 v49, s[8:11], s68 offen offset:1024 lds
    v_dot2_f32_bf16 v62, v132, v132, v62
    v_dot2_f32_bf16 v61, v133, v65, v61
    v_dot2_f32_bf16 v63, v133, v133, v63
    v_dot2_f32_bf16 v60, v134, v65, v60
    v_dot2_f32_bf16 v62, v134, v134, v62
    v_dot2_f32_bf16 v61, v135, v65, v61
    v_dot2_f32_bf16 v63, v135, v135, v63
    s_waitcnt lgkmcnt(4)
    v_dot2_f32_bf16 v60, v136, v65, v60
    v_dot2_f32_bf16 v62, v136, v136, v62
    buffer_load_dwordx4 v50, s[8:11], s68 offen offset:2048 lds
    v_dot2_f32_bf16 v61, v137, v65, v61
    v_dot2_f32_bf16 v63, v137, v137, v63
    v_dot2_f32_bf16 v60, v138, v65, v60
    v_dot2_f32_bf16 v62, v138, v138, v62
    v_dot2_f32_bf16 v61, v139, v65, v61
    v_dot2_f32_bf16 v63, v139, v139, v63
    v_dot2_f32_bf16 v60, v140, v65, v60
    v_dot2_f32_bf16 v62, v140, v140, v62
    v_dot2_f32_bf16 v61, v141, v65, v61
    v_dot2_f32_bf16 v63, v141, v141, v63
    buffer_load_dwordx4 v51, s[8:11], s68 offen offset:3072 lds
    v_dot2_f32_bf16 v60, v142, v65, v60
    v_dot2_f32_bf16 v62, v142, v142, v62
    v_dot2_f32_bf16 v61, v143, v65, v61
    v_dot2_f32_bf16 v63, v143, v143, v63
    s_waitcnt vmcnt(8)
    ds_read_b128 v[160:163], v52 offset:16384
    ds_read_b128 v[164:167], v53 offset:16384
    ds_read_b128 v[168:171], v54 offset:16384
    ds_read_b128 v[172:175], v55 offset:16384
    s_waitcnt lgkmcnt(6)
    s_add_u32 m0, s61, 28672
    s_nop 0
    buffer_load_dwordx4 v48, s[8:11], s69 offen offset:0 lds
    v_dot2_f32_bf16 v60, v144, v65, v60
    v_dot2_f32_bf16 v62, v144, v144, v62
    v_dot2_f32_bf16 v61, v145, v65, v61
    v_dot2_f32_bf16 v63, v145, v145, v63
    v_dot2_f32_bf16 v60, v146, v65, v60
    v_dot2_f32_bf16 v62, v146, v146, v62
    v_dot2_f32_bf16 v61, v147, v65, v61
    v_dot2_f32_bf16 v63, v147, v147, v63
    v_dot2_f32_bf16 v60, v148, v65, v60
    v_dot2_f32_bf16 v62, v148, v148, v62
    buffer_load_dwordx4 v49, s[8:11], s69 offen offset:1024 lds
    v_dot2_f32_bf16 v61, v149, v65, v61
    v_dot2_f32_bf16 v63, v149, v149, v63
    v_dot2_f32_bf16 v60, v150, v65, v60
    v_dot2_f32_bf16 v62, v150, v150, v62
    v_dot2_f32_bf16 v61, v151, v65, v61
    v_dot2_f32_bf16 v63, v151, v151, v63
    s_waitcnt lgkmcnt(4)
    v_dot2_f32_bf16 v60, v152, v65, v60
    v_dot2_f32_bf16 v62, v152, v152, v62
    v_dot2_f32_bf16 v61, v153, v65, v61
    buffer_load_dwordx4 v50, s[8:11], s69 offen offset:2048 lds
    v_dot2_f32_bf16 v63, v153, v153, v63
    v_dot2_f32_bf16 v60, v154, v65, v60
    v_dot2_f32_bf16 v62, v154, v154, v62
    v_dot2_f32_bf16 v61, v155, v65, v61
    v_dot2_f32_bf16 v63, v155, v155, v63
    v_dot2_f32_bf16 v60, v156, v65, v60
    v_dot2_f32_bf16 v62, v156, v156, v62
    v_dot2_f32_bf16 v61, v157, v65, v61
    v_dot2_f32_bf16 v63, v157, v157, v63
    v_dot2_f32_bf16 v60, v158, v65, v60
    buffer_load_dwordx4 v51, s[8:11], s69 offen offset:3072 lds
    v_dot2_f32_bf16 v62, v158, v158, v62
    v_dot2_f32_bf16 v61, v159, v65, v61
    v_dot2_f32_bf16 v63, v159, v159, v63
    s_waitcnt vmcnt(8)
    ds_read_b128 v[176:179], v52 offset:20480
    ds_read_b128 v[180:183], v53 offset:20480
    ds_read_b128 v[184:187], v54 offset:20480
    ds_read_b128 v[188:191], v55 offset:20480
    s_waitcnt lgkmcnt(6)
    v_dot2_f32_bf16 v60, v160, v65, v60
    s_add_u32 m0, s61, 32768
    s_nop 0
    buffer_load_dwordx4 v48, s[8:11], s70 offen offset:0 lds
    v_dot2_f32_bf16 v62, v160, v160, v62
    v_dot2_f32_bf16 v61, v161, v65, v61
    v_dot2_f32_bf16 v63, v161, v161, v63
    v_dot2_f32_bf16 v60, v162, v65, v60
    v_dot2_f32_bf16 v62, v162, v162, v62
    v_dot2_f32_bf16 v61, v163, v65, v61
    v_dot2_f32_bf16 v63, v163, v163, v63
    v_dot2_f32_bf16 v60, v164, v65, v60
    v_dot2_f32_bf16 v62, v164, v164, v62
    v_dot2_f32_bf16 v61, v165, v65, v61
    buffer_load_dwordx4 v49, s[8:11], s70 offen offset:1024 lds
    v_dot2_f32_bf16 v63, v165, v165, v63
    v_dot2_f32_bf16 v60, v166, v65, v60
    v_dot2_f32_bf16 v62, v166, v166, v62
    v_dot2_f32_bf16 v61, v167, v65, v61
    v_dot2_f32_bf16 v63, v167, v167, v63
    s_waitcnt lgkmcnt(4)
    v_dot2_f32_bf16 v60, v168, v65, v60
    v_dot2_f32_bf16 v62, v168, v168, v62
    v_dot2_f32_bf16 v61, v169, v65, v61
    v_dot2_f32_bf16 v63, v169, v169, v63
    buffer_load_dwordx4 v50, s[8:11], s70 offen offset:2048 lds
    v_dot2_f32_bf16 v60, v170, v65, v60
    v_dot2_f32_bf16 v62, v170, v170, v62
    v_dot2_f32_bf16 v61, v171, v65, v61
    v_dot2_f32_bf16 v63, v171, v171, v63
    v_dot2_f32_bf16 v60, v172, v65, v60
    v_dot2_f32_bf16 v62, v172, v172, v62
    v_dot2_f32_bf16 v61, v173, v65, v61
    v_dot2_f32_bf16 v63, v173, v173, v63
    v_dot2_f32_bf16 v60, v174, v65, v60
    v_dot2_f32_bf16 v62, v174, v174, v62
    buffer_load_dwordx4 v51, s[8:11], s70 offen offset:3072 lds
    v_dot2_f32_bf16 v61, v175, v65, v61
    v_dot2_f32_bf16 v63, v175, v175, v63
    s_waitcnt vmcnt(8)
    ds_read_b128 v[192:195], v52 offset:24576
    ds_read_b128 v[196:199], v53 offset:24576
    ds_read_b128 v[200:203], v54 offset:24576
    ds_read_b128 v[204:207], v55 offset:24576
    s_waitcnt lgkmcnt(6)
    v_dot2_f32_bf16 v60, v176, v65, v60
    v_dot2_f32_bf16 v62, v176, v176, v62
    s_add_u32 m0, s61, 36864
    s_nop 0
    buffer_load_dwordx4 v48, s[8:11], s71 offen offset:0 lds
    v_dot2_f32_bf16 v61, v177, v65, v61
    v_dot2_f32_bf16 v63, v177, v177, v63
    v_dot2_f32_bf16 v60, v178, v65, v60
    v_dot2_f32_bf16 v62, v178, v178, v62
    v_dot2_f32_bf16 v61, v179, v65, v61
    v_dot2_f32_bf16 v63, v179, v179, v63
    v_dot2_f32_bf16 v60, v180, v65, v60
    v_dot2_f32_bf16 v62, v180, v180, v62
    v_dot2_f32_bf16 v61, v181, v65, v61
    v_dot2_f32_bf16 v63, v181, v181, v63
    buffer_load_dwordx4 v49, s[8:11], s71 offen offset:1024 lds
    v_dot2_f32_bf16 v60, v182, v65, v60
    v_dot2_f32_bf16 v62, v182, v182, v62
    v_dot2_f32_bf16 v61, v183, v65, v61
    v_dot2_f32_bf16 v63, v183, v183, v63
    s_waitcnt lgkmcnt(4)
    v_dot2_f32_bf16 v60, v184, v65, v60
    v_dot2_f32_bf16 v62, v184, v184, v62
    v_dot2_f32_bf16 v61, v185, v65, v61
    v_dot2_f32_bf16 v63, v185, v185, v63
    v_dot2_f32_bf16 v60, v186, v65, v60
    buffer_load_dwordx4 v50, s[8:11], s71 offen offset:2048 lds
    v_dot2_f32_bf16 v62, v186, v186, v62
    v_dot2_f32_bf16 v61, v187, v65, v61
    v_dot2_f32_bf16 v63, v187, v187, v63
    v_dot2_f32_bf16 v60, v188, v65, v60
    v_dot2_f32_bf16 v62, v188, v188, v62
    v_dot2_f32_bf16 v61, v189, v65, v61
    v_dot2_f32_bf16 v63, v189, v189, v63
    v_dot2_f32_bf16 v60, v190, v65, v60
    v_dot2_f32_bf16 v62, v190, v190, v62
    v_dot2_f32_bf16 v61, v191, v65, v61
    buffer_load_dwordx4 v51, s[8:11], s71 offen offset:3072 lds
    v_dot2_f32_bf16 v63, v191, v191, v63
    s_waitcnt vmcnt(8)
    ds_read_b128 v[208:211], v52 offset:28672
    ds_read_b128 v[212:215], v53 offset:28672
    ds_read_b128 v[216:219], v54 offset:28672
    ds_read_b128 v[220:223], v55 offset:28672
    s_waitcnt lgkmcnt(6)
    v_dot2_f32_bf16 v60, v192, v65, v60
    v_dot2_f32_bf16 v62, v192, v192, v62
    v_dot2_f32_bf16 v61, v193, v65, v61
    s_add_u32 m0, s61, 0
    s_nop 0
    buffer_load_dwordx4 v17, s[12:15], s40 offen offset:1024 lds
    v_dot2_f32_bf16 v63, v193, v193, v63
    v_dot2_f32_bf16 v60, v194, v65, v60
    v_dot2_f32_bf16 v62, v194, v194, v62
    v_dot2_f32_bf16 v61, v195, v65, v61
    v_dot2_f32_bf16 v63, v195, v195, v63
    v_dot2_f32_bf16 v60, v196, v65, v60
    v_dot2_f32_bf16 v62, v196, v196, v62
    v_dot2_f32_bf16 v61, v197, v65, v61
    v_dot2_f32_bf16 v63, v197, v197, v63
    v_dot2_f32_bf16 v60, v198, v65, v60
    buffer_load_dwordx4 v18, s[12:15], s40 offen offset:2048 lds
    v_dot2_f32_bf16 v62, v198, v198, v62
    v_dot2_f32_bf16 v61, v199, v65, v61
    v_dot2_f32_bf16 v63, v199, v199, v63
    s_waitcnt lgkmcnt(4)
    v_dot2_f32_bf16 v60, v200, v65, v60
    v_dot2_f32_bf16 v62, v200, v200, v62
    v_dot2_f32_bf16 v61, v201, v65, v61
    v_dot2_f32_bf16 v63, v201, v201, v63
    v_dot2_f32_bf16 v60, v202, v65, v60
    v_dot2_f32_bf16 v62, v202, v202, v62
    buffer_load_dwordx4 v19, s[12:15], s40 offen offset:3072 lds
    v_dot2_f32_bf16 v61, v203, v65, v61
    v_dot2_f32_bf16 v63, v203, v203, v63
    v_dot2_f32_bf16 v60, v204, v65, v60
    v_dot2_f32_bf16 v62, v204, v204, v62
    v_dot2_f32_bf16 v61, v205, v65, v61
    v_dot2_f32_bf16 v63, v205, v205, v63
    v_dot2_f32_bf16 v60, v206, v65, v60
    v_dot2_f32_bf16 v62, v206, v206, v62
    v_dot2_f32_bf16 v61, v207, v65, v61
    v_dot2_f32_bf16 v63, v207, v207, v63
    s_add_u32 m0, s61, 4096
    s_add_u32 s40, s40, s50
    buffer_load_dwordx4 v17, s[12:15], s40 offen offset:1024 lds
    s_waitcnt vmcnt(8)
    ds_read_b128 v[224:227], v52 offset:32768
    ds_read_b128 v[228:231], v53 offset:32768
    ds_read_b128 v[232:235], v54 offset:32768
    ds_read_b128 v[236:239], v55 offset:32768
    s_waitcnt lgkmcnt(6)
    v_dot2_f32_bf16 v60, v208, v65, v60
    v_dot2_f32_bf16 v62, v208, v208, v62
    v_dot2_f32_bf16 v61, v209, v65, v61
    v_dot2_f32_bf16 v63, v209, v209, v63
    buffer_load_dwordx4 v18, s[12:15], s40 offen offset:2048 lds
    v_dot2_f32_bf16 v60, v210, v65, v60
    v_dot2_f32_bf16 v62, v210, v210, v62
    v_dot2_f32_bf16 v61, v211, v65, v61
    v_dot2_f32_bf16 v63, v211, v211, v63
    v_dot2_f32_bf16 v60, v212, v65, v60
    v_dot2_f32_bf16 v62, v212, v212, v62
    v_dot2_f32_bf16 v61, v213, v65, v61
    v_dot2_f32_bf16 v63, v213, v213, v63
    v_dot2_f32_bf16 v60, v214, v65, v60
    v_dot2_f32_bf16 v62, v214, v214, v62
    buffer_load_dwordx4 v19, s[12:15], s40 offen offset:3072 lds
    v_dot2_f32_bf16 v61, v215, v65, v61
    v_dot2_f32_bf16 v63, v215, v215, v63
    s_waitcnt lgkmcnt(4)
    v_dot2_f32_bf16 v60, v216, v65, v60
    v_dot2_f32_bf16 v62, v216, v216, v62
    v_dot2_f32_bf16 v61, v217, v65, v61
    v_dot2_f32_bf16 v63, v217, v217, v63
    v_dot2_f32_bf16 v60, v218, v65, v60
    v_dot2_f32_bf16 v62, v218, v218, v62
    v_dot2_f32_bf16 v61, v219, v65, v61
    buffer_store_dwordx4 v[72:75], v76, s[28:31], 0 offen sc1
    v_dot2_f32_bf16 v63, v219, v219, v63
    v_dot2_f32_bf16 v60, v220, v65, v60
    v_dot2_f32_bf16 v62, v220, v220, v62
    v_dot2_f32_bf16 v61, v221, v65, v61
    v_dot2_f32_bf16 v63, v221, v221, v63
    v_dot2_f32_bf16 v60, v222, v65, v60
    v_dot2_f32_bf16 v62, v222, v222, v62
    v_dot2_f32_bf16 v61, v223, v65, v61
    v_dot2_f32_bf16 v63, v223, v223, v63
    s_waitcnt vmcnt(7)
    buffer_load_dword v28, v83, s[24:27], 0 offen
    ds_read_b128 v[240:243], v52 offset:36864
    ds_read_b128 v[244:247], v53 offset:36864
    ds_read_b128 v[248:251], v54 offset:36864
    ds_read_b128 v[252:255], v55 offset:36864
    s_waitcnt lgkmcnt(6)
    v_dot2_f32_bf16 v60, v224, v65, v60
    v_dot2_f32_bf16 v62, v224, v224, v62
    v_dot2_f32_bf16 v61, v225, v65, v61
    v_dot2_f32_bf16 v63, v225, v225, v63
    v_dot2_f32_bf16 v60, v226, v65, v60
    buffer_load_dword v29, v84, s[20:23], 0 offen
    v_dot2_f32_bf16 v62, v226, v226, v62
    v_dot2_f32_bf16 v61, v227, v65, v61
    v_dot2_f32_bf16 v63, v227, v227, v63
    v_dot2_f32_bf16 v60, v228, v65, v60
    v_dot2_f32_bf16 v62, v228, v228, v62
    v_dot2_f32_bf16 v61, v229, v65, v61
    v_dot2_f32_bf16 v63, v229, v229, v63
    v_dot2_f32_bf16 v60, v230, v65, v60
    v_dot2_f32_bf16 v62, v230, v230, v62
    v_dot2_f32_bf16 v61, v231, v65, v61
    s_add_u32 m0, s61, 8192
    s_nop 0
    buffer_load_dwordx4 v16, s[12:15], s41 offen offset:0 lds
    v_dot2_f32_bf16 v63, v231, v231, v63
    s_waitcnt lgkmcnt(4)
    v_dot2_f32_bf16 v60, v232, v65, v60
    v_dot2_f32_bf16 v62, v232, v232, v62
    v_dot2_f32_bf16 v61, v233, v65, v61
    v_dot2_f32_bf16 v63, v233, v233, v63
    v_dot2_f32_bf16 v60, v234, v65, v60
    v_dot2_f32_bf16 v62, v234, v234, v62
    v_dot2_f32_bf16 v61, v235, v65, v61
    v_dot2_f32_bf16 v63, v235, v235, v63
    buffer_load_dwordx4 v17, s[12:15], s41 offen offset:1024 lds
    v_dot2_f32_bf16 v60, v236, v65, v60
    v_dot2_f32_bf16 v62, v236, v236, v62
    v_dot2_f32_bf16 v61, v237, v65, v61
    v_dot2_f32_bf16 v63, v237, v237, v63
    v_dot2_f32_bf16 v60, v238, v65, v60
    v_dot2_f32_bf16 v62, v238, v238, v62
    v_dot2_f32_bf16 v61, v239, v65, v61
    v_dot2_f32_bf16 v63, v239, v239, v63
    s_waitcnt vmcnt(4)
    s_barrier
    ds_read_b64_tr_b16 a[96:97], v1 offset:0
    ds_read_b64_tr_b16 a[98:99], v1 offset:512
    ds_read_b64_tr_b16 a[100:101], v2 offset:0
    ds_read_b64_tr_b16 a[102:103], v2 offset:512
    ds_read_b64_tr_b16 a[104:105], v3 offset:0
    ds_read_b64_tr_b16 a[106:107], v3 offset:512
    ds_read_b64_tr_b16 a[108:109], v4 offset:0
    ds_read_b64_tr_b16 a[110:111], v4 offset:512
    ds_read_b64_tr_b16 a[112:113], v5 offset:0
    ds_read_b64_tr_b16 a[114:115], v5 offset:512
    ds_read_b64_tr_b16 a[116:117], v6 offset:0
    s_waitcnt lgkmcnt(14)
    ds_read_b64_tr_b16 a[118:119], v6 offset:512
    s_waitcnt lgkmcnt(14)
    v_dot2_f32_bf16 v60, v240, v65, v60
    v_dot2_f32_bf16 v62, v240, v240, v62
    v_dot2_f32_bf16 v61, v241, v65, v61
    v_dot2_f32_bf16 v63, v241, v241, v63
    v_dot2_f32_bf16 v60, v242, v65, v60
    v_dot2_f32_bf16 v62, v242, v242, v62
    v_dot2_f32_bf16 v61, v243, v65, v61
    v_dot2_f32_bf16 v63, v243, v243, v63
    v_dot2_f32_bf16 v60, v244, v65, v60
    v_dot2_f32_bf16 v62, v244, v244, v62
    v_dot2_f32_bf16 v61, v245, v65, v61
    v_dot2_f32_bf16 v63, v245, v245, v63
    v_dot2_f32_bf16 v60, v246, v65, v60
    v_dot2_f32_bf16 v62, v246, v246, v62
    v_dot2_f32_bf16 v61, v247, v65, v61
    v_dot2_f32_bf16 v63, v247, v247, v63
    s_waitcnt lgkmcnt(12)
    v_dot2_f32_bf16 v60, v248, v65, v60
    v_dot2_f32_bf16 v62, v248, v248, v62
    v_dot2_f32_bf16 v61, v249, v65, v61
    v_dot2_f32_bf16 v63, v249, v249, v63
    v_dot2_f32_bf16 v60, v250, v65, v60
    v_dot2_f32_bf16 v62, v250, v250, v62
    v_dot2_f32_bf16 v61, v251, v65, v61
    v_dot2_f32_bf16 v63, v251, v251, v63
    v_dot2_f32_bf16 v60, v252, v65, v60
    v_dot2_f32_bf16 v62, v252, v252, v62
    v_dot2_f32_bf16 v61, v253, v65, v61
    v_dot2_f32_bf16 v63, v253, v253, v63
    v_dot2_f32_bf16 v60, v254, v65, v60
    v_dot2_f32_bf16 v62, v254, v254, v62
    v_dot2_f32_bf16 v61, v255, v65, v61
    v_dot2_f32_bf16 v63, v255, v255, v63
    s_nop 1
    v_add_f32 v60, v60, v61
    v_add_f32 v62, v62, v63
    v_mov_b32 v61, v60
    v_mov_b32 v63, v62
    s_nop 0
    v_permlane32_swap_b32 v60, v61
    v_permlane32_swap_b32 v62, v63
    v_add_f32 v60, v60, v61
    v_add_f32 v62, v62, v63
    v_mul_f32 v60, 0x3b000000, v60
    v_mul_f32 v62, 0x3b000000, v62
    v_fma_f32 v62, -v60, v60, v62
    v_max_f32 v62, 0, v62
    v_cvt_pk_bf16_f32 v66, v60, v62
    v_and_b32 v67, s62, v66
    v_add_f32 v67, 0x3727c5ac, v67
    v_cvt_pk_bf16_f32 v67, v67, v67
    v_and_b32 v67, s62, v67
    v_sqrt_f32 v67, v67
    v_lshlrev_b32 v66, 16, v66
    v_cvt_pk_bf16_f32 v67, v67, v67
    v_and_b32 v67, s62, v67
    v_rcp_f32 v10, v67
    s_nop 0
    v_mul_f32_e64 v11, -v66, v10
    v_lshlrev_b32 v12, 16, v128
    v_and_b32 v13, s62, v128
    v_pk_fma_f32 v[12:13], v[12:13], v[10:11], v[10:11] op_sel:[0,0,1] op_sel_hi:[1,0,1]
    v_cvt_pk_bf16_f32 v128, v12, v13
    v_lshlrev_b32 v14, 16, v129
    v_and_b32 v15, s62, v129
    v_pk_fma_f32 v[14:15], v[14:15], v[10:11], v[10:11] op_sel:[0,0,1] op_sel_hi:[1,0,1]
    v_cvt_pk_bf16_f32 v129, v14, v15
    v_lshlrev_b32 v12, 16, v130
    v_and_b32 v13, s62, v130
    v_pk_fma_f32 v[12:13], v[12:13], v[10:11], v[10:11] op_sel:[0,0,1] op_sel_hi:[1,0,1]
    v_cvt_pk_bf16_f32 v130, v12, v13
    v_lshlrev_b32 v14, 16, v131
    v_and_b32 v15, s62, v131
    v_pk_fma_f32 v[14:15], v[14:15], v[10:11], v[10:11] op_sel:[0,0,1] op_sel_hi:[1,0,1]
    v_cvt_pk_bf16_f32 v131, v14, v15
    buffer_load_dwordx4 v18, s[12:15], s41 offen offset:2048 lds
    s_nop 0
    s_waitcnt lgkmcnt(6)
    v_mfma_f32_32x32x16_bf16 v[32:47], a[96:99], v[128:131], 0
    ds_read_b64_tr_b16 a[120:121], v7 offset:0
    ds_read_b64_tr_b16 a[122:123], v7 offset:512
    buffer_load_dwordx4 v19, s[12:15], s41 offen offset:3072 lds
    v_lshlrev_b32 v12, 16, v132
    v_mfma_f32_32x32x16_bf16 v[48:63], a[100:103], v[128:131], 0
    ds_read_b64_tr_b16 a[124:125], v8 offset:0
    ds_read_b64_tr_b16 a[126:127], v8 offset:512
    s_add_u32 m0, s61, 12288
    s_add_u32 s41, s41, s50
    v_and_b32 v13, s62, v132
    v_fma_f32 v12, v12, v10, v11
    v_mfma_f32_32x32x16_bf16 a[0:15], a[104:107], v[128:131], 0
    ds_read_b64_tr_b16 a[96:97], v1 offset:2048
    ds_read_b64_tr_b16 a[98:99], v1 offset:2560
    buffer_load_dwordx4 v16, s[12:15], s41 offen offset:0 lds
    v_fma_f32 v13, v13, v10, v11
    v_cvt_pk_bf16_f32 v132, v12, v13
    s_waitcnt lgkmcnt(6)
    v_mfma_f32_32x32x16_bf16 a[16:31], a[108:111], v[128:131], 0
    ds_read_b64_tr_b16 a[100:101], v2 offset:2048
    ds_read_b64_tr_b16 a[102:103], v2 offset:2560
    v_lshlrev_b32 v14, 16, v133
    v_and_b32 v15, s62, v133
    v_fma_f32 v14, v14, v10, v11
    v_mfma_f32_32x32x16_bf16 a[32:47], a[112:115], v[128:131], 0
    ds_read_b64_tr_b16 a[104:105], v3 offset:2048
    ds_read_b64_tr_b16 a[106:107], v3 offset:2560
    buffer_load_dwordx4 v17, s[12:15], s41 offen offset:1024 lds
    v_fma_f32 v15, v15, v10, v11
    v_cvt_pk_bf16_f32 v133, v14, v15
    v_mfma_f32_32x32x16_bf16 a[48:63], a[116:119], v[128:131], 0
    ds_read_b64_tr_b16 a[108:109], v4 offset:2048
    ds_read_b64_tr_b16 a[110:111], v4 offset:2560
    v_lshlrev_b32 v12, 16, v134
    v_and_b32 v13, s62, v134
    v_fma_f32 v12, v12, v10, v11
    v_fma_f32 v13, v13, v10, v11
    s_waitcnt lgkmcnt(6)
    v_mfma_f32_32x32x16_bf16 a[64:79], a[120:123], v[128:131], 0
    ds_read_b64_tr_b16 a[112:113], v5 offset:2048
    ds_read_b64_tr_b16 a[114:115], v5 offset:2560
    buffer_load_dwordx4 v18, s[12:15], s41 offen offset:2048 lds
    v_cvt_pk_bf16_f32 v134, v12, v13
    v_lshlrev_b32 v14, 16, v135
    v_and_b32 v15, s62, v135
    v_fma_f32 v14, v14, v10, v11
    v_fma_f32 v15, v15, v10, v11
    v_cvt_pk_bf16_f32 v135, v14, v15
    v_mfma_f32_32x32x16_bf16 a[80:95], a[124:127], v[128:131], 0
    ds_read_b64_tr_b16 a[116:117], v6 offset:2048
    ds_read_b64_tr_b16 a[118:119], v6 offset:2560
    v_lshlrev_b32 v12, 16, v136
    v_and_b32 v13, s62, v136
    v_fma_f32 v12, v12, v10, v11
    v_fma_f32 v13, v13, v10, v11
    v_mfma_f32_32x32x16_bf16 v[32:47], a[96:99], v[132:135], v[32:47]
    ds_read_b64_tr_b16 a[120:121], v7 offset:2048
    ds_read_b64_tr_b16 a[122:123], v7 offset:2560
    buffer_load_dwordx4 v19, s[12:15], s41 offen offset:3072 lds
    v_cvt_pk_bf16_f32 v136, v12, v13
    v_lshlrev_b32 v14, 16, v137
    s_waitcnt lgkmcnt(6)
    v_mfma_f32_32x32x16_bf16 v[48:63], a[100:103], v[132:135], v[48:63]
    ds_read_b64_tr_b16 a[124:125], v8 offset:2048
    ds_read_b64_tr_b16 a[126:127], v8 offset:2560
    s_add_u32 m0, s61, 16384
    v_and_b32 v15, s62, v137
    v_fma_f32 v14, v14, v10, v11
    v_mfma_f32_32x32x16_bf16 a[0:15], a[104:107], v[132:135], a[0:15]
    ds_read_b64_tr_b16 a[96:97], v1 offset:4096
    ds_read_b64_tr_b16 a[98:99], v1 offset:4608
    buffer_load_dwordx4 v16, s[12:15], s42 offen offset:0 lds
    v_fma_f32 v15, v15, v10, v11
    v_cvt_pk_bf16_f32 v137, v14, v15
    v_mfma_f32_32x32x16_bf16 a[16:31], a[108:111], v[132:135], a[16:31]
    ds_read_b64_tr_b16 a[100:101], v2 offset:4096
    ds_read_b64_tr_b16 a[102:103], v2 offset:4608
    v_lshlrev_b32 v12, 16, v138
    v_and_b32 v13, s62, v138
    v_fma_f32 v12, v12, v10, v11
    v_fma_f32 v13, v13, v10, v11
    s_waitcnt lgkmcnt(6)
    v_mfma_f32_32x32x16_bf16 a[32:47], a[112:115], v[132:135], a[32:47]
    ds_read_b64_tr_b16 a[104:105], v3 offset:4096
    ds_read_b64_tr_b16 a[106:107], v3 offset:4608
    buffer_load_dwordx4 v17, s[12:15], s42 offen offset:1024 lds
    v_cvt_pk_bf16_f32 v138, v12, v13
    v_mfma_f32_32x32x16_bf16 a[48:63], a[116:119], v[132:135], a[48:63]
    ds_read_b64_tr_b16 a[108:109], v4 offset:4096
    ds_read_b64_tr_b16 a[110:111], v4 offset:4608
    v_lshlrev_b32 v14, 16, v139
    v_and_b32 v15, s62, v139
    v_fma_f32 v14, v14, v10, v11
    v_fma_f32 v15, v15, v10, v11
    v_mfma_f32_32x32x16_bf16 a[64:79], a[120:123], v[132:135], a[64:79]
    ds_read_b64_tr_b16 a[112:113], v5 offset:4096
    ds_read_b64_tr_b16 a[114:115], v5 offset:4608
    buffer_load_dwordx4 v18, s[12:15], s42 offen offset:2048 lds
    v_cvt_pk_bf16_f32 v139, v14, v15
    v_lshlrev_b32 v12, 16, v140
    s_waitcnt lgkmcnt(6)
    v_mfma_f32_32x32x16_bf16 a[80:95], a[124:127], v[132:135], a[80:95]
    ds_read_b64_tr_b16 a[116:117], v6 offset:4096
    ds_read_b64_tr_b16 a[118:119], v6 offset:4608
    v_and_b32 v13, s62, v140
    v_fma_f32 v12, v12, v10, v11
    v_fma_f32 v13, v13, v10, v11
    v_mfma_f32_32x32x16_bf16 v[32:47], a[96:99], v[136:139], v[32:47]
    ds_read_b64_tr_b16 a[120:121], v7 offset:4096
    ds_read_b64_tr_b16 a[122:123], v7 offset:4608
    buffer_load_dwordx4 v19, s[12:15], s42 offen offset:3072 lds
    v_cvt_pk_bf16_f32 v140, v12, v13
    v_lshlrev_b32 v14, 16, v141
    v_mfma_f32_32x32x16_bf16 v[48:63], a[100:103], v[136:139], v[48:63]
    ds_read_b64_tr_b16 a[124:125], v8 offset:4096
    ds_read_b64_tr_b16 a[126:127], v8 offset:4608
    s_add_u32 m0, s61, 20480
    s_add_u32 s42, s42, s50
    v_and_b32 v15, s62, v141
    v_fma_f32 v14, v14, v10, v11
    s_waitcnt lgkmcnt(6)
    v_mfma_f32_32x32x16_bf16 a[0:15], a[104:107], v[136:139], a[0:15]
    ds_read_b64_tr_b16 a[96:97], v1 offset:6144
    ds_read_b64_tr_b16 a[98:99], v1 offset:6656
    buffer_load_dwordx4 v16, s[12:15], s42 offen offset:0 lds
    v_fma_f32 v15, v15, v10, v11
    v_mfma_f32_32x32x16_bf16 a[16:31], a[108:111], v[136:139], a[16:31]
    ds_read_b64_tr_b16 a[100:101], v2 offset:6144
    ds_read_b64_tr_b16 a[102:103], v2 offset:6656
    v_cvt_pk_bf16_f32 v141, v14, v15
    v_lshlrev_b32 v12, 16, v142
    v_and_b32 v13, s62, v142
    v_fma_f32 v12, v12, v10, v11
    v_mfma_f32_32x32x16_bf16 a[32:47], a[112:115], v[136:139], a[32:47]
    ds_read_b64_tr_b16 a[104:105], v3 offset:6144
    ds_read_b64_tr_b16 a[106:107], v3 offset:6656
    buffer_load_dwordx4 v17, s[12:15], s42 offen offset:1024 lds
    v_fma_f32 v13, v13, v10, v11
    v_cvt_pk_bf16_f32 v142, v12, v13
    s_waitcnt lgkmcnt(6)
    v_mfma_f32_32x32x16_bf16 a[48:63], a[116:119], v[136:139], a[48:63]
    ds_read_b64_tr_b16 a[108:109], v4 offset:6144
    ds_read_b64_tr_b16 a[110:111], v4 offset:6656
    v_lshlrev_b32 v14, 16, v143
    v_and_b32 v15, s62, v143
    v_fma_f32 v14, v14, v10, v11
    v_mfma_f32_32x32x16_bf16 a[64:79], a[120:123], v[136:139], a[64:79]
    ds_read_b64_tr_b16 a[112:113], v5 offset:6144
    ds_read_b64_tr_b16 a[114:115], v5 offset:6656
    buffer_load_dwordx4 v18, s[12:15], s42 offen offset:2048 lds
    v_fma_f32 v15, v15, v10, v11
    v_cvt_pk_bf16_f32 v143, v14, v15
    v_mfma_f32_32x32x16_bf16 a[80:95], a[124:127], v[136:139], a[80:95]
    ds_read_b64_tr_b16 a[116:117], v6 offset:6144
    ds_read_b64_tr_b16 a[118:119], v6 offset:6656
    v_lshlrev_b32 v12, 16, v144
    v_and_b32 v13, s62, v144
    v_fma_f32 v12, v12, v10, v11
    v_fma_f32 v13, v13, v10, v11
    s_waitcnt lgkmcnt(6)
    v_mfma_f32_32x32x16_bf16 v[32:47], a[96:99], v[140:143], v[32:47]
    ds_read_b64_tr_b16 a[120:121], v7 offset:6144
    ds_read_b64_tr_b16 a[122:123], v7 offset:6656
    buffer_load_dwordx4 v19, s[12:15], s42 offen offset:3072 lds
    v_cvt_pk_bf16_f32 v144, v12, v13
    v_mfma_f32_32x32x16_bf16 v[48:63], a[100:103], v[140:143], v[48:63]
    ds_read_b64_tr_b16 a[124:125], v8 offset:6144
    ds_read_b64_tr_b16 a[126:127], v8 offset:6656
    s_add_u32 m0, s61, 24576
    v_lshlrev_b32 v14, 16, v145
    v_and_b32 v15, s62, v145
    v_fma_f32 v14, v14, v10, v11
    v_mfma_f32_32x32x16_bf16 a[0:15], a[104:107], v[140:143], a[0:15]
    s_waitcnt vmcnt(8)
    s_barrier
    ds_read_b64_tr_b16 a[96:97], v1 offset:8192
    ds_read_b64_tr_b16 a[98:99], v1 offset:8704
    buffer_load_dwordx4 v16, s[12:15], s43 offen offset:0 lds
    s_waitcnt lgkmcnt(6)
    v_mfma_f32_32x32x16_bf16 a[16:31], a[108:111], v[140:143], a[16:31]
    ds_read_b64_tr_b16 a[100:101], v2 offset:8192
    ds_read_b64_tr_b16 a[102:103], v2 offset:8704
    v_fma_f32 v15, v15, v10, v11
    v_cvt_pk_bf16_f32 v145, v14, v15
    v_lshlrev_b32 v12, 16, v146
    v_mfma_f32_32x32x16_bf16 a[32:47], a[112:115], v[140:143], a[32:47]
    ds_read_b64_tr_b16 a[104:105], v3 offset:8192
    ds_read_b64_tr_b16 a[106:107], v3 offset:8704
    buffer_load_dwordx4 v17, s[12:15], s43 offen offset:1024 lds
    v_and_b32 v13, s62, v146
    v_fma_f32 v12, v12, v10, v11
    v_mfma_f32_32x32x16_bf16 a[48:63], a[116:119], v[140:143], a[48:63]
    ds_read_b64_tr_b16 a[108:109], v4 offset:8192
    ds_read_b64_tr_b16 a[110:111], v4 offset:8704
    v_fma_f32 v13, v13, v10, v11
    v_cvt_pk_bf16_f32 v146, v12, v13
    v_lshlrev_b32 v14, 16, v147
    v_and_b32 v15, s62, v147
    s_waitcnt lgkmcnt(6)
    v_mfma_f32_32x32x16_bf16 a[64:79], a[120:123], v[140:143], a[64:79]
    ds_read_b64_tr_b16 a[112:113], v5 offset:8192
    ds_read_b64_tr_b16 a[114:115], v5 offset:8704
    buffer_load_dwordx4 v18, s[12:15], s43 offen offset:2048 lds
    v_fma_f32 v14, v14, v10, v11
    v_fma_f32 v15, v15, v10, v11
    v_cvt_pk_bf16_f32 v147, v14, v15
    v_mfma_f32_32x32x16_bf16 a[80:95], a[124:127], v[140:143], a[80:95]
    ds_read_b64_tr_b16 a[116:117], v6 offset:8192
    ds_read_b64_tr_b16 a[118:119], v6 offset:8704
    v_lshlrev_b32 v12, 16, v148
    v_and_b32 v13, s62, v148
    v_fma_f32 v12, v12, v10, v11
    v_fma_f32 v13, v13, v10, v11
    v_mfma_f32_32x32x16_bf16 v[32:47], a[96:99], v[144:147], v[32:47]
    ds_read_b64_tr_b16 a[120:121], v7 offset:8192
    ds_read_b64_tr_b16 a[122:123], v7 offset:8704
    buffer_load_dwordx4 v19, s[12:15], s43 offen offset:3072 lds
    v_cvt_pk_bf16_f32 v148, v12, v13
    v_lshlrev_b32 v14, 16, v149
    s_waitcnt lgkmcnt(6)
    v_mfma_f32_32x32x16_bf16 v[48:63], a[100:103], v[144:147], v[48:63]
    ds_read_b64_tr_b16 a[124:125], v8 offset:8192
    ds_read_b64_tr_b16 a[126:127], v8 offset:8704
    s_add_u32 m0, s61, 28672
    s_add_u32 s43, s43, s50
    v_and_b32 v15, s62, v149
    v_mfma_f32_32x32x16_bf16 a[0:15], a[104:107], v[144:147], a[0:15]
    ds_read_b64_tr_b16 a[96:97], v1 offset:10240
    ds_read_b64_tr_b16 a[98:99], v1 offset:10752
    buffer_load_dwordx4 v16, s[12:15], s43 offen offset:0 lds
    v_fma_f32 v14, v14, v10, v11
    v_fma_f32 v15, v15, v10, v11
    v_mfma_f32_32x32x16_bf16 a[16:31], a[108:111], v[144:147], a[16:31]
    ds_read_b64_tr_b16 a[100:101], v2 offset:10240
    ds_read_b64_tr_b16 a[102:103], v2 offset:10752
    v_cvt_pk_bf16_f32 v149, v14, v15
    v_lshlrev_b32 v12, 16, v150
    v_and_b32 v13, s62, v150
    v_fma_f32 v12, v12, v10, v11
    s_waitcnt lgkmcnt(6)
    v_mfma_f32_32x32x16_bf16 a[32:47], a[112:115], v[144:147], a[32:47]
    ds_read_b64_tr_b16 a[104:105], v3 offset:10240
    ds_read_b64_tr_b16 a[106:107], v3 offset:10752
    buffer_load_dwordx4 v17, s[12:15], s43 offen offset:1024 lds
    v_fma_f32 v13, v13, v10, v11
    v_mfma_f32_32x32x16_bf16 a[48:63], a[116:119], v[144:147], a[48:63]
    ds_read_b64_tr_b16 a[108:109], v4 offset:10240
    ds_read_b64_tr_b16 a[110:111], v4 offset:10752
    v_cvt_pk_bf16_f32 v150, v12, v13
    v_lshlrev_b32 v14, 16, v151
    v_and_b32 v15, s62, v151
    v_fma_f32 v14, v14, v10, v11
    v_mfma_f32_32x32x16_bf16 a[64:79], a[120:123], v[144:147], a[64:79]
    ds_read_b64_tr_b16 a[112:113], v5 offset:10240
    ds_read_b64_tr_b16 a[114:115], v5 offset:10752
    buffer_load_dwordx4 v18, s[12:15], s43 offen offset:2048 lds
    v_fma_f32 v15, v15, v10, v11
    v_cvt_pk_bf16_f32 v151, v14, v15
    s_waitcnt lgkmcnt(6)
    v_mfma_f32_32x32x16_bf16 a[80:95], a[124:127], v[144:147], a[80:95]
    ds_read_b64_tr_b16 a[116:117], v6 offset:10240
    ds_read_b64_tr_b16 a[118:119], v6 offset:10752
    v_lshlrev_b32 v12, 16, v152
    v_and_b32 v13, s62, v152
    v_fma_f32 v12, v12, v10, v11
    v_mfma_f32_32x32x16_bf16 v[32:47], a[96:99], v[148:151], v[32:47]
    ds_read_b64_tr_b16 a[120:121], v7 offset:10240
    ds_read_b64_tr_b16 a[122:123], v7 offset:10752
    buffer_load_dwordx4 v19, s[12:15], s43 offen offset:3072 lds
    v_fma_f32 v13, v13, v10, v11
    v_cvt_pk_bf16_f32 v152, v12, v13
    v_mfma_f32_32x32x16_bf16 v[48:63], a[100:103], v[148:151], v[48:63]
    ds_read_b64_tr_b16 a[124:125], v8 offset:10240
    ds_read_b64_tr_b16 a[126:127], v8 offset:10752
    v_lshlrev_b32 v14, 16, v153
    v_and_b32 v15, s62, v153
    v_fma_f32 v14, v14, v10, v11
    v_fma_f32 v15, v15, v10, v11
    s_waitcnt lgkmcnt(6)
    v_mfma_f32_32x32x16_bf16 a[0:15], a[104:107], v[148:151], a[0:15]
    ds_read_b64_tr_b16 a[96:97], v1 offset:12288
    ds_read_b64_tr_b16 a[98:99], v1 offset:12800
    buffer_store_dword v30, v31, s[36:39], 0 offen sc1
    v_cvt_pk_bf16_f32 v153, v14, v15
    v_mfma_f32_32x32x16_bf16 a[16:31], a[108:111], v[148:151], a[16:31]
    ds_read_b64_tr_b16 a[100:101], v2 offset:12288
    ds_read_b64_tr_b16 a[102:103], v2 offset:12800
    s_add_u32 m0, s61, 32768
    s_lshl_b32 s63, s75, 4
    s_add_u32 s63, s63, s53
    v_lshlrev_b32 v12, 16, v154
    v_mfma_f32_32x32x16_bf16 a[32:47], a[112:115], v[148:151], a[32:47]
    ds_read_b64_tr_b16 a[104:105], v3 offset:12288
    ds_read_b64_tr_b16 a[106:107], v3 offset:12800
    buffer_load_dwordx4 v24, s[20:23], s63 offen offset:0 lds
    v_and_b32 v13, s62, v154
    v_fma_f32 v12, v12, v10, v11
    s_waitcnt lgkmcnt(6)
    v_mfma_f32_32x32x16_bf16 a[48:63], a[116:119], v[148:151], a[48:63]
    ds_read_b64_tr_b16 a[108:109], v4 offset:12288
    ds_read_b64_tr_b16 a[110:111], v4 offset:12800
    v_fma_f32 v13, v13, v10, v11
    v_cvt_pk_bf16_f32 v154, v12, v13
    v_lshlrev_b32 v14, 16, v155
    v_mfma_f32_32x32x16_bf16 a[64:79], a[120:123], v[148:151], a[64:79]
    ds_read_b64_tr_b16 a[112:113], v5 offset:12288
    ds_read_b64_tr_b16 a[114:115], v5 offset:12800
    buffer_load_dwordx4 v25, s[20:23], s63 offen offset:1024 lds
    v_and_b32 v15, s62, v155
    v_fma_f32 v14, v14, v10, v11
    v_fma_f32 v15, v15, v10, v11
    v_cvt_pk_bf16_f32 v155, v14, v15
    v_mfma_f32_32x32x16_bf16 a[80:95], a[124:127], v[148:151], a[80:95]
    ds_read_b64_tr_b16 a[116:117], v6 offset:12288
    ds_read_b64_tr_b16 a[118:119], v6 offset:12800
    s_add_u32 s63, s63, 14336
    v_lshlrev_b32 v12, 16, v156
    v_and_b32 v13, s62, v156
    v_fma_f32 v12, v12, v10, v11
    s_waitcnt lgkmcnt(6)
    v_mfma_f32_32x32x16_bf16 v[32:47], a[96:99], v[152:155], v[32:47]
    ds_read_b64_tr_b16 a[120:121], v7 offset:12288
    ds_read_b64_tr_b16 a[122:123], v7 offset:12800
    buffer_load_dwordx4 v24, s[20:23], s63 offen offset:2048 lds
    v_fma_f32 v13, v13, v10, v11
    v_mfma_f32_32x32x16_bf16 v[48:63], a[100:103], v[152:155], v[48:63]
    ds_read_b64_tr_b16 a[124:125], v8 offset:12288
    ds_read_b64_tr_b16 a[126:127], v8 offset:12800
    v_cvt_pk_bf16_f32 v156, v12, v13
    v_lshlrev_b32 v14, 16, v157
    v_and_b32 v15, s62, v157
    v_fma_f32 v14, v14, v10, v11
    v_mfma_f32_32x32x16_bf16 a[0:15], a[104:107], v[152:155], a[0:15]
    ds_read_b64_tr_b16 a[96:97], v1 offset:14336
    ds_read_b64_tr_b16 a[98:99], v1 offset:14848
    buffer_load_dwordx4 v25, s[20:23], s63 offen offset:3072 lds
    v_fma_f32 v15, v15, v10, v11
    v_cvt_pk_bf16_f32 v157, v14, v15
    s_waitcnt lgkmcnt(6)
    v_mfma_f32_32x32x16_bf16 a[16:31], a[108:111], v[152:155], a[16:31]
    ds_read_b64_tr_b16 a[100:101], v2 offset:14336
    ds_read_b64_tr_b16 a[102:103], v2 offset:14848
    v_lshlrev_b32 v12, 16, v158
    v_and_b32 v13, s62, v158
    v_fma_f32 v12, v12, v10, v11
    v_mfma_f32_32x32x16_bf16 a[32:47], a[112:115], v[152:155], a[32:47]
    ds_read_b64_tr_b16 a[104:105], v3 offset:14336
    ds_read_b64_tr_b16 a[106:107], v3 offset:14848
    v_fma_f32 v13, v13, v10, v11
    v_cvt_pk_bf16_f32 v158, v12, v13
    v_lshlrev_b32 v14, 16, v159
    v_and_b32 v15, s62, v159
    v_mfma_f32_32x32x16_bf16 a[48:63], a[116:119], v[152:155], a[48:63]
    ds_read_b64_tr_b16 a[108:109], v4 offset:14336
    ds_read_b64_tr_b16 a[110:111], v4 offset:14848
    v_fma_f32 v14, v14, v10, v11
    v_fma_f32 v15, v15, v10, v11
    v_cvt_pk_bf16_f32 v159, v14, v15
    v_lshlrev_b32 v12, 16, v160
    s_waitcnt lgkmcnt(6)
    v_mfma_f32_32x32x16_bf16 a[64:79], a[120:123], v[152:155], a[64:79]
    ds_read_b64_tr_b16 a[112:113], v5 offset:14336
    ds_read_b64_tr_b16 a[114:115], v5 offset:14848
    v_and_b32 v13, s62, v160
    v_fma_f32 v12, v12, v10, v11
    v_fma_f32 v13, v13, v10, v11
    v_mfma_f32_32x32x16_bf16 a[80:95], a[124:127], v[152:155], a[80:95]
    ds_read_b64_tr_b16 a[116:117], v6 offset:14336
    ds_read_b64_tr_b16 a[118:119], v6 offset:14848
    v_cvt_pk_bf16_f32 v160, v12, v13
    v_lshlrev_b32 v14, 16, v161
    v_and_b32 v15, s62, v161
    v_fma_f32 v14, v14, v10, v11
    v_mfma_f32_32x32x16_bf16 v[32:47], a[96:99], v[156:159], v[32:47]
    ds_read_b64_tr_b16 a[120:121], v7 offset:14336
    ds_read_b64_tr_b16 a[122:123], v7 offset:14848
    v_fma_f32 v15, v15, v10, v11
    v_cvt_pk_bf16_f32 v161, v14, v15
    v_lshlrev_b32 v12, 16, v162
    v_and_b32 v13, s62, v162
    s_waitcnt lgkmcnt(6)
    v_mfma_f32_32x32x16_bf16 v[48:63], a[100:103], v[156:159], v[48:63]
    ds_read_b64_tr_b16 a[124:125], v8 offset:14336
    ds_read_b64_tr_b16 a[126:127], v8 offset:14848
    v_fma_f32 v12, v12, v10, v11
    v_fma_f32 v13, v13, v10, v11
    v_cvt_pk_bf16_f32 v162, v12, v13
    v_mfma_f32_32x32x16_bf16 a[0:15], a[104:107], v[156:159], a[0:15]
    s_waitcnt vmcnt(13)
    s_barrier
    ds_read_b64_tr_b16 a[96:97], v1 offset:16384
    ds_read_b64_tr_b16 a[98:99], v1 offset:16896
    s_add_u32 m0, s61, 0
    s_nop 0
    buffer_load_dwordx4 v16, s[12:15], s44 offen offset:0 lds
    v_mfma_f32_32x32x16_bf16 a[16:31], a[108:111], v[156:159], a[16:31]
    ds_read_b64_tr_b16 a[100:101], v2 offset:16384
    ds_read_b64_tr_b16 a[102:103], v2 offset:16896
    v_lshlrev_b32 v14, 16, v163
    v_and_b32 v15, s62, v163
    v_fma_f32 v14, v14, v10, v11
    v_fma_f32 v15, v15, v10, v11
    s_waitcnt lgkmcnt(6)
    v_mfma_f32_32x32x16_bf16 a[32:47], a[112:115], v[156:159], a[32:47]
    ds_read_b64_tr_b16 a[104:105], v3 offset:16384
    ds_read_b64_tr_b16 a[106:107], v3 offset:16896
    buffer_load_dwordx4 v17, s[12:15], s44 offen offset:1024 lds
    v_cvt_pk_bf16_f32 v163, v14, v15
    v_mfma_f32_32x32x16_bf16 a[48:63], a[116:119], v[156:159], a[48:63]
    ds_read_b64_tr_b16 a[108:109], v4 offset:16384
    ds_read_b64_tr_b16 a[110:111], v4 offset:16896
    v_lshlrev_b32 v12, 16, v164
    v_and_b32 v13, s62, v164
    v_fma_f32 v12, v12, v10, v11
    v_fma_f32 v13, v13, v10, v11
    v_mfma_f32_32x32x16_bf16 a[64:79], a[120:123], v[156:159], a[64:79]
    ds_read_b64_tr_b16 a[112:113], v5 offset:16384
    ds_read_b64_tr_b16 a[114:115], v5 offset:16896
    buffer_load_dwordx4 v18, s[12:15], s44 offen offset:2048 lds
    v_cvt_pk_bf16_f32 v164, v12, v13
    v_lshlrev_b32 v14, 16, v165
    s_waitcnt lgkmcnt(6)
    v_mfma_f32_32x32x16_bf16 a[80:95], a[124:127], v[156:159], a[80:95]
    ds_read_b64_tr_b16 a[116:117], v6 offset:16384
    ds_read_b64_tr_b16 a[118:119], v6 offset:16896
    v_and_b32 v15, s62, v165
    v_fma_f32 v14, v14, v10, v11
    v_fma_f32 v15, v15, v10, v11
    v_mfma_f32_32x32x16_bf16 v[32:47], a[96:99], v[160:163], v[32:47]
    ds_read_b64_tr_b16 a[120:121], v7 offset:16384
    ds_read_b64_tr_b16 a[122:123], v7 offset:16896
    buffer_load_dwordx4 v19, s[12:15], s44 offen offset:3072 lds
    v_cvt_pk_bf16_f32 v165, v14, v15
    v_lshlrev_b32 v12, 16, v166
    v_mfma_f32_32x32x16_bf16 v[48:63], a[100:103], v[160:163], v[48:63]
    ds_read_b64_tr_b16 a[124:125], v8 offset:16384
    ds_read_b64_tr_b16 a[126:127], v8 offset:16896
    s_add_u32 m0, s61, 4096
    s_add_u32 s44, s44, s50
    v_and_b32 v13, s62, v166
    v_fma_f32 v12, v12, v10, v11
    s_waitcnt lgkmcnt(6)
    v_mfma_f32_32x32x16_bf16 a[0:15], a[104:107], v[160:163], a[0:15]
    ds_read_b64_tr_b16 a[96:97], v1 offset:18432
    ds_read_b64_tr_b16 a[98:99], v1 offset:18944
    buffer_load_dwordx4 v16, s[12:15], s44 offen offset:0 lds
    v_fma_f32 v13, v13, v10, v11
    v_mfma_f32_32x32x16_bf16 a[16:31], a[108:111], v[160:163], a[16:31]
    ds_read_b64_tr_b16 a[100:101], v2 offset:18432
    ds_read_b64_tr_b16 a[102:103], v2 offset:18944
    v_cvt_pk_bf16_f32 v166, v12, v13
    v_lshlrev_b32 v14, 16, v167
    v_and_b32 v15, s62, v167
    v_fma_f32 v14, v14, v10, v11
    v_mfma_f32_32x32x16_bf16 a[32:47], a[112:115], v[160:163], a[32:47]
    ds_read_b64_tr_b16 a[104:105], v3 offset:18432
    ds_read_b64_tr_b16 a[106:107], v3 offset:18944
    buffer_load_dwordx4 v17, s[12:15], s44 offen offset:1024 lds
    v_fma_f32 v15, v15, v10, v11
    v_cvt_pk_bf16_f32 v167, v14, v15
    s_waitcnt lgkmcnt(6)
    v_mfma_f32_32x32x16_bf16 a[48:63], a[116:119], v[160:163], a[48:63]
    ds_read_b64_tr_b16 a[108:109], v4 offset:18432
    ds_read_b64_tr_b16 a[110:111], v4 offset:18944
    v_lshlrev_b32 v12, 16, v168
    v_and_b32 v13, s62, v168
    v_fma_f32 v12, v12, v10, v11
    v_mfma_f32_32x32x16_bf16 a[64:79], a[120:123], v[160:163], a[64:79]
    ds_read_b64_tr_b16 a[112:113], v5 offset:18432
    ds_read_b64_tr_b16 a[114:115], v5 offset:18944
    buffer_load_dwordx4 v18, s[12:15], s44 offen offset:2048 lds
    v_fma_f32 v13, v13, v10, v11
    v_cvt_pk_bf16_f32 v168, v12, v13
    v_mfma_f32_32x32x16_bf16 a[80:95], a[124:127], v[160:163], a[80:95]
    ds_read_b64_tr_b16 a[116:117], v6 offset:18432
    ds_read_b64_tr_b16 a[118:119], v6 offset:18944
    v_lshlrev_b32 v14, 16, v169
    v_and_b32 v15, s62, v169
    v_fma_f32 v14, v14, v10, v11
    v_fma_f32 v15, v15, v10, v11
    s_waitcnt lgkmcnt(6)
    v_mfma_f32_32x32x16_bf16 v[32:47], a[96:99], v[164:167], v[32:47]
    ds_read_b64_tr_b16 a[120:121], v7 offset:18432
    ds_read_b64_tr_b16 a[122:123], v7 offset:18944
    buffer_load_dwordx4 v19, s[12:15], s44 offen offset:3072 lds
    v_cvt_pk_bf16_f32 v169, v14, v15
    v_mfma_f32_32x32x16_bf16 v[48:63], a[100:103], v[164:167], v[48:63]
    ds_read_b64_tr_b16 a[124:125], v8 offset:18432
    ds_read_b64_tr_b16 a[126:127], v8 offset:18944
    s_add_u32 m0, s61, 36864
    s_lshl_b32 s63, s75, 4
    s_add_u32 s63, s63, s53
    s_add_u32 s63, s63, 32768
    v_mfma_f32_32x32x16_bf16 a[0:15], a[104:107], v[164:167], a[0:15]
    ds_read_b64_tr_b16 a[96:97], v1 offset:20480
    ds_read_b64_tr_b16 a[98:99], v1 offset:20992
    buffer_load_dwordx4 v24, s[20:23], s63 offen offset:0 lds
    v_lshlrev_b32 v12, 16, v170
    v_and_b32 v13, s62, v170
    s_waitcnt lgkmcnt(6)
    v_mfma_f32_32x32x16_bf16 a[16:31], a[108:111], v[164:167], a[16:31]
    ds_read_b64_tr_b16 a[100:101], v2 offset:20480
    ds_read_b64_tr_b16 a[102:103], v2 offset:20992
    v_fma_f32 v12, v12, v10, v11
    v_fma_f32 v13, v13, v10, v11
    v_cvt_pk_bf16_f32 v170, v12, v13
    v_mfma_f32_32x32x16_bf16 a[32:47], a[112:115], v[164:167], a[32:47]
    ds_read_b64_tr_b16 a[104:105], v3 offset:20480
    ds_read_b64_tr_b16 a[106:107], v3 offset:20992
    buffer_load_dwordx4 v25, s[20:23], s63 offen offset:1024 lds
    v_lshlrev_b32 v14, 16, v171
    v_and_b32 v15, s62, v171
    v_mfma_f32_32x32x16_bf16 a[48:63], a[116:119], v[164:167], a[48:63]
    ds_read_b64_tr_b16 a[108:109], v4 offset:20480
    ds_read_b64_tr_b16 a[110:111], v4 offset:20992
    s_add_u32 s63, s63, 14336
    v_fma_f32 v14, v14, v10, v11
    v_fma_f32 v15, v15, v10, v11
    v_cvt_pk_bf16_f32 v171, v14, v15
    s_waitcnt lgkmcnt(6)
    v_mfma_f32_32x32x16_bf16 a[64:79], a[120:123], v[164:167], a[64:79]
    ds_read_b64_tr_b16 a[112:113], v5 offset:20480
    ds_read_b64_tr_b16 a[114:115], v5 offset:20992
    buffer_load_dwordx4 v24, s[20:23], s63 offen offset:2048 lds
    v_lshlrev_b32 v12, 16, v172
    v_mfma_f32_32x32x16_bf16 a[80:95], a[124:127], v[164:167], a[80:95]
    ds_read_b64_tr_b16 a[116:117], v6 offset:20480
    ds_read_b64_tr_b16 a[118:119], v6 offset:20992
    v_and_b32 v13, s62, v172
    v_fma_f32 v12, v12, v10, v11
    v_fma_f32 v13, v13, v10, v11
    v_cvt_pk_bf16_f32 v172, v12, v13
    v_mfma_f32_32x32x16_bf16 v[32:47], a[96:99], v[168:171], v[32:47]
    ds_read_b64_tr_b16 a[120:121], v7 offset:20480
    ds_read_b64_tr_b16 a[122:123], v7 offset:20992
    buffer_load_dwordx4 v25, s[20:23], s63 offen offset:3072 lds
    v_lshlrev_b32 v14, 16, v173
    v_and_b32 v15, s62, v173
    s_waitcnt lgkmcnt(6)
    v_mfma_f32_32x32x16_bf16 v[48:63], a[100:103], v[168:171], v[48:63]
    ds_read_b64_tr_b16 a[124:125], v8 offset:20480
    ds_read_b64_tr_b16 a[126:127], v8 offset:20992
    v_fma_f32 v14, v14, v10, v11
    v_fma_f32 v15, v15, v10, v11
    v_cvt_pk_bf16_f32 v173, v14, v15
    v_mfma_f32_32x32x16_bf16 a[0:15], a[104:107], v[168:171], a[0:15]
    ds_read_b64_tr_b16 a[96:97], v1 offset:22528
    ds_read_b64_tr_b16 a[98:99], v1 offset:23040
    v_lshlrev_b32 v12, 16, v174
    v_and_b32 v13, s62, v174
    v_fma_f32 v12, v12, v10, v11
    v_fma_f32 v13, v13, v10, v11
    v_mfma_f32_32x32x16_bf16 a[16:31], a[108:111], v[168:171], a[16:31]
    ds_read_b64_tr_b16 a[100:101], v2 offset:22528
    ds_read_b64_tr_b16 a[102:103], v2 offset:23040
    v_cvt_pk_bf16_f32 v174, v12, v13
    v_lshlrev_b32 v14, 16, v175
    v_and_b32 v15, s62, v175
    v_fma_f32 v14, v14, v10, v11
    s_waitcnt lgkmcnt(6)
    v_mfma_f32_32x32x16_bf16 a[32:47], a[112:115], v[168:171], a[32:47]
    ds_read_b64_tr_b16 a[104:105], v3 offset:22528
    ds_read_b64_tr_b16 a[106:107], v3 offset:23040
    v_fma_f32 v15, v15, v10, v11
    v_cvt_pk_bf16_f32 v175, v14, v15
    v_lshlrev_b32 v12, 16, v176
    v_mfma_f32_32x32x16_bf16 a[48:63], a[116:119], v[168:171], a[48:63]
    ds_read_b64_tr_b16 a[108:109], v4 offset:22528
    ds_read_b64_tr_b16 a[110:111], v4 offset:23040
    v_and_b32 v13, s62, v176
    v_fma_f32 v12, v12, v10, v11
    v_fma_f32 v13, v13, v10, v11
    v_cvt_pk_bf16_f32 v176, v12, v13
    v_mfma_f32_32x32x16_bf16 a[64:79], a[120:123], v[168:171], a[64:79]
    ds_read_b64_tr_b16 a[112:113], v5 offset:22528
    ds_read_b64_tr_b16 a[114:115], v5 offset:23040
    v_lshlrev_b32 v14, 16, v177
    v_and_b32 v15, s62, v177
    v_fma_f32 v14, v14, v10, v11
    v_fma_f32 v15, v15, v10, v11
    s_waitcnt lgkmcnt(6)
    v_mfma_f32_32x32x16_bf16 a[80:95], a[124:127], v[168:171], a[80:95]
    ds_read_b64_tr_b16 a[116:117], v6 offset:22528
    ds_read_b64_tr_b16 a[118:119], v6 offset:23040
    v_cvt_pk_bf16_f32 v177, v14, v15
    v_lshlrev_b32 v12, 16, v178
    v_and_b32 v13, s62, v178
    v_mfma_f32_32x32x16_bf16 v[32:47], a[96:99], v[172:175], v[32:47]
    ds_read_b64_tr_b16 a[120:121], v7 offset:22528
    ds_read_b64_tr_b16 a[122:123], v7 offset:23040
    v_fma_f32 v12, v12, v10, v11
    v_fma_f32 v13, v13, v10, v11
    v_cvt_pk_bf16_f32 v178, v12, v13
    v_lshlrev_b32 v14, 16, v179
    v_mfma_f32_32x32x16_bf16 v[48:63], a[100:103], v[172:175], v[48:63]
    ds_read_b64_tr_b16 a[124:125], v8 offset:22528
    ds_read_b64_tr_b16 a[126:127], v8 offset:23040
    v_and_b32 v15, s62, v179
    v_fma_f32 v14, v14, v10, v11
    v_fma_f32 v15, v15, v10, v11
    v_cvt_pk_bf16_f32 v179, v14, v15
    s_waitcnt lgkmcnt(6)
    v_mfma_f32_32x32x16_bf16 a[0:15], a[104:107], v[172:175], a[0:15]
    s_waitcnt vmcnt(17)
    s_barrier
    ds_read_b64_tr_b16 a[96:97], v1 offset:24576
    ds_read_b64_tr_b16 a[98:99], v1 offset:25088
    s_waitcnt vmcnt(14)
    ds_read_b64_tr_b16 a[128:129], v26 offset:32768
    v_mfma_f32_32x32x16_bf16 a[16:31], a[108:111], v[172:175], a[16:31]
    ds_read_b64_tr_b16 a[100:101], v2 offset:24576
    ds_read_b64_tr_b16 a[102:103], v2 offset:25088
    ds_read_b64_tr_b16 a[130:131], v26 offset:33792
    s_add_u32 m0, s61, 8192
    s_nop 0
    buffer_load_dwordx4 v16, s[12:15], s45 offen offset:0 lds
    v_mfma_f32_32x32x16_bf16 a[32:47], a[112:115], v[172:175], a[32:47]
    ds_read_b64_tr_b16 a[104:105], v3 offset:24576
    ds_read_b64_tr_b16 a[106:107], v3 offset:25088
    ds_read_b64_tr_b16 a[132:133], v27 offset:32768
    v_lshlrev_b32 v12, 16, v180
    v_and_b32 v13, s62, v180
    v_fma_f32 v12, v12, v10, v11
    s_waitcnt lgkmcnt(9)
    v_mfma_f32_32x32x16_bf16 a[48:63], a[116:119], v[172:175], a[48:63]
    ds_read_b64_tr_b16 a[108:109], v4 offset:24576
    ds_read_b64_tr_b16 a[110:111], v4 offset:25088
    ds_read_b64_tr_b16 a[134:135], v27 offset:33792
    buffer_load_dwordx4 v17, s[12:15], s45 offen offset:1024 lds
    v_mfma_f32_32x32x16_bf16 a[64:79], a[120:123], v[172:175], a[64:79]
    ds_read_b64_tr_b16 a[112:113], v5 offset:24576
    ds_read_b64_tr_b16 a[114:115], v5 offset:25088
    s_waitcnt vmcnt(14)
    ds_read_b64_tr_b16 a[136:137], v26 offset:34816
    v_fma_f32 v13, v13, v10, v11
    v_cvt_pk_bf16_f32 v180, v12, v13
    v_lshlrev_b32 v14, 16, v181
    v_mfma_f32_32x32x16_bf16 a[80:95], a[124:127], v[172:175], a[80:95]
    s_waitcnt lgkmcnt(14)
    ds_read_b64_tr_b16 a[116:117], v6 offset:24576
    s_waitcnt lgkmcnt(14)
    ds_read_b64_tr_b16 a[118:119], v6 offset:25088
    buffer_load_dwordx4 v18, s[12:15], s45 offen offset:2048 lds
    v_and_b32 v15, s62, v181
    v_fma_f32 v14, v14, v10, v11
    s_waitcnt lgkmcnt(9)
    v_mfma_f32_32x32x16_bf16 v[32:47], a[96:99], v[176:179], v[32:47]
    ds_read_b64_tr_b16 a[120:121], v7 offset:24576
    ds_read_b64_tr_b16 a[122:123], v7 offset:25088
    ds_read_b64_tr_b16 a[138:139], v26 offset:35840
    v_fma_f32 v15, v15, v10, v11
    v_cvt_pk_bf16_f32 v181, v14, v15
    v_mfma_f32_32x32x16_bf16 v[48:63], a[100:103], v[176:179], v[48:63]
    ds_read_b64_tr_b16 a[124:125], v8 offset:24576
    ds_read_b64_tr_b16 a[126:127], v8 offset:25088
    ds_read_b64_tr_b16 a[140:141], v27 offset:34816
    buffer_load_dwordx4 v19, s[12:15], s45 offen offset:3072 lds
    v_lshlrev_b32 v12, 16, v182
    v_mfma_f32_32x32x16_bf16 a[0:15], a[104:107], v[176:179], a[0:15]
    s_waitcnt lgkmcnt(14)
    ds_read_b64_tr_b16 a[96:97], v1 offset:26624
    s_waitcnt lgkmcnt(14)
    ds_read_b64_tr_b16 a[98:99], v1 offset:27136
    s_add_u32 m0, s61, 12288
    s_add_u32 s45, s45, s50
    v_and_b32 v13, s62, v182
    v_fma_f32 v12, v12, v10, v11
    s_waitcnt lgkmcnt(8)
    v_mfma_f32_32x32x16_bf16 a[16:31], a[108:111], v[176:179], a[16:31]
    ds_read_b64_tr_b16 a[100:101], v2 offset:26624
    ds_read_b64_tr_b16 a[102:103], v2 offset:27136
    ds_read_b64_tr_b16 a[142:143], v27 offset:35840
    buffer_load_dwordx4 v16, s[12:15], s45 offen offset:0 lds
    v_mfma_f32_32x32x16_bf16 a[32:47], a[112:115], v[176:179], a[32:47]
    ds_read_b64_tr_b16 a[104:105], v3 offset:26624
    ds_read_b64_tr_b16 a[106:107], v3 offset:27136
    v_fma_f32 v13, v13, v10, v11
    v_cvt_pk_bf16_f32 v182, v12, v13
    v_lshlrev_b32 v14, 16, v183
    v_and_b32 v15, s62, v183
    v_mfma_f32_32x32x16_bf16 a[48:63], a[116:119], v[176:179], a[48:63]
    ds_read_b64_tr_b16 a[108:109], v4 offset:26624
    ds_read_b64_tr_b16 a[110:111], v4 offset:27136
    buffer_load_dwordx4 v17, s[12:15], s45 offen offset:1024 lds
    v_fma_f32 v14, v14, v10, v11
    v_fma_f32 v15, v15, v10, v11
    s_waitcnt lgkmcnt(7)
    v_mfma_f32_32x32x16_bf16 a[64:79], a[120:123], v[176:179], a[64:79]
    ds_read_b64_tr_b16 a[112:113], v5 offset:26624
    ds_read_b64_tr_b16 a[114:115], v5 offset:27136
    v_cvt_pk_bf16_f32 v183, v14, v15
    v_lshlrev_b32 v12, 16, v184
    v_and_b32 v13, s62, v184
    v_mfma_f32_32x32x16_bf16 a[80:95], a[124:127], v[176:179], a[80:95]
    ds_read_b64_tr_b16 a[116:117], v6 offset:26624
    ds_read_b64_tr_b16 a[118:119], v6 offset:27136
    buffer_load_dwordx4 v18, s[12:15], s45 offen offset:2048 lds
    v_fma_f32 v12, v12, v10, v11
    v_fma_f32 v13, v13, v10, v11
    v_mfma_f32_32x32x16_bf16 v[32:47], a[96:99], v[180:183], v[32:47]
    ds_read_b64_tr_b16 a[120:121], v7 offset:26624
    ds_read_b64_tr_b16 a[122:123], v7 offset:27136
    v_cvt_pk_bf16_f32 v184, v12, v13
    v_lshlrev_b32 v14, 16, v185
    v_and_b32 v15, s62, v185
    v_fma_f32 v14, v14, v10, v11
    s_waitcnt lgkmcnt(6)
    v_mfma_f32_32x32x16_bf16 v[48:63], a[100:103], v[180:183], v[48:63]
    ds_read_b64_tr_b16 a[124:125], v8 offset:26624
    ds_read_b64_tr_b16 a[126:127], v8 offset:27136
    buffer_load_dwordx4 v19, s[12:15], s45 offen offset:3072 lds
    v_fma_f32 v15, v15, v10, v11
    v_mfma_f32_32x32x16_bf16 a[0:15], a[104:107], v[180:183], a[0:15]
    ds_read_b64_tr_b16 a[96:97], v1 offset:28672
    ds_read_b64_tr_b16 a[98:99], v1 offset:29184
    v_cvt_pk_bf16_f32 v185, v14, v15
    v_lshlrev_b32 v12, 16, v186
    v_and_b32 v13, s62, v186
    v_fma_f32 v12, v12, v10, v11
    v_mfma_f32_32x32x16_bf16 a[16:31], a[108:111], v[180:183], a[16:31]
    ds_read_b64_tr_b16 a[100:101], v2 offset:28672
    ds_read_b64_tr_b16 a[102:103], v2 offset:29184
    buffer_load_dword v30, off, s[36:39], s1 sc1
    v_fma_f32 v13, v13, v10, v11
    v_cvt_pk_bf16_f32 v186, v12, v13
    s_waitcnt lgkmcnt(6)
    v_mfma_f32_32x32x16_bf16 a[32:47], a[112:115], v[180:183], a[32:47]
    ds_read_b64_tr_b16 a[104:105], v3 offset:28672
    ds_read_b64_tr_b16 a[106:107], v3 offset:29184
    s_add_u32 m0, s61, 32768
    s_lshl_b32 s63, s76, 4
    s_add_u32 s63, s63, s53
    v_mfma_f32_32x32x16_bf16 a[48:63], a[116:119], v[180:183], a[48:63]
    ds_read_b64_tr_b16 a[108:109], v4 offset:28672
    ds_read_b64_tr_b16 a[110:111], v4 offset:29184
    buffer_load_dwordx4 v24, s[20:23], s63 offen offset:0 lds
    v_lshlrev_b32 v14, 16, v187
    v_and_b32 v15, s62, v187
    v_mfma_f32_32x32x16_bf16 a[64:79], a[120:123], v[180:183], a[64:79]
    ds_read_b64_tr_b16 a[112:113], v5 offset:28672
    ds_read_b64_tr_b16 a[114:115], v5 offset:29184
    v_fma_f32 v14, v14, v10, v11
    v_fma_f32 v15, v15, v10, v11
    v_cvt_pk_bf16_f32 v187, v14, v15
    v_lshlrev_b32 v12, 16, v188
    s_waitcnt lgkmcnt(6)
    v_mfma_f32_32x32x16_bf16 a[80:95], a[124:127], v[180:183], a[80:95]
    ds_read_b64_tr_b16 a[116:117], v6 offset:28672
    ds_read_b64_tr_b16 a[118:119], v6 offset:29184
    buffer_load_dwordx4 v25, s[20:23], s63 offen offset:1024 lds
    v_and_b32 v13, s62, v188
    v_mfma_f32_32x32x16_bf16 v[32:47], a[96:99], v[184:187], v[32:47]
    ds_read_b64_tr_b16 a[120:121], v7 offset:28672
    ds_read_b64_tr_b16 a[122:123], v7 offset:29184
    s_add_u32 s63, s63, 14336
    v_fma_f32 v12, v12, v10, v11
    v_fma_f32 v13, v13, v10, v11
    v_cvt_pk_bf16_f32 v188, v12, v13
    v_mfma_f32_32x32x16_bf16 v[48:63], a[100:103], v[184:187], v[48:63]
    ds_read_b64_tr_b16 a[124:125], v8 offset:28672
    ds_read_b64_tr_b16 a[126:127], v8 offset:29184
    buffer_load_dwordx4 v24, s[20:23], s63 offen offset:2048 lds
    v_lshlrev_b32 v14, 16, v189
    v_and_b32 v15, s62, v189
    s_waitcnt lgkmcnt(6)
    v_mfma_f32_32x32x16_bf16 a[0:15], a[104:107], v[184:187], a[0:15]
    ds_read_b64_tr_b16 a[96:97], v1 offset:30720
    ds_read_b64_tr_b16 a[98:99], v1 offset:31232
    v_fma_f32 v14, v14, v10, v11
    v_fma_f32 v15, v15, v10, v11
    v_cvt_pk_bf16_f32 v189, v14, v15
    v_mfma_f32_32x32x16_bf16 a[16:31], a[108:111], v[184:187], a[16:31]
    ds_read_b64_tr_b16 a[100:101], v2 offset:30720
    ds_read_b64_tr_b16 a[102:103], v2 offset:31232
    buffer_load_dwordx4 v25, s[20:23], s63 offen offset:3072 lds
    v_lshlrev_b32 v12, 16, v190
    v_and_b32 v13, s62, v190
    v_mfma_f32_32x32x16_bf16 a[32:47], a[112:115], v[184:187], a[32:47]
    ds_read_b64_tr_b16 a[104:105], v3 offset:30720
    ds_read_b64_tr_b16 a[106:107], v3 offset:31232
    v_fma_f32 v12, v12, v10, v11
    v_fma_f32 v13, v13, v10, v11
    v_cvt_pk_bf16_f32 v190, v12, v13
    v_lshlrev_b32 v14, 16, v191
    s_waitcnt lgkmcnt(6)
    v_mfma_f32_32x32x16_bf16 a[48:63], a[116:119], v[184:187], a[48:63]
    ds_read_b64_tr_b16 a[108:109], v4 offset:30720
    ds_read_b64_tr_b16 a[110:111], v4 offset:31232
    v_and_b32 v15, s62, v191
    v_fma_f32 v14, v14, v10, v11
    v_fma_f32 v15, v15, v10, v11
    v_mfma_f32_32x32x16_bf16 a[64:79], a[120:123], v[184:187], a[64:79]
    ds_read_b64_tr_b16 a[112:113], v5 offset:30720
    ds_read_b64_tr_b16 a[114:115], v5 offset:31232
    v_cvt_pk_bf16_f32 v191, v14, v15
    v_lshlrev_b32 v12, 16, v192
    v_and_b32 v13, s62, v192
    v_fma_f32 v12, v12, v10, v11
    v_mfma_f32_32x32x16_bf16 a[80:95], a[124:127], v[184:187], a[80:95]
    ds_read_b64_tr_b16 a[116:117], v6 offset:30720
    ds_read_b64_tr_b16 a[118:119], v6 offset:31232
    v_fma_f32 v13, v13, v10, v11
    v_cvt_pk_bf16_f32 v192, v12, v13
    v_lshlrev_b32 v14, 16, v193
    v_and_b32 v15, s62, v193
    s_waitcnt lgkmcnt(6)
    v_mfma_f32_32x32x16_bf16 v[32:47], a[96:99], v[188:191], v[32:47]
    ds_read_b64_tr_b16 a[120:121], v7 offset:30720
    ds_read_b64_tr_b16 a[122:123], v7 offset:31232
    v_fma_f32 v14, v14, v10, v11
    v_fma_f32 v15, v15, v10, v11
    v_cvt_pk_bf16_f32 v193, v14, v15
    v_mfma_f32_32x32x16_bf16 v[48:63], a[100:103], v[188:191], v[48:63]
    ds_read_b64_tr_b16 a[124:125], v8 offset:30720
    ds_read_b64_tr_b16 a[126:127], v8 offset:31232
    v_lshlrev_b32 v12, 16, v194
    v_and_b32 v13, s62, v194
    v_fma_f32 v12, v12, v10, v11
    v_fma_f32 v13, v13, v10, v11
    v_mfma_f32_32x32x16_bf16 a[0:15], a[104:107], v[188:191], a[0:15]
    s_waitcnt vmcnt(17)
    s_barrier
    ds_read_b64_tr_b16 a[96:97], v1 offset:0
    ds_read_b64_tr_b16 a[98:99], v1 offset:512
    s_waitcnt vmcnt(15)
    ds_read_b64_tr_b16 a[144:145], v26 offset:36864
    s_add_u32 m0, s61, 16384
    s_nop 0
    buffer_load_dwordx4 v16, s[12:15], s46 offen offset:0 lds
    s_waitcnt lgkmcnt(7)
    v_mfma_f32_32x32x16_bf16 a[16:31], a[108:111], v[188:191], a[16:31]
    ds_read_b64_tr_b16 a[100:101], v2 offset:0
    ds_read_b64_tr_b16 a[102:103], v2 offset:512
    ds_read_b64_tr_b16 a[146:147], v26 offset:37888
    v_cvt_pk_bf16_f32 v194, v12, v13
    v_lshlrev_b32 v14, 16, v195
    v_mfma_f32_32x32x16_bf16 a[32:47], a[112:115], v[188:191], a[32:47]
    ds_read_b64_tr_b16 a[104:105], v3 offset:0
    ds_read_b64_tr_b16 a[106:107], v3 offset:512
    ds_read_b64_tr_b16 a[148:149], v27 offset:36864
    buffer_load_dwordx4 v17, s[12:15], s46 offen offset:1024 lds
    v_and_b32 v15, s62, v195
    v_mfma_f32_32x32x16_bf16 a[48:63], a[116:119], v[188:191], a[48:63]
    ds_read_b64_tr_b16 a[108:109], v4 offset:0
    ds_read_b64_tr_b16 a[110:111], v4 offset:512
    v_fma_f32 v14, v14, v10, v11
    v_fma_f32 v15, v15, v10, v11
    v_cvt_pk_bf16_f32 v195, v14, v15
    v_lshlrev_b32 v12, 16, v196
    s_waitcnt lgkmcnt(9)
    v_mfma_f32_32x32x16_bf16 a[64:79], a[120:123], v[188:191], a[64:79]
    ds_read_b64_tr_b16 a[112:113], v5 offset:0
    ds_read_b64_tr_b16 a[114:115], v5 offset:512
    ds_read_b64_tr_b16 a[150:151], v27 offset:37888
    buffer_load_dwordx4 v18, s[12:15], s46 offen offset:2048 lds
    v_mfma_f32_32x32x16_bf16 a[80:95], a[124:127], v[188:191], a[80:95]
    ds_read_b64_tr_b16 a[116:117], v6 offset:0
    ds_read_b64_tr_b16 a[118:119], v6 offset:512
    s_waitcnt vmcnt(16)
    ds_read_b64_tr_b16 a[152:153], v26 offset:38912
    v_and_b32 v13, s62, v196
    v_fma_f32 v12, v12, v10, v11
    v_fma_f32 v13, v13, v10, v11
    v_mfma_f32_32x32x16_bf16 v[32:47], a[96:99], v[192:195], v[32:47]
    s_waitcnt lgkmcnt(14)
    ds_read_b64_tr_b16 a[120:121], v7 offset:0
    s_waitcnt lgkmcnt(14)
    ds_read_b64_tr_b16 a[122:123], v7 offset:512
    buffer_load_dwordx4 v19, s[12:15], s46 offen offset:3072 lds
    v_cvt_pk_bf16_f32 v196, v12, v13
    v_lshlrev_b32 v14, 16, v197
    s_waitcnt lgkmcnt(8)
    v_mfma_f32_32x32x16_bf16 v[48:63], a[100:103], v[192:195], v[48:63]
    ds_read_b64_tr_b16 a[124:125], v8 offset:0
    ds_read_b64_tr_b16 a[126:127], v8 offset:512
    ds_read_b64_tr_b16 a[154:155], v26 offset:39936
    s_add_u32 m0, s61, 20480
    s_add_u32 s46, s46, s50
    v_mfma_f32_32x32x16_bf16 a[0:15], a[104:107], v[192:195], a[0:15]
    ds_read_b64_tr_b16 a[96:97], v1 offset:2048
    ds_read_b64_tr_b16 a[98:99], v1 offset:2560
    ds_read_b64_tr_b16 a[156:157], v27 offset:38912
    buffer_load_dwordx4 v16, s[12:15], s46 offen offset:0 lds
    v_and_b32 v15, s62, v197
    v_mfma_f32_32x32x16_bf16 a[16:31], a[108:111], v[192:195], a[16:31]
    ds_read_b64_tr_b16 a[100:101], v2 offset:2048
    s_waitcnt lgkmcnt(14)
    ds_read_b64_tr_b16 a[102:103], v2 offset:2560
    v_fma_f32 v14, v14, v10, v11
    v_fma_f32 v15, v15, v10, v11
    v_cvt_pk_bf16_f32 v197, v14, v15
    v_lshlrev_b32 v12, 16, v198
    s_waitcnt lgkmcnt(8)
    v_mfma_f32_32x32x16_bf16 a[32:47], a[112:115], v[192:195], a[32:47]
    ds_read_b64_tr_b16 a[104:105], v3 offset:2048
    ds_read_b64_tr_b16 a[106:107], v3 offset:2560
    ds_read_b64_tr_b16 a[158:159], v27 offset:39936
    buffer_load_dwordx4 v17, s[12:15], s46 offen offset:1024 lds
    v_mfma_f32_32x32x16_bf16 a[48:63], a[116:119], v[192:195], a[48:63]
    ds_read_b64_tr_b16 a[108:109], v4 offset:2048
    ds_read_b64_tr_b16 a[110:111], v4 offset:2560
    v_and_b32 v13, s62, v198
    v_fma_f32 v12, v12, v10, v11
    v_fma_f32 v13, v13, v10, v11
    v_cvt_pk_bf16_f32 v198, v12, v13
    v_mfma_f32_32x32x16_bf16 a[64:79], a[120:123], v[192:195], a[64:79]
    ds_read_b64_tr_b16 a[112:113], v5 offset:2048
    ds_read_b64_tr_b16 a[114:115], v5 offset:2560
    buffer_load_dwordx4 v18, s[12:15], s46 offen offset:2048 lds
    v_lshlrev_b32 v14, 16, v199
    v_and_b32 v15, s62, v199
    v_fma_f32 v14, v14, v10, v11
    v_fma_f32 v15, v15, v10, v11
    v_cvt_pk_bf16_f32 v199, v14, v15
    s_waitcnt lgkmcnt(7)
    v_mfma_f32_32x32x16_bf16 a[80:95], a[124:127], v[192:195], a[80:95]
    ds_read_b64_tr_b16 a[116:117], v6 offset:2048
    ds_read_b64_tr_b16 a[118:119], v6 offset:2560
    v_lshlrev_b32 v12, 16, v200
    v_and_b32 v13, s62, v200
    v_fma_f32 v12, v12, v10, v11
    v_mfma_f32_32x32x16_bf16 v[32:47], a[96:99], v[196:199], v[32:47]
    ds_read_b64_tr_b16 a[120:121], v7 offset:2048
    ds_read_b64_tr_b16 a[122:123], v7 offset:2560
    buffer_load_dwordx4 v19, s[12:15], s46 offen offset:3072 lds
    v_fma_f32 v13, v13, v10, v11
    v_cvt_pk_bf16_f32 v200, v12, v13
    v_mfma_f32_32x32x16_bf16 v[48:63], a[100:103], v[196:199], v[48:63]
    ds_read_b64_tr_b16 a[124:125], v8 offset:2048
    ds_read_b64_tr_b16 a[126:127], v8 offset:2560
    s_waitcnt lgkmcnt(10)
    s_add_u32 m0, s61, 36864
    s_lshl_b32 s63, s76, 4
    s_add_u32 s63, s63, s53
    s_waitcnt lgkmcnt(6)
    v_mfma_f32_32x32x16_bf16 a[0:15], a[104:107], v[196:199], a[0:15]
    ds_read_b64_tr_b16 a[96:97], v1 offset:4096
    ds_read_b64_tr_b16 a[98:99], v1 offset:4608
    s_add_u32 s63, s63, 32768
    buffer_load_dwordx4 v24, s[20:23], s63 offen offset:0 lds
    v_mfma_f32_32x32x16_bf16 a[16:31], a[108:111], v[196:199], a[16:31]
    ds_read_b64_tr_b16 a[100:101], v2 offset:4096
    ds_read_b64_tr_b16 a[102:103], v2 offset:4608
    v_lshlrev_b32 v14, 16, v201
    v_and_b32 v15, s62, v201
    v_fma_f32 v14, v14, v10, v11
    v_fma_f32 v15, v15, v10, v11
    v_mfma_f32_32x32x16_bf16 a[32:47], a[112:115], v[196:199], a[32:47]
    ds_read_b64_tr_b16 a[104:105], v3 offset:4096
    ds_read_b64_tr_b16 a[106:107], v3 offset:4608
    buffer_load_dwordx4 v25, s[20:23], s63 offen offset:1024 lds
    v_cvt_pk_bf16_f32 v201, v14, v15
    v_lshlrev_b32 v12, 16, v202
    s_waitcnt lgkmcnt(6)
    v_mfma_f32_32x32x16_bf16 a[48:63], a[116:119], v[196:199], a[48:63]
    ds_read_b64_tr_b16 a[108:109], v4 offset:4096
    ds_read_b64_tr_b16 a[110:111], v4 offset:4608
    s_add_u32 s63, s63, 14336
    v_and_b32 v13, s62, v202
    v_fma_f32 v12, v12, v10, v11
    v_fma_f32 v13, v13, v10, v11
    v_mfma_f32_32x32x16_bf16 a[64:79], a[120:123], v[196:199], a[64:79]
    ds_read_b64_tr_b16 a[112:113], v5 offset:4096
    ds_read_b64_tr_b16 a[114:115], v5 offset:4608
    buffer_load_dwordx4 v24, s[20:23], s63 offen offset:2048 lds
    v_cvt_pk_bf16_f32 v202, v12, v13
    v_lshlrev_b32 v14, 16, v203
    v_and_b32 v15, s62, v203
    v_fma_f32 v14, v14, v10, v11
    v_fma_f32 v15, v15, v10, v11
    v_cvt_pk_bf16_f32 v203, v14, v15
    v_mfma_f32_32x32x16_bf16 a[80:95], a[124:127], v[196:199], a[80:95]
    ds_read_b64_tr_b16 a[116:117], v6 offset:4096
    ds_read_b64_tr_b16 a[118:119], v6 offset:4608
    v_lshlrev_b32 v12, 16, v204
    v_and_b32 v13, s62, v204
    v_fma_f32 v12, v12, v10, v11
    v_fma_f32 v13, v13, v10, v11
    s_waitcnt lgkmcnt(6)
    v_mfma_f32_32x32x16_bf16 v[32:47], a[96:99], v[200:203], v[32:47]
    ds_read_b64_tr_b16 a[120:121], v7 offset:4096
    ds_read_b64_tr_b16 a[122:123], v7 offset:4608
    buffer_load_dwordx4 v25, s[20:23], s63 offen offset:3072 lds
    v_cvt_pk_bf16_f32 v204, v12, v13
    v_mfma_f32_32x32x16_bf16 v[48:63], a[100:103], v[200:203], v[48:63]
    ds_read_b64_tr_b16 a[124:125], v8 offset:4096
    ds_read_b64_tr_b16 a[126:127], v8 offset:4608
    v_lshlrev_b32 v14, 16, v205
    v_and_b32 v15, s62, v205
    v_fma_f32 v14, v14, v10, v11
    v_fma_f32 v15, v15, v10, v11
    v_mfma_f32_32x32x16_bf16 a[0:15], a[104:107], v[200:203], a[0:15]
    ds_read_b64_tr_b16 a[96:97], v1 offset:6144
    ds_read_b64_tr_b16 a[98:99], v1 offset:6656
    v_cvt_pk_bf16_f32 v205, v14, v15
    v_lshlrev_b32 v12, 16, v206
    v_and_b32 v13, s62, v206
    v_fma_f32 v12, v12, v10, v11
    s_waitcnt lgkmcnt(6)
    v_mfma_f32_32x32x16_bf16 a[16:31], a[108:111], v[200:203], a[16:31]
    ds_read_b64_tr_b16 a[100:101], v2 offset:6144
    ds_read_b64_tr_b16 a[102:103], v2 offset:6656
    v_fma_f32 v13, v13, v10, v11
    v_cvt_pk_bf16_f32 v206, v12, v13
    v_lshlrev_b32 v14, 16, v207
    v_mfma_f32_32x32x16_bf16 a[32:47], a[112:115], v[200:203], a[32:47]
    ds_read_b64_tr_b16 a[104:105], v3 offset:6144
    ds_read_b64_tr_b16 a[106:107], v3 offset:6656
    v_and_b32 v15, s62, v207
    v_fma_f32 v14, v14, v10, v11
    v_fma_f32 v15, v15, v10, v11
    v_cvt_pk_bf16_f32 v207, v14, v15
    v_mfma_f32_32x32x16_bf16 a[48:63], a[116:119], v[200:203], a[48:63]
    ds_read_b64_tr_b16 a[108:109], v4 offset:6144
    ds_read_b64_tr_b16 a[110:111], v4 offset:6656
    v_lshlrev_b32 v12, 16, v208
    v_and_b32 v13, s62, v208
    v_fma_f32 v12, v12, v10, v11
    v_fma_f32 v13, v13, v10, v11
    s_waitcnt lgkmcnt(6)
    v_mfma_f32_32x32x16_bf16 a[64:79], a[120:123], v[200:203], a[64:79]
    ds_read_b64_tr_b16 a[112:113], v5 offset:6144
    ds_read_b64_tr_b16 a[114:115], v5 offset:6656
    v_cvt_pk_bf16_f32 v208, v12, v13
    v_lshlrev_b32 v14, 16, v209
    v_and_b32 v15, s62, v209
    v_mfma_f32_32x32x16_bf16 a[80:95], a[124:127], v[200:203], a[80:95]
    ds_read_b64_tr_b16 a[116:117], v6 offset:6144
    ds_read_b64_tr_b16 a[118:119], v6 offset:6656
    v_fma_f32 v14, v14, v10, v11
    v_fma_f32 v15, v15, v10, v11
    v_cvt_pk_bf16_f32 v209, v14, v15
    v_lshlrev_b32 v12, 16, v210
    v_mfma_f32_32x32x16_bf16 v[32:47], a[96:99], v[204:207], v[32:47]
    ds_read_b64_tr_b16 a[120:121], v7 offset:6144
    ds_read_b64_tr_b16 a[122:123], v7 offset:6656
    v_and_b32 v13, s62, v210
    v_fma_f32 v12, v12, v10, v11
    v_fma_f32 v13, v13, v10, v11
    v_cvt_pk_bf16_f32 v210, v12, v13
    s_waitcnt lgkmcnt(6)
    v_mfma_f32_32x32x16_bf16 v[48:63], a[100:103], v[204:207], v[48:63]
    ds_read_b64_tr_b16 a[124:125], v8 offset:6144
    ds_read_b64_tr_b16 a[126:127], v8 offset:6656
    v_lshlrev_b32 v14, 16, v211
    v_and_b32 v15, s62, v211
    v_fma_f32 v14, v14, v10, v11
    v_mfma_f32_32x32x16_bf16 a[0:15], a[104:107], v[204:207], a[0:15]
    s_waitcnt vmcnt(17)
    s_barrier
    ds_read_b64_tr_b16 a[96:97], v1 offset:8192
    ds_read_b64_tr_b16 a[98:99], v1 offset:8704
    s_waitcnt vmcnt(14)
    ds_read_b64_tr_b16 a[160:161], v26 offset:32768
    s_add_u32 m0, s61, 24576
    s_nop 0
    buffer_load_dwordx4 v16, s[12:15], s47 offen offset:0 lds
    v_mfma_f32_32x32x16_bf16 a[16:31], a[108:111], v[204:207], a[16:31]
    ds_read_b64_tr_b16 a[100:101], v2 offset:8192
    ds_read_b64_tr_b16 a[102:103], v2 offset:8704
    ds_read_b64_tr_b16 a[162:163], v26 offset:33792
    v_fma_f32 v15, v15, v10, v11
    v_cvt_pk_bf16_f32 v211, v14, v15
    v_lshlrev_b32 v12, 16, v212
    s_waitcnt lgkmcnt(8)
    v_mfma_f32_32x32x16_bf16 a[32:47], a[112:115], v[204:207], a[32:47]
    ds_read_b64_tr_b16 a[104:105], v3 offset:8192
    ds_read_b64_tr_b16 a[106:107], v3 offset:8704
    ds_read_b64_tr_b16 a[164:165], v27 offset:32768
    buffer_load_dwordx4 v17, s[12:15], s47 offen offset:1024 lds
    v_mfma_f32_32x32x16_bf16 a[48:63], a[116:119], v[204:207], a[48:63]
    ds_read_b64_tr_b16 a[108:109], v4 offset:8192
    ds_read_b64_tr_b16 a[110:111], v4 offset:8704
    ds_read_b64_tr_b16 a[166:167], v27 offset:33792
    v_and_b32 v13, s62, v212
    v_fma_f32 v12, v12, v10, v11
    v_fma_f32 v13, v13, v10, v11
    v_mfma_f32_32x32x16_bf16 a[64:79], a[120:123], v[204:207], a[64:79]
    ds_read_b64_tr_b16 a[112:113], v5 offset:8192
    s_waitcnt lgkmcnt(14)
    ds_read_b64_tr_b16 a[114:115], v5 offset:8704
    s_waitcnt vmcnt(14)
    buffer_load_dwordx4 v18, s[12:15], s47 offen offset:2048 lds
    v_cvt_pk_bf16_f32 v212, v12, v13
    v_lshlrev_b32 v14, 16, v213
    s_waitcnt lgkmcnt(9)
    v_mfma_f32_32x32x16_bf16 a[80:95], a[124:127], v[204:207], a[80:95]
    ds_read_b64_tr_b16 a[116:117], v6 offset:8192
    ds_read_b64_tr_b16 a[118:119], v6 offset:8704
    ds_read_b64_tr_b16 a[168:169], v26 offset:34816
    v_and_b32 v15, s62, v213
    v_fma_f32 v14, v14, v10, v11
    v_mfma_f32_32x32x16_bf16 v[32:47], a[96:99], v[208:211], v[32:47]
    ds_read_b64_tr_b16 a[120:121], v7 offset:8192
    ds_read_b64_tr_b16 a[122:123], v7 offset:8704
    ds_read_b64_tr_b16 a[170:171], v26 offset:35840
    buffer_load_dwordx4 v19, s[12:15], s47 offen offset:3072 lds
    v_fma_f32 v15, v15, v10, v11
    v_mfma_f32_32x32x16_bf16 v[48:63], a[100:103], v[208:211], v[48:63]
    s_waitcnt lgkmcnt(14)
    ds_read_b64_tr_b16 a[124:125], v8 offset:8192
    s_waitcnt lgkmcnt(14)
    ds_read_b64_tr_b16 a[126:127], v8 offset:8704
    s_add_u32 m0, s61, 28672
    s_add_u32 s47, s47, s50
    v_cvt_pk_bf16_f32 v213, v14, v15
    v_lshlrev_b32 v12, 16, v214
    s_waitcnt lgkmcnt(8)
    v_mfma_f32_32x32x16_bf16 a[0:15], a[104:107], v[208:211], a[0:15]
    ds_read_b64_tr_b16 a[96:97], v1 offset:10240
    ds_read_b64_tr_b16 a[98:99], v1 offset:10752
    ds_read_b64_tr_b16 a[172:173], v27 offset:34816
    buffer_load_dwordx4 v16, s[12:15], s47 offen offset:0 lds
    v_mfma_f32_32x32x16_bf16 a[16:31], a[108:111], v[208:211], a[16:31]
    ds_read_b64_tr_b16 a[100:101], v2 offset:10240
    ds_read_b64_tr_b16 a[102:103], v2 offset:10752
    ds_read_b64_tr_b16 a[174:175], v27 offset:35840
    v_and_b32 v13, s62, v214
    v_fma_f32 v12, v12, v10, v11
    v_fma_f32 v13, v13, v10, v11
    v_mfma_f32_32x32x16_bf16 a[32:47], a[112:115], v[208:211], a[32:47]
    ds_read_b64_tr_b16 a[104:105], v3 offset:10240
    s_waitcnt lgkmcnt(14)
    ds_read_b64_tr_b16 a[106:107], v3 offset:10752
    buffer_load_dwordx4 v17, s[12:15], s47 offen offset:1024 lds
    v_cvt_pk_bf16_f32 v214, v12, v13
    v_lshlrev_b32 v14, 16, v215
    s_waitcnt lgkmcnt(8)
    v_mfma_f32_32x32x16_bf16 a[48:63], a[116:119], v[208:211], a[48:63]
    ds_read_b64_tr_b16 a[108:109], v4 offset:10240
    ds_read_b64_tr_b16 a[110:111], v4 offset:10752
    v_and_b32 v15, s62, v215
    v_fma_f32 v14, v14, v10, v11
    v_fma_f32 v15, v15, v10, v11
    v_mfma_f32_32x32x16_bf16 a[64:79], a[120:123], v[208:211], a[64:79]
    ds_read_b64_tr_b16 a[112:113], v5 offset:10240
    ds_read_b64_tr_b16 a[114:115], v5 offset:10752
    buffer_load_dwordx4 v18, s[12:15], s47 offen offset:2048 lds
    v_cvt_pk_bf16_f32 v215, v14, v15
    v_lshlrev_b32 v12, 16, v216
    v_mfma_f32_32x32x16_bf16 a[80:95], a[124:127], v[208:211], a[80:95]
    ds_read_b64_tr_b16 a[116:117], v6 offset:10240
    ds_read_b64_tr_b16 a[118:119], v6 offset:10752
    v_and_b32 v13, s62, v216
    v_fma_f32 v12, v12, v10, v11
    v_fma_f32 v13, v13, v10, v11
    v_cvt_pk_bf16_f32 v216, v12, v13
    s_waitcnt lgkmcnt(6)
    v_mfma_f32_32x32x16_bf16 v[32:47], a[96:99], v[212:215], v[32:47]
    ds_read_b64_tr_b16 a[120:121], v7 offset:10240
    ds_read_b64_tr_b16 a[122:123], v7 offset:10752
    buffer_load_dwordx4 v19, s[12:15], s47 offen offset:3072 lds
    v_lshlrev_b32 v14, 16, v217
    v_mfma_f32_32x32x16_bf16 v[48:63], a[100:103], v[212:215], v[48:63]
    ds_read_b64_tr_b16 a[124:125], v8 offset:10240
    ds_read_b64_tr_b16 a[126:127], v8 offset:10752
    s_add_u32 m0, s61, 32768
    s_lshl_b32 s63, s77, 4
    s_add_u32 s63, s63, s53
    v_and_b32 v15, s62, v217
    v_mfma_f32_32x32x16_bf16 a[0:15], a[104:107], v[212:215], a[0:15]
    ds_read_b64_tr_b16 a[96:97], v1 offset:12288
    ds_read_b64_tr_b16 a[98:99], v1 offset:12800
    buffer_load_dwordx4 v24, s[20:23], s63 offen offset:0 lds
    v_fma_f32 v14, v14, v10, v11
    v_fma_f32 v15, v15, v10, v11
    s_waitcnt lgkmcnt(6)
    v_mfma_f32_32x32x16_bf16 a[16:31], a[108:111], v[212:215], a[16:31]
    ds_read_b64_tr_b16 a[100:101], v2 offset:12288
    ds_read_b64_tr_b16 a[102:103], v2 offset:12800
    v_cvt_pk_bf16_f32 v217, v14, v15
    v_lshlrev_b32 v12, 16, v218
    v_and_b32 v13, s62, v218
    v_mfma_f32_32x32x16_bf16 a[32:47], a[112:115], v[212:215], a[32:47]
    ds_read_b64_tr_b16 a[104:105], v3 offset:12288
    ds_read_b64_tr_b16 a[106:107], v3 offset:12800
    buffer_load_dwordx4 v25, s[20:23], s63 offen offset:1024 lds
    v_fma_f32 v12, v12, v10, v11
    v_fma_f32 v13, v13, v10, v11
    v_mfma_f32_32x32x16_bf16 a[48:63], a[116:119], v[212:215], a[48:63]
    ds_read_b64_tr_b16 a[108:109], v4 offset:12288
    ds_read_b64_tr_b16 a[110:111], v4 offset:12800
    s_add_u32 s63, s63, 14336
    v_cvt_pk_bf16_f32 v218, v12, v13
    v_lshlrev_b32 v14, 16, v219
    v_and_b32 v15, s62, v219
    s_waitcnt lgkmcnt(6)
    v_mfma_f32_32x32x16_bf16 a[64:79], a[120:123], v[212:215], a[64:79]
    ds_read_b64_tr_b16 a[112:113], v5 offset:12288
    ds_read_b64_tr_b16 a[114:115], v5 offset:12800
    buffer_load_dwordx4 v24, s[20:23], s63 offen offset:2048 lds
    v_fma_f32 v14, v14, v10, v11
    v_fma_f32 v15, v15, v10, v11
    v_cvt_pk_bf16_f32 v219, v14, v15
    v_mfma_f32_32x32x16_bf16 a[80:95], a[124:127], v[212:215], a[80:95]
    ds_read_b64_tr_b16 a[116:117], v6 offset:12288
    ds_read_b64_tr_b16 a[118:119], v6 offset:12800
    v_lshlrev_b32 v12, 16, v220
    v_and_b32 v13, s62, v220
    v_fma_f32 v12, v12, v10, v11
    v_fma_f32 v13, v13, v10, v11
    v_mfma_f32_32x32x16_bf16 v[32:47], a[96:99], v[216:219], v[32:47]
    ds_read_b64_tr_b16 a[120:121], v7 offset:12288
    ds_read_b64_tr_b16 a[122:123], v7 offset:12800
    buffer_load_dwordx4 v25, s[20:23], s63 offen offset:3072 lds
    v_cvt_pk_bf16_f32 v220, v12, v13
    v_lshlrev_b32 v14, 16, v221
    s_waitcnt lgkmcnt(6)
    v_mfma_f32_32x32x16_bf16 v[48:63], a[100:103], v[216:219], v[48:63]
    ds_read_b64_tr_b16 a[124:125], v8 offset:12288
    ds_read_b64_tr_b16 a[126:127], v8 offset:12800
    v_and_b32 v15, s62, v221
    v_fma_f32 v14, v14, v10, v11
    v_fma_f32 v15, v15, v10, v11
    v_mfma_f32_32x32x16_bf16 a[0:15], a[104:107], v[216:219], a[0:15]
    ds_read_b64_tr_b16 a[96:97], v1 offset:14336
    ds_read_b64_tr_b16 a[98:99], v1 offset:14848
    v_cvt_pk_bf16_f32 v221, v14, v15
    v_lshlrev_b32 v12, 16, v222
    v_and_b32 v13, s62, v222
    v_fma_f32 v12, v12, v10, v11
    v_mfma_f32_32x32x16_bf16 a[16:31], a[108:111], v[216:219], a[16:31]
    ds_read_b64_tr_b16 a[100:101], v2 offset:14336
    ds_read_b64_tr_b16 a[102:103], v2 offset:14848
    v_fma_f32 v13, v13, v10, v11
    v_cvt_pk_bf16_f32 v222, v12, v13
    v_lshlrev_b32 v14, 16, v223
    v_and_b32 v15, s62, v223
    s_waitcnt lgkmcnt(6)
    v_mfma_f32_32x32x16_bf16 a[32:47], a[112:115], v[216:219], a[32:47]
    ds_read_b64_tr_b16 a[104:105], v3 offset:14336
    ds_read_b64_tr_b16 a[106:107], v3 offset:14848
    v_fma_f32 v14, v14, v10, v11
    v_fma_f32 v15, v15, v10, v11
    v_cvt_pk_bf16_f32 v223, v14, v15
    v_mfma_f32_32x32x16_bf16 a[48:63], a[116:119], v[216:219], a[48:63]
    ds_read_b64_tr_b16 a[108:109], v4 offset:14336
    ds_read_b64_tr_b16 a[110:111], v4 offset:14848
    v_lshlrev_b32 v12, 16, v224
    v_and_b32 v13, s62, v224
    v_fma_f32 v12, v12, v10, v11
    v_fma_f32 v13, v13, v10, v11
    v_mfma_f32_32x32x16_bf16 a[64:79], a[120:123], v[216:219], a[64:79]
    ds_read_b64_tr_b16 a[112:113], v5 offset:14336
    ds_read_b64_tr_b16 a[114:115], v5 offset:14848
    v_cvt_pk_bf16_f32 v224, v12, v13
    v_lshlrev_b32 v14, 16, v225
    v_and_b32 v15, s62, v225
    v_fma_f32 v14, v14, v10, v11
    s_waitcnt lgkmcnt(6)
    v_mfma_f32_32x32x16_bf16 a[80:95], a[124:127], v[216:219], a[80:95]
    ds_read_b64_tr_b16 a[116:117], v6 offset:14336
    ds_read_b64_tr_b16 a[118:119], v6 offset:14848
    v_fma_f32 v15, v15, v10, v11
    v_cvt_pk_bf16_f32 v225, v14, v15
    v_lshlrev_b32 v12, 16, v226
    v_mfma_f32_32x32x16_bf16 v[32:47], a[96:99], v[220:223], v[32:47]
    ds_read_b64_tr_b16 a[120:121], v7 offset:14336
    ds_read_b64_tr_b16 a[122:123], v7 offset:14848
    v_and_b32 v13, s62, v226
    v_fma_f32 v12, v12, v10, v11
    v_fma_f32 v13, v13, v10, v11
    v_cvt_pk_bf16_f32 v226, v12, v13
    v_mfma_f32_32x32x16_bf16 v[48:63], a[100:103], v[220:223], v[48:63]
    ds_read_b64_tr_b16 a[124:125], v8 offset:14336
    ds_read_b64_tr_b16 a[126:127], v8 offset:14848
    v_lshlrev_b32 v14, 16, v227
    v_and_b32 v15, s62, v227
    v_fma_f32 v14, v14, v10, v11
    v_fma_f32 v15, v15, v10, v11
    s_waitcnt lgkmcnt(6)
    v_mfma_f32_32x32x16_bf16 a[0:15], a[104:107], v[220:223], a[0:15]
    s_waitcnt vmcnt(16)
    s_barrier
    ds_read_b64_tr_b16 a[96:97], v1 offset:16384
    ds_read_b64_tr_b16 a[98:99], v1 offset:16896
    s_waitcnt vmcnt(14)
    ds_read_b64_tr_b16 a[176:177], v26 offset:36864
    v_mfma_f32_32x32x16_bf16 a[16:31], a[108:111], v[220:223], a[16:31]
    ds_read_b64_tr_b16 a[100:101], v2 offset:16384
    ds_read_b64_tr_b16 a[102:103], v2 offset:16896
    ds_read_b64_tr_b16 a[178:179], v26 offset:37888
    s_add_u32 m0, s61, 0
    s_nop 0
    buffer_load_dwordx4 v16, s[12:15], s48 offen offset:0 lds
    v_mfma_f32_32x32x16_bf16 a[32:47], a[112:115], v[220:223], a[32:47]
    ds_read_b64_tr_b16 a[104:105], v3 offset:16384
    ds_read_b64_tr_b16 a[106:107], v3 offset:16896
    ds_read_b64_tr_b16 a[180:181], v27 offset:36864
    v_cvt_pk_bf16_f32 v227, v14, v15
    v_readfirstlane_b32 s2, v30
    s_cmp_lg_u32 s2, 0
    s_cbranch_scc0 L_dbgspinB
L_dbgokB:
    s_waitcnt lgkmcnt(9)
    v_mfma_f32_32x32x16_bf16 a[48:63], a[116:119], v[220:223], a[48:63]
    ds_read_b64_tr_b16 a[108:109], v4 offset:16384
    ds_read_b64_tr_b16 a[110:111], v4 offset:16896
    ds_read_b64_tr_b16 a[182:183], v27 offset:37888
    buffer_load_dwordx4 v17, s[12:15], s48 offen offset:1024 lds
    v_mfma_f32_32x32x16_bf16 a[64:79], a[120:123], v[220:223], a[64:79]
    ds_read_b64_tr_b16 a[112:113], v5 offset:16384
    ds_read_b64_tr_b16 a[114:115], v5 offset:16896
    s_waitcnt vmcnt(14)
    ds_read_b64_tr_b16 a[184:185], v26 offset:38912
    v_lshlrev_b32 v12, 16, v228
    v_and_b32 v13, s62, v228
    v_fma_f32 v12, v12, v10, v11
    v_mfma_f32_32x32x16_bf16 a[80:95], a[124:127], v[220:223], a[80:95]
    s_waitcnt lgkmcnt(14)
    ds_read_b64_tr_b16 a[116:117], v6 offset:16384
    s_waitcnt lgkmcnt(14)
    ds_read_b64_tr_b16 a[118:119], v6 offset:16896
    buffer_load_dwordx4 v18, s[12:15], s48 offen offset:2048 lds
    v_fma_f32 v13, v13, v10, v11
    v_cvt_pk_bf16_f32 v228, v12, v13
    s_waitcnt lgkmcnt(9)
    v_mfma_f32_32x32x16_bf16 v[32:47], a[96:99], v[224:227], v[32:47]
    ds_read_b64_tr_b16 a[120:121], v7 offset:16384
    ds_read_b64_tr_b16 a[122:123], v7 offset:16896
    ds_read_b64_tr_b16 a[186:187], v26 offset:39936
    v_lshlrev_b32 v14, 16, v229
    v_and_b32 v15, s62, v229
    v_mfma_f32_32x32x16_bf16 v[48:63], a[100:103], v[224:227], v[48:63]
    ds_read_b64_tr_b16 a[124:125], v8 offset:16384
    ds_read_b64_tr_b16 a[126:127], v8 offset:16896
    ds_read_b64_tr_b16 a[188:189], v27 offset:38912
    buffer_load_dwordx4 v19, s[12:15], s48 offen offset:3072 lds
    v_fma_f32 v14, v14, v10, v11
    v_mfma_f32_32x32x16_bf16 a[0:15], a[104:107], v[224:227], a[0:15]
    s_waitcnt lgkmcnt(14)
    ds_read_b64_tr_b16 a[96:97], v1 offset:18432
    s_waitcnt lgkmcnt(14)
    ds_read_b64_tr_b16 a[98:99], v1 offset:18944
    s_add_u32 m0, s61, 4096
    s_add_u32 s48, s48, s50
    v_fma_f32 v15, v15, v10, v11
    v_cvt_pk_bf16_f32 v229, v14, v15
    s_waitcnt lgkmcnt(8)
    v_mfma_f32_32x32x16_bf16 a[16:31], a[108:111], v[224:227], a[16:31]
    ds_read_b64_tr_b16 a[100:101], v2 offset:18432
    ds_read_b64_tr_b16 a[102:103], v2 offset:18944
    ds_read_b64_tr_b16 a[190:191], v27 offset:39936
    buffer_load_dwordx4 v16, s[12:15], s48 offen offset:0 lds
    v_mfma_f32_32x32x16_bf16 a[32:47], a[112:115], v[224:227], a[32:47]
    ds_read_b64_tr_b16 a[104:105], v3 offset:18432
    ds_read_b64_tr_b16 a[106:107], v3 offset:18944
    v_lshlrev_b32 v12, 16, v230
    v_and_b32 v13, s62, v230
    v_fma_f32 v12, v12, v10, v11
    v_fma_f32 v13, v13, v10, v11
    v_mfma_f32_32x32x16_bf16 a[48:63], a[116:119], v[224:227], a[48:63]
    ds_read_b64_tr_b16 a[108:109], v4 offset:18432
    ds_read_b64_tr_b16 a[110:111], v4 offset:18944
    buffer_load_dwordx4 v17, s[12:15], s48 offen offset:1024 lds
    v_cvt_pk_bf16_f32 v230, v12, v13
    v_lshlrev_b32 v14, 16, v231
    s_waitcnt lgkmcnt(7)
    v_mfma_f32_32x32x16_bf16 a[64:79], a[120:123], v[224:227], a[64:79]
    ds_read_b64_tr_b16 a[112:113], v5 offset:18432
    ds_read_b64_tr_b16 a[114:115], v5 offset:18944
    v_and_b32 v15, s62, v231
    v_fma_f32 v14, v14, v10, v11
    v_fma_f32 v15, v15, v10, v11
    v_cvt_pk_bf16_f32 v231, v14, v15
    v_mfma_f32_32x32x16_bf16 a[80:95], a[124:127], v[224:227], a[80:95]
    ds_read_b64_tr_b16 a[116:117], v6 offset:18432
    ds_read_b64_tr_b16 a[118:119], v6 offset:18944
    buffer_load_dwordx4 v18, s[12:15], s48 offen offset:2048 lds
    v_lshlrev_b32 v12, 16, v232
    v_and_b32 v13, s62, v232
    v_mfma_f32_32x32x16_bf16 v[32:47], a[96:99], v[228:231], v[32:47]
    ds_read_b64_tr_b16 a[120:121], v7 offset:18432
    ds_read_b64_tr_b16 a[122:123], v7 offset:18944
    v_fma_f32 v12, v12, v10, v11
    v_fma_f32 v13, v13, v10, v11
    v_cvt_pk_bf16_f32 v232, v12, v13
    v_lshlrev_b32 v14, 16, v233
    s_waitcnt lgkmcnt(6)
    v_mfma_f32_32x32x16_bf16 v[48:63], a[100:103], v[228:231], v[48:63]
    ds_read_b64_tr_b16 a[124:125], v8 offset:18432
    ds_read_b64_tr_b16 a[126:127], v8 offset:18944
    buffer_load_dwordx4 v19, s[12:15], s48 offen offset:3072 lds
    v_and_b32 v15, s62, v233
    v_mfma_f32_32x32x16_bf16 a[0:15], a[104:107], v[228:231], a[0:15]
    ds_read_b64_tr_b16 a[96:97], v1 offset:20480
    ds_read_b64_tr_b16 a[98:99], v1 offset:20992
    s_add_u32 m0, s61, 36864
    s_lshl_b32 s63, s77, 4
    s_add_u32 s63, s63, s53
    s_add_u32 s63, s63, 32768
    v_mfma_f32_32x32x16_bf16 a[16:31], a[108:111], v[228:231], a[16:31]
    ds_read_b64_tr_b16 a[100:101], v2 offset:20480
    ds_read_b64_tr_b16 a[102:103], v2 offset:20992
    buffer_load_dwordx4 v24, s[20:23], s63 offen offset:0 lds
    v_fma_f32 v14, v14, v10, v11
    v_fma_f32 v15, v15, v10, v11
    s_waitcnt lgkmcnt(6)
    v_mfma_f32_32x32x16_bf16 a[32:47], a[112:115], v[228:231], a[32:47]
    ds_read_b64_tr_b16 a[104:105], v3 offset:20480
    ds_read_b64_tr_b16 a[106:107], v3 offset:20992
    v_cvt_pk_bf16_f32 v233, v14, v15
    v_lshlrev_b32 v12, 16, v234
    v_and_b32 v13, s62, v234
    v_mfma_f32_32x32x16_bf16 a[48:63], a[116:119], v[228:231], a[48:63]
    ds_read_b64_tr_b16 a[108:109], v4 offset:20480
    ds_read_b64_tr_b16 a[110:111], v4 offset:20992
    buffer_load_dwordx4 v25, s[20:23], s63 offen offset:1024 lds
    v_fma_f32 v12, v12, v10, v11
    v_fma_f32 v13, v13, v10, v11
    v_mfma_f32_32x32x16_bf16 a[64:79], a[120:123], v[228:231], a[64:79]
    ds_read_b64_tr_b16 a[112:113], v5 offset:20480
    ds_read_b64_tr_b16 a[114:115], v5 offset:20992
    s_add_u32 s63, s63, 14336
    v_cvt_pk_bf16_f32 v234, v12, v13
    v_lshlrev_b32 v14, 16, v235
    v_and_b32 v15, s62, v235
    v_fma_f32 v14, v14, v10, v11
    v_fma_f32 v15, v15, v10, v11
    v_cvt_pk_bf16_f32 v235, v14, v15
    s_waitcnt lgkmcnt(6)
    v_mfma_f32_32x32x16_bf16 a[80:95], a[124:127], v[228:231], a[80:95]
    ds_read_b64_tr_b16 a[116:117], v6 offset:20480
    ds_read_b64_tr_b16 a[118:119], v6 offset:20992
    buffer_load_dwordx4 v24, s[20:23], s63 offen offset:2048 lds
    v_lshlrev_b32 v12, 16, v236
    v_mfma_f32_32x32x16_bf16 v[32:47], a[96:99], v[232:235], v[32:47]
    ds_read_b64_tr_b16 a[120:121], v7 offset:20480
    ds_read_b64_tr_b16 a[122:123], v7 offset:20992
    v_and_b32 v13, s62, v236
    v_fma_f32 v12, v12, v10, v11
    v_fma_f32 v13, v13, v10, v11
    v_cvt_pk_bf16_f32 v236, v12, v13
    v_mfma_f32_32x32x16_bf16 v[48:63], a[100:103], v[232:235], v[48:63]
    ds_read_b64_tr_b16 a[124:125], v8 offset:20480
    ds_read_b64_tr_b16 a[126:127], v8 offset:20992
    buffer_load_dwordx4 v25, s[20:23], s63 offen offset:3072 lds
    v_lshlrev_b32 v14, 16, v237
    v_and_b32 v15, s62, v237
    s_waitcnt lgkmcnt(6)
    v_mfma_f32_32x32x16_bf16 a[0:15], a[104:107], v[232:235], a[0:15]
    ds_read_b64_tr_b16 a[96:97], v1 offset:22528
    ds_read_b64_tr_b16 a[98:99], v1 offset:23040
    v_fma_f32 v14, v14, v10, v11
    v_fma_f32 v15, v15, v10, v11
    v_cvt_pk_bf16_f32 v237, v14, v15
    v_mfma_f32_32x32x16_bf16 a[16:31], a[108:111], v[232:235], a[16:31]
    ds_read_b64_tr_b16 a[100:101], v2 offset:22528
    ds_read_b64_tr_b16 a[102:103], v2 offset:23040
    v_lshlrev_b32 v12, 16, v238
    v_and_b32 v13, s62, v238
    v_fma_f32 v12, v12, v10, v11
    v_fma_f32 v13, v13, v10, v11
    v_mfma_f32_32x32x16_bf16 a[32:47], a[112:115], v[232:235], a[32:47]
    ds_read_b64_tr_b16 a[104:105], v3 offset:22528
    ds_read_b64_tr_b16 a[106:107], v3 offset:23040
    v_cvt_pk_bf16_f32 v238, v12, v13
    v_lshlrev_b32 v14, 16, v239
    v_and_b32 v15, s62, v239
    v_fma_f32 v14, v14, v10, v11
    s_waitcnt lgkmcnt(6)
    v_mfma_f32_32x32x16_bf16 a[48:63], a[116:119], v[232:235], a[48:63]
    ds_read_b64_tr_b16 a[108:109], v4 offset:22528
    ds_read_b64_tr_b16 a[110:111], v4 offset:23040
    v_fma_f32 v15, v15, v10, v11
    v_cvt_pk_bf16_f32 v239, v14, v15
    v_lshlrev_b32 v12, 16, v240
    v_mfma_f32_32x32x16_bf16 a[64:79], a[120:123], v[232:235], a[64:79]
    ds_read_b64_tr_b16 a[112:113], v5 offset:22528
    ds_read_b64_tr_b16 a[114:115], v5 offset:23040
    v_and_b32 v13, s62, v240
    v_fma_f32 v12, v12, v10, v11
    v_fma_f32 v13, v13, v10, v11
    v_cvt_pk_bf16_f32 v240, v12, v13
    v_mfma_f32_32x32x16_bf16 a[80:95], a[124:127], v[232:235], a[80:95]
    ds_read_b64_tr_b16 a[116:117], v6 offset:22528
    ds_read_b64_tr_b16 a[118:119], v6 offset:23040
    v_lshlrev_b32 v14, 16, v241
    v_and_b32 v15, s62, v241
    v_fma_f32 v14, v14, v10, v11
    v_fma_f32 v15, v15, v10, v11
    s_waitcnt lgkmcnt(6)
    v_mfma_f32_32x32x16_bf16 v[32:47], a[96:99], v[236:239], v[32:47]
    ds_read_b64_tr_b16 a[120:121], v7 offset:22528
    ds_read_b64_tr_b16 a[122:123], v7 offset:23040
    v_cvt_pk_bf16_f32 v241, v14, v15
    v_lshlrev_b32 v12, 16, v242
    v_and_b32 v13, s62, v242
    v_mfma_f32_32x32x16_bf16 v[48:63], a[100:103], v[236:239], v[48:63]
    ds_read_b64_tr_b16 a[124:125], v8 offset:22528
    ds_read_b64_tr_b16 a[126:127], v8 offset:23040
    v_fma_f32 v12, v12, v10, v11
    v_fma_f32 v13, v13, v10, v11
    v_cvt_pk_bf16_f32 v242, v12, v13
    v_lshlrev_b32 v14, 16, v243
    v_mfma_f32_32x32x16_bf16 a[0:15], a[104:107], v[236:239], a[0:15]
    s_waitcnt vmcnt(16)
    s_barrier
    ds_read_b64_tr_b16 a[96:97], v1 offset:24576
    ds_read_b64_tr_b16 a[98:99], v1 offset:25088
    s_waitcnt vmcnt(14)
    ds_read_b64_tr_b16 a[192:193], v26 offset:32768
    s_add_u32 m0, s61, 8192
    s_nop 0
    buffer_load_dwordx4 v16, s[12:15], s49 offen offset:0 lds
    s_waitcnt lgkmcnt(7)
    v_mfma_f32_32x32x16_bf16 a[16:31], a[108:111], v[236:239], a[16:31]
    ds_read_b64_tr_b16 a[100:101], v2 offset:24576
    ds_read_b64_tr_b16 a[102:103], v2 offset:25088
    ds_read_b64_tr_b16 a[194:195], v26 offset:33792
    v_and_b32 v15, s62, v243
    v_fma_f32 v14, v14, v10, v11
    v_mfma_f32_32x32x16_bf16 a[32:47], a[112:115], v[236:239], a[32:47]
    ds_read_b64_tr_b16 a[104:105], v3 offset:24576
    ds_read_b64_tr_b16 a[106:107], v3 offset:25088
    ds_read_b64_tr_b16 a[196:197], v27 offset:32768
    buffer_load_dwordx4 v17, s[12:15], s49 offen offset:1024 lds
    v_fma_f32 v15, v15, v10, v11
    v_mfma_f32_32x32x16_bf16 a[48:63], a[116:119], v[236:239], a[48:63]
    ds_read_b64_tr_b16 a[108:109], v4 offset:24576
    ds_read_b64_tr_b16 a[110:111], v4 offset:25088
    v_cvt_pk_bf16_f32 v243, v14, v15
    v_lshlrev_b32 v12, 16, v244
    v_and_b32 v13, s62, v244
    v_fma_f32 v12, v12, v10, v11
    s_waitcnt lgkmcnt(9)
    v_mfma_f32_32x32x16_bf16 a[64:79], a[120:123], v[236:239], a[64:79]
    ds_read_b64_tr_b16 a[112:113], v5 offset:24576
    ds_read_b64_tr_b16 a[114:115], v5 offset:25088
    ds_read_b64_tr_b16 a[198:199], v27 offset:33792
    buffer_load_dwordx4 v18, s[12:15], s49 offen offset:2048 lds
    v_mfma_f32_32x32x16_bf16 a[80:95], a[124:127], v[236:239], a[80:95]
    ds_read_b64_tr_b16 a[116:117], v6 offset:24576
    ds_read_b64_tr_b16 a[118:119], v6 offset:25088
    s_waitcnt vmcnt(15)
    ds_read_b64_tr_b16 a[200:201], v26 offset:34816
    v_fma_f32 v13, v13, v10, v11
    v_cvt_pk_bf16_f32 v244, v12, v13
    v_lshlrev_b32 v14, 16, v245
    v_mfma_f32_32x32x16_bf16 v[32:47], a[96:99], v[240:243], v[32:47]
    s_waitcnt lgkmcnt(14)
    ds_read_b64_tr_b16 a[120:121], v7 offset:24576
    s_waitcnt lgkmcnt(14)
    ds_read_b64_tr_b16 a[122:123], v7 offset:25088
    buffer_load_dwordx4 v19, s[12:15], s49 offen offset:3072 lds
    v_and_b32 v15, s62, v245
    v_fma_f32 v14, v14, v10, v11
    s_waitcnt lgkmcnt(8)
    v_mfma_f32_32x32x16_bf16 v[48:63], a[100:103], v[240:243], v[48:63]
    ds_read_b64_tr_b16 a[124:125], v8 offset:24576
    ds_read_b64_tr_b16 a[126:127], v8 offset:25088
    ds_read_b64_tr_b16 a[202:203], v26 offset:35840
    s_add_u32 m0, s61, 12288
    s_add_u32 s49, s49, s50
    v_mfma_f32_32x32x16_bf16 a[0:15], a[104:107], v[240:243], a[0:15]
    ds_read_b64_tr_b16 a[96:97], v1 offset:26624
    ds_read_b64_tr_b16 a[98:99], v1 offset:27136
    ds_read_b64_tr_b16 a[204:205], v27 offset:34816
    buffer_load_dwordx4 v16, s[12:15], s49 offen offset:0 lds
    v_fma_f32 v15, v15, v10, v11
    v_mfma_f32_32x32x16_bf16 a[16:31], a[108:111], v[240:243], a[16:31]
    ds_read_b64_tr_b16 a[100:101], v2 offset:26624
    s_waitcnt lgkmcnt(14)
    ds_read_b64_tr_b16 a[102:103], v2 offset:27136
    v_cvt_pk_bf16_f32 v245, v14, v15
    v_lshlrev_b32 v12, 16, v246
    v_and_b32 v13, s62, v246
    v_fma_f32 v12, v12, v10, v11
    s_waitcnt lgkmcnt(8)
    v_mfma_f32_32x32x16_bf16 a[32:47], a[112:115], v[240:243], a[32:47]
    ds_read_b64_tr_b16 a[104:105], v3 offset:26624
    ds_read_b64_tr_b16 a[106:107], v3 offset:27136
    ds_read_b64_tr_b16 a[206:207], v27 offset:35840
    buffer_load_dwordx4 v17, s[12:15], s49 offen offset:1024 lds
    v_mfma_f32_32x32x16_bf16 a[48:63], a[116:119], v[240:243], a[48:63]
    ds_read_b64_tr_b16 a[108:109], v4 offset:26624
    ds_read_b64_tr_b16 a[110:111], v4 offset:27136
    v_fma_f32 v13, v13, v10, v11
    v_cvt_pk_bf16_f32 v246, v12, v13
    v_lshlrev_b32 v14, 16, v247
    v_and_b32 v15, s62, v247
    v_mfma_f32_32x32x16_bf16 a[64:79], a[120:123], v[240:243], a[64:79]
    ds_read_b64_tr_b16 a[112:113], v5 offset:26624
    ds_read_b64_tr_b16 a[114:115], v5 offset:27136
    buffer_load_dwordx4 v18, s[12:15], s49 offen offset:2048 lds
    v_fma_f32 v14, v14, v10, v11
    v_fma_f32 v15, v15, v10, v11
    v_cvt_pk_bf16_f32 v247, v14, v15
    s_waitcnt lgkmcnt(7)
    v_mfma_f32_32x32x16_bf16 a[80:95], a[124:127], v[240:243], a[80:95]
    ds_read_b64_tr_b16 a[116:117], v6 offset:26624
    ds_read_b64_tr_b16 a[118:119], v6 offset:27136
    v_lshlrev_b32 v12, 16, v248
    v_and_b32 v13, s62, v248
    v_fma_f32 v12, v12, v10, v11
    v_mfma_f32_32x32x16_bf16 v[32:47], a[96:99], v[244:247], v[32:47]
    ds_read_b64_tr_b16 a[120:121], v7 offset:26624
    ds_read_b64_tr_b16 a[122:123], v7 offset:27136
    buffer_load_dwordx4 v19, s[12:15], s49 offen offset:3072 lds
    v_fma_f32 v13, v13, v10, v11
    v_cvt_pk_bf16_f32 v248, v12, v13
    v_mfma_f32_32x32x16_bf16 v[48:63], a[100:103], v[244:247], v[48:63]
    ds_read_b64_tr_b16 a[124:125], v8 offset:26624
    ds_read_b64_tr_b16 a[126:127], v8 offset:27136
    s_waitcnt lgkmcnt(10)
    s_add_u32 m0, s61, 32768
    s_lshl_b32 s63, s78, 4
    s_add_u32 s63, s63, s53
    s_waitcnt lgkmcnt(6)
    v_mfma_f32_32x32x16_bf16 a[0:15], a[104:107], v[244:247], a[0:15]
    ds_read_b64_tr_b16 a[96:97], v1 offset:28672
    ds_read_b64_tr_b16 a[98:99], v1 offset:29184
    buffer_load_dwordx4 v24, s[20:23], s63 offen offset:0 lds
    v_lshlrev_b32 v14, 16, v249
    v_mfma_f32_32x32x16_bf16 a[16:31], a[108:111], v[244:247], a[16:31]
    ds_read_b64_tr_b16 a[100:101], v2 offset:28672
    ds_read_b64_tr_b16 a[102:103], v2 offset:29184
    v_and_b32 v15, s62, v249
    v_fma_f32 v14, v14, v10, v11
    v_fma_f32 v15, v15, v10, v11
    v_cvt_pk_bf16_f32 v249, v14, v15
    v_mfma_f32_32x32x16_bf16 a[32:47], a[112:115], v[244:247], a[32:47]
    ds_read_b64_tr_b16 a[104:105], v3 offset:28672
    ds_read_b64_tr_b16 a[106:107], v3 offset:29184
    buffer_load_dwordx4 v25, s[20:23], s63 offen offset:1024 lds
    v_lshlrev_b32 v12, 16, v250
    v_and_b32 v13, s62, v250
    s_waitcnt lgkmcnt(6)
    v_mfma_f32_32x32x16_bf16 a[48:63], a[116:119], v[244:247], a[48:63]
    ds_read_b64_tr_b16 a[108:109], v4 offset:28672
    ds_read_b64_tr_b16 a[110:111], v4 offset:29184
    s_add_u32 s63, s63, 14336
    v_fma_f32 v12, v12, v10, v11
    v_fma_f32 v13, v13, v10, v11
    v_mfma_f32_32x32x16_bf16 a[64:79], a[120:123], v[244:247], a[64:79]
    ds_read_b64_tr_b16 a[112:113], v5 offset:28672
    ds_read_b64_tr_b16 a[114:115], v5 offset:29184
    buffer_load_dwordx4 v24, s[20:23], s63 offen offset:2048 lds
    v_cvt_pk_bf16_f32 v250, v12, v13
    v_lshlrev_b32 v14, 16, v251
    v_and_b32 v15, s62, v251
    v_fma_f32 v14, v14, v10, v11
    v_fma_f32 v15, v15, v10, v11
    v_cvt_pk_bf16_f32 v251, v14, v15
    v_mfma_f32_32x32x16_bf16 a[80:95], a[124:127], v[244:247], a[80:95]
    ds_read_b64_tr_b16 a[116:117], v6 offset:28672
    ds_read_b64_tr_b16 a[118:119], v6 offset:29184
    v_lshlrev_b32 v12, 16, v252
    v_and_b32 v13, s62, v252
    v_fma_f32 v12, v12, v10, v11
    v_fma_f32 v13, v13, v10, v11
    s_waitcnt lgkmcnt(6)
    v_mfma_f32_32x32x16_bf16 v[32:47], a[96:99], v[248:251], v[32:47]
    ds_read_b64_tr_b16 a[120:121], v7 offset:28672
    ds_read_b64_tr_b16 a[122:123], v7 offset:29184
    buffer_load_dwordx4 v25, s[20:23], s63 offen offset:3072 lds
    v_cvt_pk_bf16_f32 v252, v12, v13
    v_mfma_f32_32x32x16_bf16 v[48:63], a[100:103], v[248:251], v[48:63]
    ds_read_b64_tr_b16 a[124:125], v8 offset:28672
    ds_read_b64_tr_b16 a[126:127], v8 offset:29184
    v_lshlrev_b32 v14, 16, v253
    v_and_b32 v15, s62, v253
    v_fma_f32 v14, v14, v10, v11
    v_fma_f32 v15, v15, v10, v11
    v_mfma_f32_32x32x16_bf16 a[0:15], a[104:107], v[248:251], a[0:15]
    ds_read_b64_tr_b16 a[96:97], v1 offset:30720
    ds_read_b64_tr_b16 a[98:99], v1 offset:31232
    v_cvt_pk_bf16_f32 v253, v14, v15
    v_lshlrev_b32 v12, 16, v254
    v_and_b32 v13, s62, v254
    v_fma_f32 v12, v12, v10, v11
    s_waitcnt lgkmcnt(6)
    v_mfma_f32_32x32x16_bf16 a[16:31], a[108:111], v[248:251], a[16:31]
    ds_read_b64_tr_b16 a[100:101], v2 offset:30720
    ds_read_b64_tr_b16 a[102:103], v2 offset:31232
    v_fma_f32 v13, v13, v10, v11
    v_cvt_pk_bf16_f32 v254, v12, v13
    v_lshlrev_b32 v14, 16, v255
    v_mfma_f32_32x32x16_bf16 a[32:47], a[112:115], v[248:251], a[32:47]
    ds_read_b64_tr_b16 a[104:105], v3 offset:30720
    ds_read_b64_tr_b16 a[106:107], v3 offset:31232
    v_and_b32 v15, s62, v255
    v_fma_f32 v14, v14, v10, v11
    v_fma_f32 v15, v15, v10, v11
    v_cvt_pk_bf16_f32 v255, v14, v15
    v_mfma_f32_32x32x16_bf16 a[48:63], a[116:119], v[248:251], a[48:63]
    ds_read_b64_tr_b16 a[108:109], v4 offset:30720
    ds_read_b64_tr_b16 a[110:111], v4 offset:31232
    s_waitcnt lgkmcnt(6)
    v_mfma_f32_32x32x16_bf16 a[64:79], a[120:123], v[248:251], a[64:79]
    ds_read_b64_tr_b16 a[112:113], v5 offset:30720
    ds_read_b64_tr_b16 a[114:115], v5 offset:31232
    v_mfma_f32_32x32x16_bf16 a[80:95], a[124:127], v[248:251], a[80:95]
    ds_read_b64_tr_b16 a[116:117], v6 offset:30720
    ds_read_b64_tr_b16 a[118:119], v6 offset:31232
    v_mfma_f32_32x32x16_bf16 v[32:47], a[96:99], v[252:255], v[32:47]
    ds_read_b64_tr_b16 a[120:121], v7 offset:30720
    ds_read_b64_tr_b16 a[122:123], v7 offset:31232
    s_waitcnt lgkmcnt(6)
    v_mfma_f32_32x32x16_bf16 v[48:63], a[100:103], v[252:255], v[48:63]
    ds_read_b64_tr_b16 a[124:125], v8 offset:30720
    ds_read_b64_tr_b16 a[126:127], v8 offset:31232
    v_mfma_f32_32x32x16_bf16 a[0:15], a[104:107], v[252:255], a[0:15]
    s_waitcnt vmcnt(16)
    s_barrier
    ds_read_b64_tr_b16 a[96:97], v1 offset:0
    ds_read_b64_tr_b16 a[98:99], v1 offset:512
    s_waitcnt vmcnt(14)
    ds_read_b64_tr_b16 a[208:209], v26 offset:36864
    s_add_u32 m0, s61, 16384
    s_nop 0
    buffer_load_dwordx4 v16, s[12:15], s80 offen offset:0 lds
    v_mfma_f32_32x32x16_bf16 a[16:31], a[108:111], v[252:255], a[16:31]
    ds_read_b64_tr_b16 a[100:101], v2 offset:0
    ds_read_b64_tr_b16 a[102:103], v2 offset:512
    ds_read_b64_tr_b16 a[210:211], v26 offset:37888
    s_waitcnt lgkmcnt(8)
    v_mfma_f32_32x32x16_bf16 a[32:47], a[112:115], v[252:255], a[32:47]
    ds_read_b64_tr_b16 a[104:105], v3 offset:0
    ds_read_b64_tr_b16 a[106:107], v3 offset:512
    ds_read_b64_tr_b16 a[212:213], v27 offset:36864
    buffer_load_dwordx4 v17, s[12:15], s80 offen offset:1024 lds
    v_mfma_f32_32x32x16_bf16 a[48:63], a[116:119], v[252:255], a[48:63]
    ds_read_b64_tr_b16 a[108:109], v4 offset:0
    ds_read_b64_tr_b16 a[110:111], v4 offset:512
    ds_read_b64_tr_b16 a[214:215], v27 offset:37888
    v_mfma_f32_32x32x16_bf16 a[64:79], a[120:123], v[252:255], a[64:79]
    ds_read_b64_tr_b16 a[112:113], v1 offset:2048
    s_waitcnt lgkmcnt(14)
    ds_read_b64_tr_b16 a[114:115], v1 offset:2560
    s_waitcnt vmcnt(14)
    buffer_load_dwordx4 v18, s[12:15], s80 offen offset:2048 lds
    s_waitcnt lgkmcnt(9)
    v_mfma_f32_32x32x16_bf16 a[80:95], a[124:127], v[252:255], a[80:95]
    ds_read_b64_tr_b16 a[116:117], v2 offset:2048
    ds_read_b64_tr_b16 a[118:119], v2 offset:2560
    ds_read_b64_tr_b16 a[216:217], v26 offset:38912
    v_mfma_f32_32x32x16_bf16 v[64:79], a[96:99], v[128:131], 0
    ds_read_b64_tr_b16 a[120:121], v3 offset:2048
    ds_read_b64_tr_b16 a[122:123], v3 offset:2560
    ds_read_b64_tr_b16 a[218:219], v26 offset:39936
    buffer_load_dwordx4 v19, s[12:15], s80 offen offset:3072 lds
    v_mfma_f32_32x32x16_bf16 v[80:95], a[100:103], v[128:131], 0
    s_waitcnt lgkmcnt(14)
    ds_read_b64_tr_b16 a[124:125], v4 offset:2048
    s_waitcnt lgkmcnt(14)
    ds_read_b64_tr_b16 a[126:127], v4 offset:2560
    s_add_u32 m0, s61, 20480
    s_add_u32 s80, s80, s50
    s_waitcnt lgkmcnt(8)
    v_mfma_f32_32x32x16_bf16 v[96:111], a[104:107], v[128:131], 0
    ds_read_b64_tr_b16 a[96:97], v1 offset:4096
    ds_read_b64_tr_b16 a[98:99], v1 offset:4608
    ds_read_b64_tr_b16 a[220:221], v27 offset:38912
    buffer_load_dwordx4 v16, s[12:15], s80 offen offset:0 lds
    v_max_f32 v32, 0, v32
    v_max_f32 v33, 0, v33
    v_max_f32 v34, 0, v34
    v_max_f32 v35, 0, v35
    v_mfma_f32_32x32x16_bf16 v[112:127], a[108:111], v[128:131], 0
    ds_read_b64_tr_b16 a[100:101], v2 offset:4096
    ds_read_b64_tr_b16 a[102:103], v2 offset:4608
    ds_read_b64_tr_b16 a[222:223], v27 offset:39936
    v_max_f32 v36, 0, v36
    v_max_f32 v37, 0, v37
    v_max_f32 v38, 0, v38
    v_max_f32 v39, 0, v39
    v_mul_f32 v32, v32, v40
    v_mul_f32 v33, v33, v41
    v_mul_f32 v34, v34, v42
    v_mfma_f32_32x32x16_bf16 v[64:79], a[112:115], v[132:135], v[64:79]
    ds_read_b64_tr_b16 a[104:105], v3 offset:4096
    s_waitcnt lgkmcnt(14)
    ds_read_b64_tr_b16 a[106:107], v3 offset:4608
    buffer_load_dwordx4 v17, s[12:15], s80 offen offset:1024 lds
    v_mul_f32 v35, v35, v43
    v_mul_f32 v36, v36, v44
    v_mul_f32 v37, v37, v45
    v_mul_f32 v38, v38, v46
    v_mul_f32 v39, v39, v47
    v_cvt_pk_bf16_f32 v40, v32, v33
    s_waitcnt lgkmcnt(8)
    v_mfma_f32_32x32x16_bf16 v[80:95], a[116:119], v[132:135], v[80:95]
    ds_read_b64_tr_b16 a[108:109], v4 offset:4096
    ds_read_b64_tr_b16 a[110:111], v4 offset:4608
    v_cvt_pk_bf16_f32 v41, v34, v35
    v_cvt_pk_bf16_f32 v42, v36, v37
    v_cvt_pk_bf16_f32 v43, v38, v39
    v_max_f32 v48, 0, v48
    v_max_f32 v49, 0, v49
    v_max_f32 v50, 0, v50
    v_max_f32 v51, 0, v51
    v_mfma_f32_32x32x16_bf16 v[96:111], a[120:123], v[132:135], v[96:111]
    ds_read_b64_tr_b16 a[112:113], v1 offset:6144
    ds_read_b64_tr_b16 a[114:115], v1 offset:6656
    buffer_load_dwordx4 v18, s[12:15], s80 offen offset:2048 lds
    v_max_f32 v52, 0, v52
    v_max_f32 v53, 0, v53
    v_max_f32 v54, 0, v54
    v_max_f32 v55, 0, v55
    v_mul_f32 v48, v48, v56
    v_mul_f32 v49, v49, v57
    v_mfma_f32_32x32x16_bf16 v[112:127], a[124:127], v[132:135], v[112:127]
    ds_read_b64_tr_b16 a[116:117], v2 offset:6144
    ds_read_b64_tr_b16 a[118:119], v2 offset:6656
    v_mul_f32 v50, v50, v58
    v_mul_f32 v51, v51, v59
    v_mul_f32 v52, v52, v60
    v_mul_f32 v53, v53, v61
    v_mul_f32 v54, v54, v62
    v_mul_f32 v55, v55, v63
    v_cvt_pk_bf16_f32 v56, v48, v49
    v_cvt_pk_bf16_f32 v57, v50, v51
    s_waitcnt lgkmcnt(6)
    v_mfma_f32_32x32x16_bf16 v[64:79], a[96:99], v[136:139], v[64:79]
    ds_read_b64_tr_b16 a[120:121], v3 offset:6144
    ds_read_b64_tr_b16 a[122:123], v3 offset:6656
    buffer_load_dwordx4 v19, s[12:15], s80 offen offset:3072 lds
    v_cvt_pk_bf16_f32 v58, v52, v53
    v_cvt_pk_bf16_f32 v59, v54, v55
    v_accvgpr_read_b32 v32, a0
    v_accvgpr_read_b32 v33, a1
    v_accvgpr_read_b32 v34, a2
    v_mfma_f32_32x32x16_bf16 v[80:95], a[100:103], v[136:139], v[80:95]
    ds_read_b64_tr_b16 a[124:125], v4 offset:6144
    ds_read_b64_tr_b16 a[126:127], v4 offset:6656
    s_add_u32 m0, s61, 36864
    s_lshl_b32 s63, s78, 4
    s_add_u32 s63, s63, s53
    s_add_u32 s63, s63, 32768
    v_accvgpr_read_b32 v35, a3
    v_accvgpr_read_b32 v36, a4
    v_accvgpr_read_b32 v37, a5
    v_accvgpr_read_b32 v38, a6
    v_mfma_f32_32x32x16_bf16 v[96:111], a[104:107], v[136:139], v[96:111]
    ds_read_b64_tr_b16 a[96:97], v5 offset:0
    ds_read_b64_tr_b16 a[98:99], v5 offset:512
    buffer_load_dwordx4 v24, s[20:23], s63 offen offset:0 lds
    v_accvgpr_read_b32 v39, a7
    v_max_f32 v32, 0, v32
    v_max_f32 v33, 0, v33
    v_max_f32 v34, 0, v34
    v_max_f32 v35, 0, v35
    v_max_f32 v36, 0, v36
    s_waitcnt lgkmcnt(6)
    v_mfma_f32_32x32x16_bf16 v[112:127], a[108:111], v[136:139], v[112:127]
    ds_read_b64_tr_b16 a[100:101], v6 offset:0
    ds_read_b64_tr_b16 a[102:103], v6 offset:512
    v_max_f32 v37, 0, v37
    v_max_f32 v38, 0, v38
    v_max_f32 v39, 0, v39
    v_accvgpr_read_b32 v44, a8
    v_accvgpr_read_b32 v45, a9
    v_accvgpr_read_b32 v46, a10
    v_accvgpr_read_b32 v47, a11
    v_mfma_f32_32x32x16_bf16 v[64:79], a[112:115], v[140:143], v[64:79]
    ds_read_b64_tr_b16 a[104:105], v7 offset:0
    ds_read_b64_tr_b16 a[106:107], v7 offset:512
    buffer_load_dwordx4 v25, s[20:23], s63 offen offset:1024 lds
    v_mul_f32 v32, v32, v44
    v_mul_f32 v33, v33, v45
    v_mul_f32 v34, v34, v46
    v_mul_f32 v35, v35, v47
    v_accvgpr_read_b32 v44, a12
    v_accvgpr_read_b32 v45, a13
    v_mfma_f32_32x32x16_bf16 v[80:95], a[116:119], v[140:143], v[80:95]
    ds_read_b64_tr_b16 a[108:109], v8 offset:0
    ds_read_b64_tr_b16 a[110:111], v8 offset:512
    s_add_u32 s63, s63, 14336
    v_accvgpr_read_b32 v46, a14
    v_accvgpr_read_b32 v47, a15
    v_mul_f32 v36, v36, v44
    v_mul_f32 v37, v37, v45
    v_mul_f32 v38, v38, v46
    v_mul_f32 v39, v39, v47
    v_cvt_pk_bf16_f32 v12, v32, v33
    s_waitcnt lgkmcnt(6)
    v_mfma_f32_32x32x16_bf16 v[96:111], a[120:123], v[140:143], v[96:111]
    ds_read_b64_tr_b16 a[112:113], v5 offset:2048
    ds_read_b64_tr_b16 a[114:115], v5 offset:2560
    buffer_load_dwordx4 v24, s[20:23], s63 offen offset:2048 lds
    v_cvt_pk_bf16_f32 v13, v34, v35
    v_cvt_pk_bf16_f32 v14, v36, v37
    v_cvt_pk_bf16_f32 v15, v38, v39
    v_accvgpr_read_b32 v48, a16
    v_accvgpr_read_b32 v49, a17
    v_mfma_f32_32x32x16_bf16 v[112:127], a[124:127], v[140:143], v[112:127]
    ds_read_b64_tr_b16 a[116:117], v6 offset:2048
    ds_read_b64_tr_b16 a[118:119], v6 offset:2560
    v_accvgpr_read_b32 v50, a18
    v_accvgpr_read_b32 v51, a19
    v_accvgpr_read_b32 v52, a20
    v_accvgpr_read_b32 v53, a21
    v_accvgpr_read_b32 v54, a22
    v_accvgpr_read_b32 v55, a23
    v_max_f32 v48, 0, v48
    v_max_f32 v49, 0, v49
    v_mfma_f32_32x32x16_bf16 v[64:79], a[96:99], v[144:147], v[64:79]
    ds_read_b64_tr_b16 a[120:121], v7 offset:2048
    ds_read_b64_tr_b16 a[122:123], v7 offset:2560
    buffer_load_dwordx4 v25, s[20:23], s63 offen offset:3072 lds
    v_max_f32 v50, 0, v50
    v_max_f32 v51, 0, v51
    v_max_f32 v52, 0, v52
    v_max_f32 v53, 0, v53
    v_max_f32 v54, 0, v54
    v_max_f32 v55, 0, v55
    s_waitcnt lgkmcnt(6)
    v_mfma_f32_32x32x16_bf16 v[80:95], a[100:103], v[144:147], v[80:95]
    ds_read_b64_tr_b16 a[124:125], v8 offset:2048
    ds_read_b64_tr_b16 a[126:127], v8 offset:2560
    v_accvgpr_read_b32 v60, a24
    v_accvgpr_read_b32 v61, a25
    v_accvgpr_read_b32 v62, a26
    v_accvgpr_read_b32 v63, a27
    v_mul_f32 v48, v48, v60
    v_mul_f32 v49, v49, v61
    v_mul_f32 v50, v50, v62
    v_mfma_f32_32x32x16_bf16 v[96:111], a[104:107], v[144:147], v[96:111]
    ds_read_b64_tr_b16 a[96:97], v5 offset:4096
    ds_read_b64_tr_b16 a[98:99], v5 offset:4608
    buffer_store_dwordx4 v[40:43], v0, s[28:31], s52 offen offset:0 sc1
    v_mul_f32 v51, v51, v63
    v_accvgpr_read_b32 v60, a28
    v_accvgpr_read_b32 v61, a29
    v_accvgpr_read_b32 v62, a30
    v_accvgpr_read_b32 v63, a31
    v_mul_f32 v52, v52, v60
    v_mfma_f32_32x32x16_bf16 v[112:127], a[108:111], v[144:147], v[112:127]
    ds_read_b64_tr_b16 a[100:101], v6 offset:4096
    ds_read_b64_tr_b16 a[102:103], v6 offset:4608
    v_mul_f32 v53, v53, v61
    v_mul_f32 v54, v54, v62
    v_mul_f32 v55, v55, v63
    v_cvt_pk_bf16_f32 v20, v48, v49
    v_cvt_pk_bf16_f32 v21, v50, v51
    v_cvt_pk_bf16_f32 v22, v52, v53
    v_cvt_pk_bf16_f32 v23, v54, v55
    v_accvgpr_read_b32 v32, a32
    s_waitcnt lgkmcnt(6)
    v_mfma_f32_32x32x16_bf16 v[64:79], a[112:115], v[148:151], v[64:79]
    ds_read_b64_tr_b16 a[104:105], v7 offset:4096
    ds_read_b64_tr_b16 a[106:107], v7 offset:4608
    buffer_store_dwordx4 v[56:59], v0, s[28:31], s52 offen offset:1024 sc1
    v_accvgpr_read_b32 v33, a33
    v_accvgpr_read_b32 v34, a34
    v_accvgpr_read_b32 v35, a35
    v_accvgpr_read_b32 v36, a36
    v_accvgpr_read_b32 v37, a37
    v_mfma_f32_32x32x16_bf16 v[80:95], a[116:119], v[148:151], v[80:95]
    ds_read_b64_tr_b16 a[108:109], v8 offset:4096
    ds_read_b64_tr_b16 a[110:111], v8 offset:4608
    v_accvgpr_read_b32 v38, a38
    v_accvgpr_read_b32 v39, a39
    v_max_f32 v32, 0, v32
    v_max_f32 v33, 0, v33
    v_max_f32 v34, 0, v34
    v_max_f32 v35, 0, v35
    v_max_f32 v36, 0, v36
    v_max_f32 v37, 0, v37
    v_mfma_f32_32x32x16_bf16 v[96:111], a[120:123], v[148:151], v[96:111]
    ds_read_b64_tr_b16 a[112:113], v5 offset:6144
    ds_read_b64_tr_b16 a[114:115], v5 offset:6656
    buffer_store_dwordx4 v[12:15], v0, s[28:31], s52 offen offset:2048 sc1
    v_max_f32 v38, 0, v38
    v_max_f32 v39, 0, v39
    v_accvgpr_read_b32 v44, a40
    v_accvgpr_read_b32 v45, a41
    v_accvgpr_read_b32 v46, a42
    v_accvgpr_read_b32 v47, a43
    s_waitcnt lgkmcnt(6)
    v_mfma_f32_32x32x16_bf16 v[112:127], a[124:127], v[148:151], v[112:127]
    ds_read_b64_tr_b16 a[116:117], v6 offset:6144
    ds_read_b64_tr_b16 a[118:119], v6 offset:6656
    v_mul_f32 v32, v32, v44
    v_mul_f32 v33, v33, v45
    v_mul_f32 v34, v34, v46
    v_mul_f32 v35, v35, v47
    v_accvgpr_read_b32 v44, a44
    v_accvgpr_read_b32 v45, a45
    v_accvgpr_read_b32 v46, a46
    v_mfma_f32_32x32x16_bf16 v[64:79], a[96:99], v[152:155], v[64:79]
    ds_read_b64_tr_b16 a[120:121], v7 offset:6144
    ds_read_b64_tr_b16 a[122:123], v7 offset:6656
    buffer_store_dwordx4 v[20:23], v0, s[28:31], s52 offen offset:3072 sc1
    v_accvgpr_read_b32 v47, a47
    v_mul_f32 v36, v36, v44
    v_mul_f32 v37, v37, v45
    v_mul_f32 v38, v38, v46
    v_mul_f32 v39, v39, v47
    v_cvt_pk_bf16_f32 v44, v32, v33
    v_mfma_f32_32x32x16_bf16 v[80:95], a[100:103], v[152:155], v[80:95]
    ds_read_b64_tr_b16 a[124:125], v8 offset:6144
    ds_read_b64_tr_b16 a[126:127], v8 offset:6656
    v_cvt_pk_bf16_f32 v45, v34, v35
    v_cvt_pk_bf16_f32 v46, v36, v37
    v_cvt_pk_bf16_f32 v47, v38, v39
    v_accvgpr_read_b32 v48, a48
    v_accvgpr_read_b32 v49, a49
    v_accvgpr_read_b32 v50, a50
    v_accvgpr_read_b32 v51, a51
    v_accvgpr_read_b32 v52, a52
    s_waitcnt lgkmcnt(6)
    v_mfma_f32_32x32x16_bf16 v[96:111], a[104:107], v[152:155], v[96:111]
    s_waitcnt vmcnt(20)
    s_barrier
    ds_read_b64_tr_b16 a[96:97], v1 offset:8192
    ds_read_b64_tr_b16 a[98:99], v1 offset:8704
    s_waitcnt vmcnt(18)
    ds_read_b64_tr_b16 a[224:225], v26 offset:32768
    v_accvgpr_read_b32 v53, a53
    v_accvgpr_read_b32 v54, a54
    v_accvgpr_read_b32 v55, a55
    v_max_f32 v48, 0, v48
    v_mfma_f32_32x32x16_bf16 v[112:127], a[108:111], v[152:155], v[112:127]
    ds_read_b64_tr_b16 a[100:101], v2 offset:8192
    ds_read_b64_tr_b16 a[102:103], v2 offset:8704
    ds_read_b64_tr_b16 a[226:227], v26 offset:33792
    s_add_u32 s52, s52, 4096
    buffer_store_dwordx4 v[44:47], v0, s[28:31], s52 offen offset:0 sc1
    v_max_f32 v49, 0, v49
    v_max_f32 v50, 0, v50
    v_max_f32 v51, 0, v51
    v_max_f32 v52, 0, v52
    v_mfma_f32_32x32x16_bf16 v[64:79], a[112:115], v[156:159], v[64:79]
    ds_read_b64_tr_b16 a[104:105], v3 offset:8192
    ds_read_b64_tr_b16 a[106:107], v3 offset:8704
    ds_read_b64_tr_b16 a[228:229], v27 offset:32768
    s_add_u32 m0, s61, 24576
    v_max_f32 v53, 0, v53
    v_max_f32 v54, 0, v54
    v_max_f32 v55, 0, v55
    v_accvgpr_read_b32 v60, a56
    v_accvgpr_read_b32 v61, a57
    v_accvgpr_read_b32 v62, a58
    s_waitcnt lgkmcnt(9)
    v_mfma_f32_32x32x16_bf16 v[80:95], a[116:119], v[156:159], v[80:95]
    ds_read_b64_tr_b16 a[108:109], v4 offset:8192
    ds_read_b64_tr_b16 a[110:111], v4 offset:8704
    ds_read_b64_tr_b16 a[230:231], v27 offset:33792
    buffer_load_dwordx4 v16, s[12:15], s81 offen offset:0 lds
    v_accvgpr_read_b32 v63, a59
    v_mul_f32 v48, v48, v60
    v_mul_f32 v49, v49, v61
    v_mul_f32 v50, v50, v62
    v_mfma_f32_32x32x16_bf16 v[96:111], a[120:123], v[156:159], v[96:111]
    ds_read_b64_tr_b16 a[112:113], v1 offset:10240
    ds_read_b64_tr_b16 a[114:115], v1 offset:10752
    s_waitcnt vmcnt(18)
    ds_read_b64_tr_b16 a[232:233], v26 offset:34816
    v_mul_f32 v51, v51, v63
    v_accvgpr_read_b32 v60, a60
    v_accvgpr_read_b32 v61, a61
    v_accvgpr_read_b32 v62, a62
    v_accvgpr_read_b32 v63, a63
    v_mul_f32 v52, v52, v60
    v_mul_f32 v53, v53, v61
    v_mfma_f32_32x32x16_bf16 v[112:127], a[124:127], v[156:159], v[112:127]
    s_waitcnt lgkmcnt(14)
    ds_read_b64_tr_b16 a[116:117], v2 offset:10240
    s_waitcnt lgkmcnt(14)
    ds_read_b64_tr_b16 a[118:119], v2 offset:10752
    buffer_load_dwordx4 v17, s[12:15], s81 offen offset:1024 lds
    v_mul_f32 v54, v54, v62
    v_mul_f32 v55, v55, v63
    v_cvt_pk_bf16_f32 v60, v48, v49
    v_cvt_pk_bf16_f32 v61, v50, v51
    v_cvt_pk_bf16_f32 v62, v52, v53
    v_cvt_pk_bf16_f32 v63, v54, v55
    s_waitcnt lgkmcnt(9)
    v_mfma_f32_32x32x16_bf16 v[64:79], a[96:99], v[160:163], v[64:79]
    ds_read_b64_tr_b16 a[120:121], v3 offset:10240
    ds_read_b64_tr_b16 a[122:123], v3 offset:10752
    ds_read_b64_tr_b16 a[234:235], v26 offset:35840
    v_accvgpr_read_b32 v32, a64
    v_accvgpr_read_b32 v33, a65
    v_accvgpr_read_b32 v34, a66
    v_accvgpr_read_b32 v35, a67
    v_accvgpr_read_b32 v36, a68
    v_accvgpr_read_b32 v37, a69
    v_mfma_f32_32x32x16_bf16 v[80:95], a[100:103], v[160:163], v[80:95]
    ds_read_b64_tr_b16 a[124:125], v4 offset:10240
    ds_read_b64_tr_b16 a[126:127], v4 offset:10752
    ds_read_b64_tr_b16 a[236:237], v27 offset:34816
    buffer_store_dwordx4 v[60:63], v0, s[28:31], s52 offen offset:1024 sc1
    v_accvgpr_read_b32 v38, a70
    v_accvgpr_read_b32 v39, a71
    v_max_f32 v32, 0, v32
    v_max_f32 v33, 0, v33
    v_max_f32 v34, 0, v34
    v_mfma_f32_32x32x16_bf16 v[96:111], a[104:107], v[160:163], v[96:111]
    s_waitcnt lgkmcnt(14)
    ds_read_b64_tr_b16 a[96:97], v1 offset:12288
    s_waitcnt lgkmcnt(14)
    ds_read_b64_tr_b16 a[98:99], v1 offset:12800
    v_max_f32 v35, 0, v35
    v_max_f32 v36, 0, v36
    v_max_f32 v37, 0, v37
    v_max_f32 v38, 0, v38
    v_max_f32 v39, 0, v39
    v_accvgpr_read_b32 v28, a72
    v_accvgpr_read_b32 v29, a73
    v_accvgpr_read_b32 v30, a74
    s_waitcnt lgkmcnt(8)
    v_mfma_f32_32x32x16_bf16 v[112:127], a[108:111], v[160:163], v[112:127]
    ds_read_b64_tr_b16 a[100:101], v2 offset:12288
    ds_read_b64_tr_b16 a[102:103], v2 offset:12800
    ds_read_b64_tr_b16 a[238:239], v27 offset:35840
    buffer_load_dwordx4 v18, s[12:15], s81 offen offset:2048 lds
    v_accvgpr_read_b32 v31, a75
    v_mul_f32 v32, v32, v28
    v_mul_f32 v33, v33, v29
    v_mul_f32 v34, v34, v30
    v_mfma_f32_32x32x16_bf16 v[64:79], a[112:115], v[164:167], v[64:79]
    ds_read_b64_tr_b16 a[104:105], v3 offset:12288
    ds_read_b64_tr_b16 a[106:107], v3 offset:12800
    v_mul_f32 v35, v35, v31
    v_accvgpr_read_b32 v28, a76
    v_accvgpr_read_b32 v29, a77
    v_accvgpr_read_b32 v30, a78
    v_accvgpr_read_b32 v31, a79
    v_mul_f32 v36, v36, v28
    v_mul_f32 v37, v37, v29
    v_mul_f32 v38, v38, v30
    v_mfma_f32_32x32x16_bf16 v[80:95], a[116:119], v[164:167], v[80:95]
    ds_read_b64_tr_b16 a[108:109], v4 offset:12288
    ds_read_b64_tr_b16 a[110:111], v4 offset:12800
    buffer_load_dwordx4 v19, s[12:15], s81 offen offset:3072 lds
    v_mul_f32 v39, v39, v31
    v_cvt_pk_bf16_f32 v32, v32, v33
    v_cvt_pk_bf16_f32 v33, v34, v35
    v_cvt_pk_bf16_f32 v34, v36, v37
    v_cvt_pk_bf16_f32 v35, v38, v39
    v_accvgpr_read_b32 v48, a80
    s_waitcnt lgkmcnt(7)
    v_mfma_f32_32x32x16_bf16 v[96:111], a[120:123], v[164:167], v[96:111]
    ds_read_b64_tr_b16 a[112:113], v1 offset:14336
    ds_read_b64_tr_b16 a[114:115], v1 offset:14848
    v_accvgpr_read_b32 v49, a81
    v_accvgpr_read_b32 v50, a82
    v_accvgpr_read_b32 v51, a83
    v_accvgpr_read_b32 v52, a84
    v_accvgpr_read_b32 v53, a85
    v_accvgpr_read_b32 v54, a86
    v_accvgpr_read_b32 v55, a87
    v_mfma_f32_32x32x16_bf16 v[112:127], a[124:127], v[164:167], v[112:127]
    ds_read_b64_tr_b16 a[116:117], v2 offset:14336
    ds_read_b64_tr_b16 a[118:119], v2 offset:14848
    buffer_store_dwordx4 v[32:35], v0, s[28:31], s52 offen offset:2048 sc1
    v_max_f32 v48, 0, v48
    v_max_f32 v49, 0, v49
    v_max_f32 v50, 0, v50
    v_max_f32 v51, 0, v51
    v_max_f32 v52, 0, v52
    v_max_f32 v53, 0, v53
    v_mfma_f32_32x32x16_bf16 v[64:79], a[96:99], v[168:171], v[64:79]
    ds_read_b64_tr_b16 a[120:121], v3 offset:14336
    ds_read_b64_tr_b16 a[122:123], v3 offset:14848
    s_waitcnt lgkmcnt(10)
    s_add_u32 m0, s61, 32768
    s_lshl_b32 s63, s79, 4
    s_add_u32 s63, s63, s53
    v_max_f32 v54, 0, v54
    v_max_f32 v55, 0, v55
    v_accvgpr_read_b32 v36, a88
    v_accvgpr_read_b32 v37, a89
    s_waitcnt lgkmcnt(6)
    v_mfma_f32_32x32x16_bf16 v[80:95], a[100:103], v[168:171], v[80:95]
    ds_read_b64_tr_b16 a[124:125], v4 offset:14336
    ds_read_b64_tr_b16 a[126:127], v4 offset:14848
    buffer_load_dwordx4 v24, s[20:23], s63 offen offset:0 lds
    v_accvgpr_read_b32 v38, a90
    v_accvgpr_read_b32 v39, a91
    v_mul_f32 v48, v48, v36
    v_mul_f32 v49, v49, v37
    v_mul_f32 v50, v50, v38
    v_mfma_f32_32x32x16_bf16 v[96:111], a[104:107], v[168:171], v[96:111]
    ds_read_b64_tr_b16 a[96:97], v5 offset:8192
    ds_read_b64_tr_b16 a[98:99], v5 offset:8704
    v_mul_f32 v51, v51, v39
    v_accvgpr_read_b32 v36, a92
    v_accvgpr_read_b32 v37, a93
    v_accvgpr_read_b32 v38, a94
    v_accvgpr_read_b32 v39, a95
    v_mul_f32 v52, v52, v36
    v_mul_f32 v53, v53, v37
    v_mul_f32 v54, v54, v38
    v_mfma_f32_32x32x16_bf16 v[112:127], a[108:111], v[168:171], v[112:127]
    ds_read_b64_tr_b16 a[100:101], v6 offset:8192
    ds_read_b64_tr_b16 a[102:103], v6 offset:8704
    buffer_load_dwordx4 v25, s[20:23], s63 offen offset:1024 lds
    v_mul_f32 v55, v55, v39
    v_cvt_pk_bf16_f32 v48, v48, v49
    v_cvt_pk_bf16_f32 v49, v50, v51
    v_cvt_pk_bf16_f32 v50, v52, v53
    v_cvt_pk_bf16_f32 v51, v54, v55
    s_lshl_b32 s72, s4, 1
    s_waitcnt lgkmcnt(6)
    v_mfma_f32_32x32x16_bf16 v[64:79], a[112:115], v[172:175], v[64:79]
    ds_read_b64_tr_b16 a[104:105], v7 offset:8192
    ds_read_b64_tr_b16 a[106:107], v7 offset:8704
    s_lshr_b32 s73, s3, 1
    s_add_u32 s72, s72, s73
    s_lshl_b32 s72, s72, 11
    s_lshl_b32 s73, s5, 3
    s_add_u32 s72, s72, s73
    s_and_b32 s73, s3, 1
    s_lshl_b32 s73, s73, 2
    v_mfma_f32_32x32x16_bf16 v[80:95], a[116:119], v[172:175], v[80:95]
    ds_read_b64_tr_b16 a[108:109], v8 offset:8192
    ds_read_b64_tr_b16 a[110:111], v8 offset:8704
    buffer_store_dwordx4 v[48:51], v0, s[28:31], s52 offen offset:3072 sc1
    s_add_u32 s72, s72, s73
    s_add_u32 s72, s72, 10485760
    v_mfma_f32_32x32x16_bf16 v[96:111], a[120:123], v[172:175], v[96:111]
    ds_read_b64_tr_b16 a[112:113], v5 offset:10240
    ds_read_b64_tr_b16 a[114:115], v5 offset:10752
    s_add_u32 s63, s63, 14336
    v_lshlrev_b32 v9, 4, v0
    v_add_u32 v9, s72, v9
    v_cmp_gt_u32 vcc, 128, v0
    s_waitcnt lgkmcnt(6)
    v_mfma_f32_32x32x16_bf16 v[112:127], a[124:127], v[172:175], v[112:127]
    ds_read_b64_tr_b16 a[116:117], v6 offset:10240
    ds_read_b64_tr_b16 a[118:119], v6 offset:10752
    buffer_load_dwordx4 v24, s[20:23], s63 offen offset:2048 lds
    v_mov_b32 v29, 2146435072
    v_mfma_f32_32x32x16_bf16 v[64:79], a[96:99], v[176:179], v[64:79]
    ds_read_b64_tr_b16 a[120:121], v7 offset:10240
    ds_read_b64_tr_b16 a[122:123], v7 offset:10752
    s_lshl_b32 s72, s7, 3
    v_cndmask_b32 v9, v29, v9, vcc
    s_add_u32 s72, s72, s60
    s_lshl_b32 s72, s72, 8
    v_mfma_f32_32x32x16_bf16 v[80:95], a[100:103], v[176:179], v[80:95]
    ds_read_b64_tr_b16 a[124:125], v8 offset:10240
    ds_read_b64_tr_b16 a[126:127], v8 offset:10752
    buffer_load_dwordx4 v25, s[20:23], s63 offen offset:3072 lds
    s_lshl_b32 s73, s3, 5
    s_add_u32 s72, s72, s73
    s_waitcnt lgkmcnt(6)
    v_mfma_f32_32x32x16_bf16 v[96:111], a[104:107], v[176:179], v[96:111]
    ds_read_b64_tr_b16 a[96:97], v5 offset:12288
    ds_read_b64_tr_b16 a[98:99], v5 offset:12800
    s_add_u32 m0, s61, 28672
    s_add_u32 s81, s81, s50
    s_add_u32 s72, s72, 10485760
    v_mfma_f32_32x32x16_bf16 v[112:127], a[108:111], v[176:179], v[112:127]
    ds_read_b64_tr_b16 a[100:101], v6 offset:12288
    ds_read_b64_tr_b16 a[102:103], v6 offset:12800
    buffer_load_dwordx4 v16, s[12:15], s81 offen offset:0 lds
    v_bfe_u32 v29, v0, 4, 3
    v_lshlrev_b32 v29, 2, v29
    v_mfma_f32_32x32x16_bf16 v[64:79], a[112:115], v[180:183], v[64:79]
    ds_read_b64_tr_b16 a[104:105], v7 offset:12288
    ds_read_b64_tr_b16 a[106:107], v7 offset:12800
    v_add_u32 v29, s72, v29
    v_mov_b32 v10, 1
    s_lshl_b32 s64, s7, 16
    s_lshr_b32 s72, s3, 1
    s_waitcnt lgkmcnt(6)
    v_mfma_f32_32x32x16_bf16 v[80:95], a[116:119], v[180:183], v[80:95]
    ds_read_b64_tr_b16 a[108:109], v8 offset:12288
    ds_read_b64_tr_b16 a[110:111], v8 offset:12800
    buffer_load_dwordx4 v17, s[12:15], s81 offen offset:1024 lds
    s_lshl_b32 s72, s72, 15
    v_mfma_f32_32x32x16_bf16 v[96:111], a[120:123], v[180:183], v[96:111]
    ds_read_b64_tr_b16 a[112:113], v5 offset:14336
    ds_read_b64_tr_b16 a[114:115], v5 offset:14848
    s_add_u32 s64, s64, s72
    s_lshl_b32 s72, s60, 7
    s_add_u32 s64, s64, s72
    s_and_b32 s72, s3, 1
    v_mfma_f32_32x32x16_bf16 v[112:127], a[124:127], v[180:183], v[112:127]
    ds_read_b64_tr_b16 a[116:117], v6 offset:14336
    ds_read_b64_tr_b16 a[118:119], v6 offset:14848
    buffer_load_dwordx4 v18, s[12:15], s81 offen offset:2048 lds
    s_lshl_b32 s72, s72, 6
    s_add_u32 s64, s64, s72
    s_waitcnt lgkmcnt(6)
    v_mfma_f32_32x32x16_bf16 v[64:79], a[96:99], v[184:187], v[64:79]
    ds_read_b64_tr_b16 a[120:121], v7 offset:14336
    ds_read_b64_tr_b16 a[122:123], v7 offset:14848
    v_lshrrev_b32 v30, 6, v0
    v_lshlrev_b32 v30, 10, v30
    v_lshrrev_b32 v28, 4, v0
    v_mfma_f32_32x32x16_bf16 v[80:95], a[100:103], v[184:187], v[80:95]
    ds_read_b64_tr_b16 a[124:125], v8 offset:14336
    ds_read_b64_tr_b16 a[126:127], v8 offset:14848
    buffer_load_dwordx4 v19, s[12:15], s81 offen offset:3072 lds
    v_xor_b32 v28, v28, v0
    v_and_b32 v28, 0x30, v28
    v_mfma_f32_32x32x16_bf16 v[96:111], a[104:107], v[184:187], v[96:111]
    s_waitcnt vmcnt(24)
    s_barrier
    ds_read_b64_tr_b16 a[96:97], v1 offset:16384
    ds_read_b64_tr_b16 a[98:99], v1 offset:16896
    s_waitcnt vmcnt(22)
    ds_read_b64_tr_b16 a[240:241], v26 offset:36864
    s_add_u32 m0, s61, 0
    s_waitcnt lgkmcnt(7)
    v_mfma_f32_32x32x16_bf16 v[112:127], a[108:111], v[184:187], v[112:127]
    ds_read_b64_tr_b16 a[100:101], v2 offset:16384
    ds_read_b64_tr_b16 a[102:103], v2 offset:16896
    ds_read_b64_tr_b16 a[242:243], v26 offset:37888
    s_add_u32 s63, s53, 131072
    buffer_load_dwordx4 v24, s[20:23], s63 offen offset:0 lds
    v_mfma_f32_32x32x16_bf16 v[64:79], a[112:115], v[188:191], v[64:79]
    ds_read_b64_tr_b16 a[104:105], v3 offset:16384
    ds_read_b64_tr_b16 a[106:107], v3 offset:16896
    ds_read_b64_tr_b16 a[244:245], v27 offset:36864
    v_add_u32 v28, v28, v30
    v_mfma_f32_32x32x16_bf16 v[80:95], a[116:119], v[188:191], v[80:95]
    ds_read_b64_tr_b16 a[108:109], v4 offset:16384
    ds_read_b64_tr_b16 a[110:111], v4 offset:16896
    buffer_load_dwordx4 v25, s[20:23], s63 offen offset:1024 lds
    s_waitcnt lgkmcnt(9)
    v_mfma_f32_32x32x16_bf16 v[96:111], a[120:123], v[188:191], v[96:111]
    ds_read_b64_tr_b16 a[112:113], v1 offset:18432
    ds_read_b64_tr_b16 a[114:115], v1 offset:18944
    ds_read_b64_tr_b16 a[246:247], v27 offset:37888
    s_add_u32 s63, s63, 14336
    v_mfma_f32_32x32x16_bf16 v[112:127], a[124:127], v[188:191], v[112:127]
    ds_read_b64_tr_b16 a[116:117], v2 offset:18432
    ds_read_b64_tr_b16 a[118:119], v2 offset:18944
    s_waitcnt vmcnt(22)
    ds_read_b64_tr_b16 a[248:249], v26 offset:38912
    buffer_load_dwordx4 v24, s[20:23], s63 offen offset:2048 lds
    v_mfma_f32_32x32x16_bf16 v[64:79], a[96:99], v[192:195], v[64:79]
    s_waitcnt lgkmcnt(14)
    ds_read_b64_tr_b16 a[120:121], v3 offset:18432
    s_waitcnt lgkmcnt(14)
    ds_read_b64_tr_b16 a[122:123], v3 offset:18944
    s_waitcnt lgkmcnt(8)
    v_mfma_f32_32x32x16_bf16 v[80:95], a[100:103], v[192:195], v[80:95]
    ds_read_b64_tr_b16 a[124:125], v4 offset:18432
    ds_read_b64_tr_b16 a[126:127], v4 offset:18944
    ds_read_b64_tr_b16 a[250:251], v26 offset:39936
    buffer_load_dwordx4 v25, s[20:23], s63 offen offset:3072 lds
    v_mfma_f32_32x32x16_bf16 v[96:111], a[104:107], v[192:195], v[96:111]
    ds_read_b64_tr_b16 a[96:97], v1 offset:20480
    ds_read_b64_tr_b16 a[98:99], v1 offset:20992
    ds_read_b64_tr_b16 a[252:253], v27 offset:38912
    s_add_u32 m0, s61, 4096
    s_add_u32 s63, s53, 163840
    v_mfma_f32_32x32x16_bf16 v[112:127], a[108:111], v[192:195], v[112:127]
    ds_read_b64_tr_b16 a[100:101], v2 offset:20480
    s_waitcnt lgkmcnt(14)
    ds_read_b64_tr_b16 a[102:103], v2 offset:20992
    buffer_load_dwordx4 v24, s[20:23], s63 offen offset:0 lds
    s_waitcnt lgkmcnt(8)
    v_mfma_f32_32x32x16_bf16 v[64:79], a[112:115], v[196:199], v[64:79]
    ds_read_b64_tr_b16 a[104:105], v3 offset:20480
    ds_read_b64_tr_b16 a[106:107], v3 offset:20992
    ds_read_b64_tr_b16 a[254:255], v27 offset:39936
    v_mfma_f32_32x32x16_bf16 v[80:95], a[116:119], v[196:199], v[80:95]
    ds_read_b64_tr_b16 a[108:109], v4 offset:20480
    ds_read_b64_tr_b16 a[110:111], v4 offset:20992
    buffer_load_dwordx4 v25, s[20:23], s63 offen offset:1024 lds
    v_mfma_f32_32x32x16_bf16 v[96:111], a[120:123], v[196:199], v[96:111]
    ds_read_b64_tr_b16 a[112:113], v1 offset:22528
    ds_read_b64_tr_b16 a[114:115], v1 offset:23040
    s_add_u32 s63, s63, 14336
    s_waitcnt lgkmcnt(7)
    v_mfma_f32_32x32x16_bf16 v[112:127], a[124:127], v[196:199], v[112:127]
    ds_read_b64_tr_b16 a[116:117], v2 offset:22528
    ds_read_b64_tr_b16 a[118:119], v2 offset:23040
    buffer_load_dwordx4 v24, s[20:23], s63 offen offset:2048 lds
    v_mfma_f32_32x32x16_bf16 v[64:79], a[96:99], v[200:203], v[64:79]
    ds_read_b64_tr_b16 a[120:121], v3 offset:22528
    ds_read_b64_tr_b16 a[122:123], v3 offset:23040
    v_mfma_f32_32x32x16_bf16 v[80:95], a[100:103], v[200:203], v[80:95]
    ds_read_b64_tr_b16 a[124:125], v4 offset:22528
    ds_read_b64_tr_b16 a[126:127], v4 offset:23040
    buffer_load_dwordx4 v25, s[20:23], s63 offen offset:3072 lds
    s_waitcnt lgkmcnt(6)
    v_mfma_f32_32x32x16_bf16 v[96:111], a[104:107], v[200:203], v[96:111]
    ds_read_b64_tr_b16 a[96:97], v5 offset:16384
    ds_read_b64_tr_b16 a[98:99], v5 offset:16896
    s_add_u32 m0, s61, 36864
    s_lshl_b32 s63, s79, 4
    s_add_u32 s63, s63, s53
    v_mfma_f32_32x32x16_bf16 v[112:127], a[108:111], v[200:203], v[112:127]
    ds_read_b64_tr_b16 a[100:101], v6 offset:16384
    ds_read_b64_tr_b16 a[102:103], v6 offset:16896
    s_add_u32 s63, s63, 32768
    buffer_load_dwordx4 v24, s[20:23], s63 offen offset:0 lds
    v_mfma_f32_32x32x16_bf16 v[64:79], a[112:115], v[204:207], v[64:79]
    ds_read_b64_tr_b16 a[104:105], v7 offset:16384
    ds_read_b64_tr_b16 a[106:107], v7 offset:16896
    s_waitcnt lgkmcnt(6)
    v_mfma_f32_32x32x16_bf16 v[80:95], a[116:119], v[204:207], v[80:95]
    ds_read_b64_tr_b16 a[108:109], v8 offset:16384
    ds_read_b64_tr_b16 a[110:111], v8 offset:16896
    buffer_load_dwordx4 v25, s[20:23], s63 offen offset:1024 lds
    v_mfma_f32_32x32x16_bf16 v[96:111], a[120:123], v[204:207], v[96:111]
    ds_read_b64_tr_b16 a[112:113], v5 offset:18432
    ds_read_b64_tr_b16 a[114:115], v5 offset:18944
    s_add_u32 s63, s63, 14336
    v_mfma_f32_32x32x16_bf16 v[112:127], a[124:127], v[204:207], v[112:127]
    ds_read_b64_tr_b16 a[116:117], v6 offset:18432
    ds_read_b64_tr_b16 a[118:119], v6 offset:18944
    buffer_load_dwordx4 v24, s[20:23], s63 offen offset:2048 lds
    s_waitcnt lgkmcnt(6)
    v_mfma_f32_32x32x16_bf16 v[64:79], a[96:99], v[208:211], v[64:79]
    ds_read_b64_tr_b16 a[120:121], v7 offset:18432
    ds_read_b64_tr_b16 a[122:123], v7 offset:18944
    v_mfma_f32_32x32x16_bf16 v[80:95], a[100:103], v[208:211], v[80:95]
    ds_read_b64_tr_b16 a[124:125], v8 offset:18432
    ds_read_b64_tr_b16 a[126:127], v8 offset:18944
    buffer_load_dwordx4 v25, s[20:23], s63 offen offset:3072 lds
    v_mfma_f32_32x32x16_bf16 v[96:111], a[104:107], v[208:211], v[96:111]
    ds_read_b64_tr_b16 a[96:97], v5 offset:20480
    ds_read_b64_tr_b16 a[98:99], v5 offset:20992
    s_waitcnt vmcnt(18)
    buffer_store_dword v10, v9, s[28:31], 0 offen sc1
    s_waitcnt lgkmcnt(6)
    v_mfma_f32_32x32x16_bf16 v[112:127], a[108:111], v[208:211], v[112:127]
    ds_read_b64_tr_b16 a[100:101], v6 offset:20480
    ds_read_b64_tr_b16 a[102:103], v6 offset:20992
    v_mfma_f32_32x32x16_bf16 v[64:79], a[112:115], v[212:215], v[64:79]
    ds_read_b64_tr_b16 a[104:105], v7 offset:20480
    ds_read_b64_tr_b16 a[106:107], v7 offset:20992
    v_mfma_f32_32x32x16_bf16 v[80:95], a[116:119], v[212:215], v[80:95]
    ds_read_b64_tr_b16 a[108:109], v8 offset:20480
    ds_read_b64_tr_b16 a[110:111], v8 offset:20992
    s_waitcnt lgkmcnt(6)
    v_mfma_f32_32x32x16_bf16 v[96:111], a[120:123], v[212:215], v[96:111]
    ds_read_b64_tr_b16 a[112:113], v5 offset:22528
    ds_read_b64_tr_b16 a[114:115], v5 offset:23040
    v_mfma_f32_32x32x16_bf16 v[112:127], a[124:127], v[212:215], v[112:127]
    ds_read_b64_tr_b16 a[116:117], v6 offset:22528
    ds_read_b64_tr_b16 a[118:119], v6 offset:23040
    v_mfma_f32_32x32x16_bf16 v[64:79], a[96:99], v[216:219], v[64:79]
    ds_read_b64_tr_b16 a[120:121], v7 offset:22528
    ds_read_b64_tr_b16 a[122:123], v7 offset:23040
    s_waitcnt lgkmcnt(6)
    v_mfma_f32_32x32x16_bf16 v[80:95], a[100:103], v[216:219], v[80:95]
    ds_read_b64_tr_b16 a[124:125], v8 offset:22528
    ds_read_b64_tr_b16 a[126:127], v8 offset:23040
    v_mfma_f32_32x32x16_bf16 v[96:111], a[104:107], v[216:219], v[96:111]
    s_waitcnt vmcnt(13)
    s_barrier
    ds_read_b64_tr_b16 a[96:97], v1 offset:24576
    ds_read_b64_tr_b16 a[98:99], v1 offset:25088
    s_add_u32 m0, s61, 14336
    s_nop 0
    buffer_load_dwordx4 v28, s[8:11], s64 offen lds
    v_mfma_f32_32x32x16_bf16 v[112:127], a[108:111], v[216:219], v[112:127]
    ds_read_b64_tr_b16 a[100:101], v2 offset:24576
    ds_read_b64_tr_b16 a[102:103], v2 offset:25088
    s_add_u32 m0, s61, 15360
    s_add_u32 s63, s64, 16384
    s_waitcnt lgkmcnt(6)
    v_mfma_f32_32x32x16_bf16 v[64:79], a[112:115], v[220:223], v[64:79]
    ds_read_b64_tr_b16 a[104:105], v3 offset:24576
    ds_read_b64_tr_b16 a[106:107], v3 offset:25088
    buffer_load_dwordx4 v28, s[8:11], s63 offen lds
    v_mfma_f32_32x32x16_bf16 v[80:95], a[116:119], v[220:223], v[80:95]
    ds_read_b64_tr_b16 a[108:109], v4 offset:24576
    ds_read_b64_tr_b16 a[110:111], v4 offset:25088
    s_add_u32 m0, s61, 8192
    s_add_u32 s63, s53, 327680
    v_mfma_f32_32x32x16_bf16 v[96:111], a[120:123], v[220:223], v[96:111]
    ds_read_b64_tr_b16 a[112:113], v1 offset:26624
    ds_read_b64_tr_b16 a[114:115], v1 offset:27136
    buffer_load_dwordx4 v24, s[20:23], s63 offen offset:0 lds
    s_waitcnt lgkmcnt(6)
    v_mfma_f32_32x32x16_bf16 v[112:127], a[124:127], v[220:223], v[112:127]
    ds_read_b64_tr_b16 a[116:117], v2 offset:26624
    ds_read_b64_tr_b16 a[118:119], v2 offset:27136
    v_mfma_f32_32x32x16_bf16 v[64:79], a[96:99], v[224:227], v[64:79]
    ds_read_b64_tr_b16 a[120:121], v3 offset:26624
    ds_read_b64_tr_b16 a[122:123], v3 offset:27136
    buffer_load_dwordx4 v25, s[20:23], s63 offen offset:1024 lds
    v_mfma_f32_32x32x16_bf16 v[80:95], a[100:103], v[224:227], v[80:95]
    ds_read_b64_tr_b16 a[124:125], v4 offset:26624
    ds_read_b64_tr_b16 a[126:127], v4 offset:27136
    s_add_u32 s63, s63, 14336
    s_waitcnt lgkmcnt(6)
    v_mfma_f32_32x32x16_bf16 v[96:111], a[104:107], v[224:227], v[96:111]
    ds_read_b64_tr_b16 a[96:97], v1 offset:28672
    ds_read_b64_tr_b16 a[98:99], v1 offset:29184
    buffer_load_dwordx4 v24, s[20:23], s63 offen offset:2048 lds
    v_mfma_f32_32x32x16_bf16 v[112:127], a[108:111], v[224:227], v[112:127]
    ds_read_b64_tr_b16 a[100:101], v2 offset:28672
    ds_read_b64_tr_b16 a[102:103], v2 offset:29184
    v_mfma_f32_32x32x16_bf16 v[64:79], a[112:115], v[228:231], v[64:79]
    ds_read_b64_tr_b16 a[104:105], v3 offset:28672
    ds_read_b64_tr_b16 a[106:107], v3 offset:29184
    buffer_load_dwordx4 v25, s[20:23], s63 offen offset:3072 lds
    s_waitcnt lgkmcnt(6)
    v_mfma_f32_32x32x16_bf16 v[80:95], a[116:119], v[228:231], v[80:95]
    ds_read_b64_tr_b16 a[108:109], v4 offset:28672
    ds_read_b64_tr_b16 a[110:111], v4 offset:29184
    s_add_u32 m0, s61, 12288
    s_add_u32 s63, s53, 360448
    v_mfma_f32_32x32x16_bf16 v[96:111], a[120:123], v[228:231], v[96:111]
    ds_read_b64_tr_b16 a[112:113], v1 offset:30720
    ds_read_b64_tr_b16 a[114:115], v1 offset:31232
    buffer_load_dwordx4 v24, s[20:23], s63 offen offset:0 lds
    v_mfma_f32_32x32x16_bf16 v[112:127], a[124:127], v[228:231], v[112:127]
    ds_read_b64_tr_b16 a[116:117], v2 offset:30720
    ds_read_b64_tr_b16 a[118:119], v2 offset:31232
    s_waitcnt lgkmcnt(6)
    v_mfma_f32_32x32x16_bf16 v[64:79], a[96:99], v[232:235], v[64:79]
    ds_read_b64_tr_b16 a[120:121], v3 offset:30720
    ds_read_b64_tr_b16 a[122:123], v3 offset:31232
    buffer_load_dwordx4 v25, s[20:23], s63 offen offset:1024 lds
    v_mfma_f32_32x32x16_bf16 v[80:95], a[100:103], v[232:235], v[80:95]
    ds_read_b64_tr_b16 a[124:125], v4 offset:30720
    ds_read_b64_tr_b16 a[126:127], v4 offset:31232
    v_mfma_f32_32x32x16_bf16 v[96:111], a[104:107], v[232:235], v[96:111]
    ds_read_b64_tr_b16 a[96:97], v5 offset:24576
    ds_read_b64_tr_b16 a[98:99], v5 offset:25088
    s_waitcnt lgkmcnt(6)
    v_mfma_f32_32x32x16_bf16 v[112:127], a[108:111], v[232:235], v[112:127]
    ds_read_b64_tr_b16 a[100:101], v6 offset:24576
    ds_read_b64_tr_b16 a[102:103], v6 offset:25088
    v_mfma_f32_32x32x16_bf16 v[64:79], a[112:115], v[236:239], v[64:79]
    ds_read_b64_tr_b16 a[104:105], v7 offset:24576
    ds_read_b64_tr_b16 a[106:107], v7 offset:25088
    v_mfma_f32_32x32x16_bf16 v[80:95], a[116:119], v[236:239], v[80:95]
    ds_read_b64_tr_b16 a[108:109], v8 offset:24576
    ds_read_b64_tr_b16 a[110:111], v8 offset:25088
    s_waitcnt lgkmcnt(6)
    v_mfma_f32_32x32x16_bf16 v[96:111], a[120:123], v[236:239], v[96:111]
    ds_read_b64_tr_b16 a[112:113], v5 offset:26624
    ds_read_b64_tr_b16 a[114:115], v5 offset:27136
    v_mfma_f32_32x32x16_bf16 v[112:127], a[124:127], v[236:239], v[112:127]
    ds_read_b64_tr_b16 a[116:117], v6 offset:26624
    ds_read_b64_tr_b16 a[118:119], v6 offset:27136
    v_mfma_f32_32x32x16_bf16 v[64:79], a[96:99], v[240:243], v[64:79]
    ds_read_b64_tr_b16 a[120:121], v7 offset:26624
    ds_read_b64_tr_b16 a[122:123], v7 offset:27136
    s_waitcnt lgkmcnt(6)
    v_mfma_f32_32x32x16_bf16 v[80:95], a[100:103], v[240:243], v[80:95]
    ds_read_b64_tr_b16 a[124:125], v8 offset:26624
    ds_read_b64_tr_b16 a[126:127], v8 offset:27136
    v_mfma_f32_32x32x16_bf16 v[96:111], a[104:107], v[240:243], v[96:111]
    ds_read_b64_tr_b16 a[96:97], v5 offset:28672
    ds_read_b64_tr_b16 a[98:99], v5 offset:29184
    v_mfma_f32_32x32x16_bf16 v[112:127], a[108:111], v[240:243], v[112:127]
    ds_read_b64_tr_b16 a[100:101], v6 offset:28672
    ds_read_b64_tr_b16 a[102:103], v6 offset:29184
    s_waitcnt lgkmcnt(6)
    v_mfma_f32_32x32x16_bf16 v[64:79], a[112:115], v[244:247], v[64:79]
    ds_read_b64_tr_b16 a[104:105], v7 offset:28672
    ds_read_b64_tr_b16 a[106:107], v7 offset:29184
    v_mfma_f32_32x32x16_bf16 v[80:95], a[116:119], v[244:247], v[80:95]
    ds_read_b64_tr_b16 a[108:109], v8 offset:28672
    ds_read_b64_tr_b16 a[110:111], v8 offset:29184
    v_mfma_f32_32x32x16_bf16 v[96:111], a[120:123], v[244:247], v[96:111]
    ds_read_b64_tr_b16 a[112:113], v5 offset:30720
    ds_read_b64_tr_b16 a[114:115], v5 offset:31232
    buffer_load_dword v11, v29, s[28:31], 0 offen sc1
    s_waitcnt lgkmcnt(6)
    v_mfma_f32_32x32x16_bf16 v[112:127], a[124:127], v[244:247], v[112:127]
    ds_read_b64_tr_b16 a[116:117], v6 offset:30720
    ds_read_b64_tr_b16 a[118:119], v6 offset:31232
    v_mfma_f32_32x32x16_bf16 v[64:79], a[96:99], v[248:251], v[64:79]
    ds_read_b64_tr_b16 a[120:121], v7 offset:30720
    ds_read_b64_tr_b16 a[122:123], v7 offset:31232
    v_mfma_f32_32x32x16_bf16 v[80:95], a[100:103], v[248:251], v[80:95]
    ds_read_b64_tr_b16 a[124:125], v8 offset:30720
    ds_read_b64_tr_b16 a[126:127], v8 offset:31232
    s_waitcnt lgkmcnt(6)
    v_mfma_f32_32x32x16_bf16 v[96:111], a[104:107], v[248:251], v[96:111]
    v_mfma_f32_32x32x16_bf16 v[112:127], a[108:111], v[248:251], v[112:127]
    v_mfma_f32_32x32x16_bf16 v[64:79], a[112:115], v[252:255], v[64:79]
    s_waitcnt lgkmcnt(0)
    v_mfma_f32_32x32x16_bf16 v[80:95], a[116:119], v[252:255], v[80:95]
    v_mfma_f32_32x32x16_bf16 v[96:111], a[120:123], v[252:255], v[96:111]
    v_mfma_f32_32x32x16_bf16 v[112:127], a[124:127], v[252:255], v[112:127]
    s_waitcnt vmcnt(0)
    v_cmp_ne_u32 vcc, 1, v11
    s_nop 4
    s_cbranch_vccnz L_hspinB
L_hokB:
    v_max_f32 v64, 0, v64
    v_max_f32 v65, 0, v65
    v_max_f32 v66, 0, v66
    v_max_f32 v67, 0, v67
    v_max_f32 v68, 0, v68
    v_max_f32 v69, 0, v69
    v_max_f32 v70, 0, v70
    v_max_f32 v71, 0, v71
    v_mul_f32 v64, v64, v72
    v_mul_f32 v65, v65, v73
    v_mul_f32 v66, v66, v74
    v_mul_f32 v67, v67, v75
    v_mul_f32 v68, v68, v76
    v_mul_f32 v69, v69, v77
    s_add_u32 s65, s55, s75
    s_add_u32 s66, s56, s75
    buffer_load_dwordx4 a[0:3], v0, s[28:31], s65 offen offset:0 sc1
    v_mul_f32 v70, v70, v78
    v_mul_f32 v71, v71, v79
    v_cvt_pk_bf16_f32 v72, v64, v65
    v_cvt_pk_bf16_f32 v73, v66, v67
    v_cvt_pk_bf16_f32 v74, v68, v69
    v_cvt_pk_bf16_f32 v75, v70, v71
    v_max_f32 v80, 0, v80
    v_max_f32 v81, 0, v81
    v_max_f32 v82, 0, v82
    v_max_f32 v83, 0, v83
    v_max_f32 v84, 0, v84
    v_max_f32 v85, 0, v85
    v_max_f32 v86, 0, v86
    v_max_f32 v87, 0, v87
    buffer_load_dwordx4 a[4:7], v0, s[28:31], s66 offen offset:0 sc1
    v_mul_f32 v80, v80, v88
    v_mul_f32 v81, v81, v89
    v_mul_f32 v82, v82, v90
    v_mul_f32 v83, v83, v91
    v_mul_f32 v84, v84, v92
    v_mul_f32 v85, v85, v93
    v_mul_f32 v86, v86, v94
    v_mul_f32 v87, v87, v95
    v_cvt_pk_bf16_f32 v88, v80, v81
    v_cvt_pk_bf16_f32 v89, v82, v83
    v_cvt_pk_bf16_f32 v90, v84, v85
    v_cvt_pk_bf16_f32 v91, v86, v87
    v_max_f32 v96, 0, v96
    v_max_f32 v97, 0, v97
    buffer_load_dwordx4 a[8:11], v0, s[28:31], s65 offen offset:1024 sc1
    v_max_f32 v98, 0, v98
    v_max_f32 v99, 0, v99
    v_max_f32 v100, 0, v100
    v_max_f32 v101, 0, v101
    v_max_f32 v102, 0, v102
    v_max_f32 v103, 0, v103
    v_mul_f32 v96, v96, v104
    v_mul_f32 v97, v97, v105
    v_mul_f32 v98, v98, v106
    v_mul_f32 v99, v99, v107
    v_mul_f32 v100, v100, v108
    v_mul_f32 v101, v101, v109
    v_mul_f32 v102, v102, v110
    v_mul_f32 v103, v103, v111
    buffer_load_dwordx4 a[12:15], v0, s[28:31], s66 offen offset:1024 sc1
    v_cvt_pk_bf16_f32 v104, v96, v97
    v_cvt_pk_bf16_f32 v105, v98, v99
    v_cvt_pk_bf16_f32 v106, v100, v101
    v_cvt_pk_bf16_f32 v107, v102, v103
    v_max_f32 v112, 0, v112
    v_max_f32 v113, 0, v113
    v_max_f32 v114, 0, v114
    v_max_f32 v115, 0, v115
    v_max_f32 v116, 0, v116
    v_max_f32 v117, 0, v117
    v_max_f32 v118, 0, v118
    v_max_f32 v119, 0, v119
    v_mul_f32 v112, v112, v120
    v_mul_f32 v113, v113, v121
    buffer_load_dwordx4 a[16:19], v0, s[28:31], s65 offen offset:2048 sc1
    v_mul_f32 v114, v114, v122
    v_mul_f32 v115, v115, v123
    v_mul_f32 v116, v116, v124
    v_mul_f32 v117, v117, v125
    v_mul_f32 v118, v118, v126
    v_mul_f32 v119, v119, v127
    v_cvt_pk_bf16_f32 v120, v112, v113
    v_cvt_pk_bf16_f32 v121, v114, v115
    v_cvt_pk_bf16_f32 v122, v116, v117
    v_cvt_pk_bf16_f32 v123, v118, v119
    buffer_store_dwordx4 v[72:75], v0, s[28:31], s59 offen offset:0 sc1
    buffer_store_dwordx4 v[88:91], v0, s[28:31], s59 offen offset:1024 sc1
    buffer_store_dwordx4 v[104:107], v0, s[28:31], s59 offen offset:2048 sc1
    buffer_store_dwordx4 v[120:123], v0, s[28:31], s59 offen offset:3072 sc1
    s_waitcnt lgkmcnt(0)
    s_barrier
    v_and_b32 v12, 0x1f0, v0
    v_lshlrev_b32 v12, 2, v12
    v_lshrrev_b32 v13, 9, v0
    v_lshl_add_u32 v12, v13, 3, v12
    v_bfe_u32 v13, v0, 6, 2
    v_lshl_add_u32 v12, v13, 4, v12
    v_add_u32 v12, s61, v12
    v_xor_b32 v13, 16, v12
    v_xor_b32 v14, 32, v12
    v_xor_b32 v15, 48, v12
    ds_read_b64 v[64:65], v12 offset:14336
    ds_read_b64 v[66:67], v13 offset:14336
    ds_read_b64 v[68:69], v14 offset:14336
    ds_read_b64 v[70:71], v15 offset:14336
    s_waitcnt lgkmcnt(0)
    v_lshlrev_b32 v32, 16, v64
    v_and_b32 v33, s62, v64
    v_lshlrev_b32 v34, 16, v65
    v_and_b32 v35, s62, v65
    v_lshlrev_b32 v36, 16, v66
    v_and_b32 v37, s62, v66
    v_lshlrev_b32 v38, 16, v67
    v_and_b32 v39, s62, v67
    v_lshlrev_b32 v40, 16, v68
    v_and_b32 v41, s62, v68
    v_lshlrev_b32 v42, 16, v69
    v_and_b32 v43, s62, v69
    v_lshlrev_b32 v44, 16, v70
    v_and_b32 v45, s62, v70
    v_lshlrev_b32 v46, 16, v71
    v_and_b32 v47, s62, v71
    s_nop 1
    buffer_load_dwordx4 a[20:23], v0, s[28:31], s66 offen offset:2048 sc1
    buffer_load_dwordx4 a[24:27], v0, s[28:31], s65 offen offset:3072 sc1
    buffer_load_dwordx4 a[28:31], v0, s[28:31], s66 offen offset:3072 sc1
    s_add_u32 s65, s55, s76
    s_add_u32 s66, s56, s76
    buffer_load_dwordx4 a[32:35], v0, s[28:31], s65 offen offset:0 sc1
    buffer_load_dwordx4 a[36:39], v0, s[28:31], s66 offen offset:0 sc1
    s_waitcnt vmcnt(12)
    v_mfma_f32_32x32x16_bf16 v[32:47], a[128:131], a[0:3], v[32:47]
    v_mfma_f32_32x32x16_bf16 v[48:63], a[132:135], a[0:3], 0
    buffer_load_dwordx4 a[40:43], v0, s[28:31], s65 offen offset:1024 sc1
    v_mfma_f32_32x32x16_bf16 v[64:79], a[128:131], a[4:7], 0
    v_mfma_f32_32x32x16_bf16 v[80:95], a[132:135], a[4:7], 0
    buffer_load_dwordx4 a[44:47], v0, s[28:31], s66 offen offset:1024 sc1
    s_waitcnt vmcnt(12)
    v_mfma_f32_32x32x16_bf16 v[32:47], a[136:139], a[8:11], v[32:47]
    buffer_load_dwordx4 a[48:51], v0, s[28:31], s65 offen offset:2048 sc1
    v_mfma_f32_32x32x16_bf16 v[48:63], a[140:143], a[8:11], v[48:63]
    v_mfma_f32_32x32x16_bf16 v[64:79], a[136:139], a[12:15], v[64:79]
    buffer_load_dwordx4 a[52:55], v0, s[28:31], s66 offen offset:2048 sc1
    v_mfma_f32_32x32x16_bf16 v[80:95], a[140:143], a[12:15], v[80:95]
    buffer_load_dwordx4 a[56:59], v0, s[28:31], s65 offen offset:3072 sc1
    s_waitcnt vmcnt(9)
    v_mfma_f32_32x32x16_bf16 v[32:47], a[144:147], a[16:19], v[32:47]
    v_mfma_f32_32x32x16_bf16 v[48:63], a[148:151], a[16:19], v[48:63]
    buffer_store_dword v10, v9, s[28:31], 0 offen offset:128 sc1
    v_mfma_f32_32x32x16_bf16 v[64:79], a[144:147], a[20:23], v[64:79]
    buffer_load_dwordx4 a[60:63], v0, s[28:31], s66 offen offset:3072 sc1
    v_mfma_f32_32x32x16_bf16 v[80:95], a[148:151], a[20:23], v[80:95]
    s_waitcnt vmcnt(9)
    v_mfma_f32_32x32x16_bf16 v[32:47], a[152:155], a[24:27], v[32:47]
    s_add_u32 s65, s55, s77
    s_add_u32 s66, s56, s77
    buffer_load_dwordx4 a[64:67], v0, s[28:31], s65 offen offset:0 sc1
    v_mfma_f32_32x32x16_bf16 v[48:63], a[156:159], a[24:27], v[48:63]
    buffer_load_dwordx4 a[68:71], v0, s[28:31], s66 offen offset:0 sc1
    v_mfma_f32_32x32x16_bf16 v[64:79], a[152:155], a[28:31], v[64:79]
    v_mfma_f32_32x32x16_bf16 v[80:95], a[156:159], a[28:31], v[80:95]
    buffer_load_dwordx4 a[72:75], v0, s[28:31], s65 offen offset:1024 sc1
    s_waitcnt vmcnt(10)
    v_mfma_f32_32x32x16_bf16 v[32:47], a[160:163], a[32:35], v[32:47]
    buffer_load_dwordx4 a[76:79], v0, s[28:31], s66 offen offset:1024 sc1
    v_mfma_f32_32x32x16_bf16 v[48:63], a[164:167], a[32:35], v[48:63]
    v_mfma_f32_32x32x16_bf16 v[64:79], a[160:163], a[36:39], v[64:79]
    buffer_load_dwordx4 a[80:83], v0, s[28:31], s65 offen offset:2048 sc1
    v_mfma_f32_32x32x16_bf16 v[80:95], a[164:167], a[36:39], v[80:95]
    buffer_load_dwordx4 a[84:87], v0, s[28:31], s66 offen offset:2048 sc1
    s_waitcnt vmcnt(11)
    v_mfma_f32_32x32x16_bf16 v[32:47], a[168:171], a[40:43], v[32:47]
    v_mfma_f32_32x32x16_bf16 v[48:63], a[172:175], a[40:43], v[48:63]
    buffer_load_dwordx4 a[88:91], v0, s[28:31], s65 offen offset:3072 sc1
    v_mfma_f32_32x32x16_bf16 v[64:79], a[168:171], a[44:47], v[64:79]
    v_mfma_f32_32x32x16_bf16 v[80:95], a[172:175], a[44:47], v[80:95]
    buffer_load_dwordx4 a[92:95], v0, s[28:31], s66 offen offset:3072 sc1
    s_waitcnt vmcnt(11)
    v_mfma_f32_32x32x16_bf16 v[32:47], a[176:179], a[48:51], v[32:47]
    s_add_u32 s65, s55, s78
    s_add_u32 s66, s56, s78
    buffer_load_dwordx4 v[96:99], v0, s[28:31], s65 offen offset:0 sc1
    v_mfma_f32_32x32x16_bf16 v[48:63], a[180:183], a[48:51], v[48:63]
    v_mfma_f32_32x32x16_bf16 v[64:79], a[176:179], a[52:55], v[64:79]
    buffer_load_dwordx4 v[100:103], v0, s[28:31], s66 offen offset:0 sc1
    v_mfma_f32_32x32x16_bf16 v[80:95], a[180:183], a[52:55], v[80:95]
    buffer_load_dwordx4 v[104:107], v0, s[28:31], s65 offen offset:1024 sc1
    s_waitcnt vmcnt(11)
    v_mfma_f32_32x32x16_bf16 v[32:47], a[184:187], a[56:59], v[32:47]
    v_mfma_f32_32x32x16_bf16 v[48:63], a[188:191], a[56:59], v[48:63]
    buffer_load_dwordx4 v[108:111], v0, s[28:31], s66 offen offset:1024 sc1
    v_mfma_f32_32x32x16_bf16 v[64:79], a[184:187], a[60:63], v[64:79]
    buffer_load_dwordx4 v[112:115], v0, s[28:31], s65 offen offset:2048 sc1
    v_mfma_f32_32x32x16_bf16 v[80:95], a[188:191], a[60:63], v[80:95]
    s_waitcnt vmcnt(11)
    v_mfma_f32_32x32x16_bf16 v[32:47], a[192:195], a[64:67], v[32:47]
    buffer_load_dwordx4 v[116:119], v0, s[28:31], s66 offen offset:2048 sc1
    v_mfma_f32_32x32x16_bf16 v[48:63], a[196:199], a[64:67], v[48:63]
    buffer_load_dwordx4 v[120:123], v0, s[28:31], s65 offen offset:3072 sc1
    v_mfma_f32_32x32x16_bf16 v[64:79], a[192:195], a[68:71], v[64:79]
    v_mfma_f32_32x32x16_bf16 v[80:95], a[196:199], a[68:71], v[80:95]
    buffer_load_dwordx4 v[124:127], v0, s[28:31], s66 offen offset:3072 sc1
    s_waitcnt vmcnt(12)
    v_mfma_f32_32x32x16_bf16 v[32:47], a[200:203], a[72:75], v[32:47]
    s_add_u32 s65, s55, s79
    s_add_u32 s66, s56, s79
    buffer_load_dwordx4 v[128:131], v0, s[28:31], s65 offen offset:0 sc1
    v_mfma_f32_32x32x16_bf16 v[48:63], a[204:207], a[72:75], v[48:63]
    v_mfma_f32_32x32x16_bf16 v[64:79], a[200:203], a[76:79], v[64:79]
    buffer_load_dwordx4 v[132:135], v0, s[28:31], s66 offen offset:0 sc1
    v_mfma_f32_32x32x16_bf16 v[80:95], a[204:207], a[76:79], v[80:95]
    buffer_load_dwordx4 v[136:139], v0, s[28:31], s65 offen offset:1024 sc1
    s_waitcnt vmcnt(13)
    v_mfma_f32_32x32x16_bf16 v[32:47], a[208:211], a[80:83], v[32:47]
    v_mfma_f32_32x32x16_bf16 v[48:63], a[212:215], a[80:83], v[48:63]
    buffer_load_dword v11, v29, s[28:31], 0 offen offset:128 sc1
    v_mfma_f32_32x32x16_bf16 v[64:79], a[208:211], a[84:87], v[64:79]
    v_mfma_f32_32x32x16_bf16 v[80:95], a[212:215], a[84:87], v[80:95]
    buffer_load_dwordx4 v[140:143], v0, s[28:31], s66 offen offset:1024 sc1
    s_waitcnt vmcnt(13)
    v_mfma_f32_32x32x16_bf16 v[32:47], a[216:219], a[88:91], v[32:47]
    buffer_load_dwordx4 v[144:147], v0, s[28:31], s65 offen offset:2048 sc1
    v_mfma_f32_32x32x16_bf16 v[48:63], a[220:223], a[88:91], v[48:63]
    v_mfma_f32_32x32x16_bf16 v[64:79], a[216:219], a[92:95], v[64:79]
    buffer_load_dwordx4 v[148:151], v0, s[28:31], s66 offen offset:2048 sc1
    v_mfma_f32_32x32x16_bf16 v[80:95], a[220:223], a[92:95], v[80:95]
    buffer_load_dwordx4 v[152:155], v0, s[28:31], s65 offen offset:3072 sc1
    s_waitcnt vmcnt(14)
    v_mfma_f32_32x32x16_bf16 v[32:47], a[224:227], v[96:99], v[32:47]
    v_mfma_f32_32x32x16_bf16 v[48:63], a[228:231], v[96:99], v[48:63]
    buffer_load_dwordx4 v[156:159], v0, s[28:31], s66 offen offset:3072 sc1
    v_mfma_f32_32x32x16_bf16 v[64:79], a[224:227], v[100:103], v[64:79]
    s_add_u32 m0, s61, 30720
    s_add_u32 s63, s53, 376832
    buffer_load_dwordx4 v24, s[20:23], s63 offen offset:0 lds
    v_mfma_f32_32x32x16_bf16 v[80:95], a[228:231], v[100:103], v[80:95]
    s_waitcnt vmcnt(14)
    v_mfma_f32_32x32x16_bf16 v[32:47], a[232:235], v[104:107], v[32:47]
    buffer_load_dwordx4 v25, s[20:23], s63 offen offset:1024 lds
    v_mfma_f32_32x32x16_bf16 v[48:63], a[236:239], v[104:107], v[48:63]
    s_add_u32 m0, s61, 16384
    s_add_u32 s63, s54, 0
    buffer_load_dwordx4 v24, s[24:27], s63 offen offset:0 lds
    v_mfma_f32_32x32x16_bf16 v[64:79], a[232:235], v[108:111], v[64:79]
    v_mfma_f32_32x32x16_bf16 v[80:95], a[236:239], v[108:111], v[80:95]
    buffer_load_dwordx4 v25, s[24:27], s63 offen offset:1024 lds
    s_waitcnt vmcnt(9)
    v_cmp_ne_u32 vcc, 1, v11
    s_nop 4
    s_and_b32 vcc_lo, vcc_lo, 0x0f0f0f0f
    s_cbranch_scc1 L_mspinB
L_mokB:
    v_mfma_f32_32x32x16_bf16 v[32:47], a[240:243], v[112:115], v[32:47]
    ds_read_b64_tr_b16 a[96:97], v26 offset:32768
    ds_read_b64_tr_b16 a[98:99], v26 offset:33792
    ds_read_b64_tr_b16 a[100:101], v27 offset:32768
    ds_read_b64_tr_b16 a[102:103], v27 offset:33792
    v_mfma_f32_32x32x16_bf16 v[48:63], a[244:247], v[112:115], v[48:63]
    s_add_u32 s65, s55, 8192
    s_add_u32 s66, s56, 8192
    buffer_load_dwordx4 v[160:163], v0, s[28:31], s65 offen offset:0 sc1
    v_mfma_f32_32x32x16_bf16 v[64:79], a[240:243], v[116:119], v[64:79]
    buffer_load_dwordx4 v[164:167], v0, s[28:31], s66 offen offset:0 sc1
    v_mfma_f32_32x32x16_bf16 v[80:95], a[244:247], v[116:119], v[80:95]
    buffer_load_dwordx4 v[168:171], v0, s[28:31], s65 offen offset:1024 sc1
    v_mfma_f32_32x32x16_bf16 v[32:47], a[248:251], v[120:123], v[32:47]
    ds_read_b64_tr_b16 a[104:105], v26 offset:34816
    ds_read_b64_tr_b16 a[106:107], v26 offset:35840
    ds_read_b64_tr_b16 a[108:109], v27 offset:34816
    ds_read_b64_tr_b16 a[110:111], v27 offset:35840
    v_mfma_f32_32x32x16_bf16 v[48:63], a[252:255], v[120:123], v[48:63]
    buffer_load_dwordx4 v[172:175], v0, s[28:31], s66 offen offset:1024 sc1
    v_mfma_f32_32x32x16_bf16 v[64:79], a[248:251], v[124:127], v[64:79]
    v_mfma_f32_32x32x16_bf16 v[80:95], a[252:255], v[124:127], v[80:95]
    buffer_load_dwordx4 v[176:179], v0, s[28:31], s65 offen offset:2048 sc1
    s_waitcnt lgkmcnt(4)
    v_mfma_f32_32x32x16_bf16 v[32:47], a[96:99], v[128:131], v[32:47]
    ds_read_b64_tr_b16 a[112:113], v26 offset:36864
    ds_read_b64_tr_b16 a[114:115], v26 offset:37888
    ds_read_b64_tr_b16 a[116:117], v27 offset:36864
    ds_read_b64_tr_b16 a[118:119], v27 offset:37888
    v_mfma_f32_32x32x16_bf16 v[48:63], a[100:103], v[128:131], v[48:63]
    buffer_load_dwordx4 v[180:183], v0, s[28:31], s66 offen offset:2048 sc1
    v_mfma_f32_32x32x16_bf16 v[64:79], a[96:99], v[132:135], v[64:79]
    buffer_load_dwordx4 v[184:187], v0, s[28:31], s65 offen offset:3072 sc1
    v_mfma_f32_32x32x16_bf16 v[80:95], a[100:103], v[132:135], v[80:95]
    buffer_load_dwordx4 v[188:191], v0, s[28:31], s66 offen offset:3072 sc1
    s_waitcnt vmcnt(16) lgkmcnt(4)
    v_mfma_f32_32x32x16_bf16 v[32:47], a[104:107], v[136:139], v[32:47]
    ds_read_b64_tr_b16 a[120:121], v26 offset:38912
    ds_read_b64_tr_b16 a[122:123], v26 offset:39936
    ds_read_b64_tr_b16 a[124:125], v27 offset:38912
    ds_read_b64_tr_b16 a[126:127], v27 offset:39936
    v_mfma_f32_32x32x16_bf16 v[48:63], a[108:111], v[136:139], v[48:63]
    s_add_u32 s65, s55, 20480
    s_add_u32 s66, s56, 20480
    buffer_load_dwordx4 v[192:195], v0, s[28:31], s65 offen offset:0 sc1
    v_mfma_f32_32x32x16_bf16 v[64:79], a[104:107], v[140:143], v[64:79]
    buffer_load_dwordx4 v[196:199], v0, s[28:31], s66 offen offset:0 sc1
    v_mfma_f32_32x32x16_bf16 v[80:95], a[108:111], v[140:143], v[80:95]
    s_waitcnt vmcnt(16) lgkmcnt(4)
    v_mfma_f32_32x32x16_bf16 v[32:47], a[112:115], v[144:147], v[32:47]
    ds_read_b64_tr_b16 a[96:97], v26 offset:0
    ds_read_b64_tr_b16 a[98:99], v26 offset:1024
    ds_read_b64_tr_b16 a[100:101], v27 offset:0
    ds_read_b64_tr_b16 a[102:103], v27 offset:1024
    v_mfma_f32_32x32x16_bf16 v[48:63], a[116:119], v[144:147], v[48:63]
    buffer_load_dwordx4 v[200:203], v0, s[28:31], s65 offen offset:1024 sc1
    v_mfma_f32_32x32x16_bf16 v[64:79], a[112:115], v[148:151], v[64:79]
    buffer_load_dwordx4 v[204:207], v0, s[28:31], s66 offen offset:1024 sc1
    v_mfma_f32_32x32x16_bf16 v[80:95], a[116:119], v[148:151], v[80:95]
    buffer_load_dwordx4 v[208:211], v0, s[28:31], s65 offen offset:2048 sc1
    s_waitcnt vmcnt(17) lgkmcnt(4)
    v_mfma_f32_32x32x16_bf16 v[32:47], a[120:123], v[152:155], v[32:47]
    ds_read_b64_tr_b16 a[104:105], v26 offset:2048
    ds_read_b64_tr_b16 a[106:107], v26 offset:3072
    ds_read_b64_tr_b16 a[108:109], v27 offset:2048
    ds_read_b64_tr_b16 a[110:111], v27 offset:3072
    v_mfma_f32_32x32x16_bf16 v[48:63], a[124:127], v[152:155], v[48:63]
    buffer_load_dword v11, v29, s[28:31], 0 offen offset:128 sc1
    v_mfma_f32_32x32x16_bf16 v[64:79], a[120:123], v[156:159], v[64:79]
    buffer_load_dwordx4 v[212:215], v0, s[28:31], s66 offen offset:2048 sc1
    v_mfma_f32_32x32x16_bf16 v[80:95], a[124:127], v[156:159], v[80:95]
    buffer_load_dwordx4 v[216:219], v0, s[28:31], s65 offen offset:3072 sc1
    s_waitcnt vmcnt(14) lgkmcnt(4)
    v_mfma_f32_32x32x16_bf16 v[32:47], a[96:99], v[160:163], v[32:47]
    ds_read_b64_tr_b16 a[112:113], v26 offset:4096
    ds_read_b64_tr_b16 a[114:115], v26 offset:5120
    ds_read_b64_tr_b16 a[116:117], v27 offset:4096
    ds_read_b64_tr_b16 a[118:119], v27 offset:5120
    v_mfma_f32_32x32x16_bf16 v[48:63], a[100:103], v[160:163], v[48:63]
    buffer_load_dwordx4 v[220:223], v0, s[28:31], s66 offen offset:3072 sc1
    v_mfma_f32_32x32x16_bf16 v[64:79], a[96:99], v[164:167], v[64:79]
    v_mfma_f32_32x32x16_bf16 v[80:95], a[100:103], v[164:167], v[80:95]
    s_add_u32 s63, s63, 14336
    buffer_load_dwordx4 v24, s[24:27], s63 offen offset:2048 lds
    s_waitcnt vmcnt(14) lgkmcnt(4)
    v_mfma_f32_32x32x16_bf16 v[32:47], a[104:107], v[168:171], v[32:47]
    ds_read_b64_tr_b16 a[120:121], v26 offset:6144
    ds_read_b64_tr_b16 a[122:123], v26 offset:7168
    ds_read_b64_tr_b16 a[124:125], v27 offset:6144
    ds_read_b64_tr_b16 a[126:127], v27 offset:7168
    v_mfma_f32_32x32x16_bf16 v[48:63], a[108:111], v[168:171], v[48:63]
    buffer_load_dwordx4 v25, s[24:27], s63 offen offset:3072 lds
    v_mfma_f32_32x32x16_bf16 v[64:79], a[104:107], v[172:175], v[64:79]
    s_add_u32 m0, s61, 20480
    s_add_u32 s63, s54, 32768
    buffer_load_dwordx4 v24, s[24:27], s63 offen offset:0 lds
    v_mfma_f32_32x32x16_bf16 v[80:95], a[108:111], v[172:175], v[80:95]
    buffer_load_dwordx4 v25, s[24:27], s63 offen offset:1024 lds
    s_waitcnt vmcnt(15) lgkmcnt(4)
    v_mfma_f32_32x32x16_bf16 v[32:47], a[112:115], v[176:179], v[32:47]
    ds_read_b64_tr_b16 a[96:97], v26 offset:8192
    ds_read_b64_tr_b16 a[98:99], v26 offset:9216
    ds_read_b64_tr_b16 a[100:101], v27 offset:8192
    ds_read_b64_tr_b16 a[102:103], v27 offset:9216
    v_mfma_f32_32x32x16_bf16 v[48:63], a[116:119], v[176:179], v[48:63]
    s_add_u32 s63, s63, 14336
    buffer_load_dwordx4 v24, s[24:27], s63 offen offset:2048 lds
    v_mfma_f32_32x32x16_bf16 v[64:79], a[112:115], v[180:183], v[64:79]
    buffer_load_dwordx4 v25, s[24:27], s63 offen offset:3072 lds
    v_mfma_f32_32x32x16_bf16 v[80:95], a[116:119], v[180:183], v[80:95]
    s_waitcnt vmcnt(9)
    v_cmp_ne_u32 vcc, 1, v11
    s_nop 4
    s_and_b32 vcc_lo, vcc_lo, 0xf0f0f0f0
    s_cbranch_scc1 L_ospinB
L_ookB:
    s_waitcnt lgkmcnt(4)
    v_mfma_f32_32x32x16_bf16 v[32:47], a[120:123], v[184:187], v[32:47]
    ds_read_b64_tr_b16 a[104:105], v26 offset:10240
    ds_read_b64_tr_b16 a[106:107], v26 offset:11264
    ds_read_b64_tr_b16 a[108:109], v27 offset:10240
    ds_read_b64_tr_b16 a[110:111], v27 offset:11264
    v_mfma_f32_32x32x16_bf16 v[48:63], a[124:127], v[184:187], v[48:63]
    buffer_load_dwordx4 v[224:227], v0, s[28:31], s57 offen offset:0 sc1
    v_mfma_f32_32x32x16_bf16 v[64:79], a[120:123], v[188:191], v[64:79]
    buffer_load_dwordx4 v[228:231], v0, s[28:31], s58 offen offset:0 sc1
    v_mfma_f32_32x32x16_bf16 v[80:95], a[124:127], v[188:191], v[80:95]
    buffer_load_dwordx4 v[232:235], v0, s[28:31], s57 offen offset:1024 sc1
    s_waitcnt lgkmcnt(4)
    v_mfma_f32_32x32x16_bf16 v[32:47], a[96:99], v[192:195], v[32:47]
    ds_read_b64_tr_b16 a[112:113], v26 offset:12288
    ds_read_b64_tr_b16 a[114:115], v26 offset:13312
    ds_read_b64_tr_b16 a[116:117], v27 offset:12288
    ds_read_b64_tr_b16 a[118:119], v27 offset:13312
    v_mfma_f32_32x32x16_bf16 v[48:63], a[100:103], v[192:195], v[48:63]
    buffer_load_dwordx4 v[236:239], v0, s[28:31], s58 offen offset:1024 sc1
    v_mfma_f32_32x32x16_bf16 v[64:79], a[96:99], v[196:199], v[64:79]
    buffer_load_dwordx4 v[240:243], v0, s[28:31], s57 offen offset:2048 sc1
    v_mfma_f32_32x32x16_bf16 v[80:95], a[100:103], v[196:199], v[80:95]
    buffer_load_dwordx4 v[244:247], v0, s[28:31], s58 offen offset:2048 sc1
    s_waitcnt lgkmcnt(4)
    v_mfma_f32_32x32x16_bf16 v[32:47], a[104:107], v[200:203], v[32:47]
    ds_read_b64_tr_b16 a[120:121], v26 offset:30720
    ds_read_b64_tr_b16 a[122:123], v26 offset:31744
    ds_read_b64_tr_b16 a[124:125], v27 offset:30720
    ds_read_b64_tr_b16 a[126:127], v27 offset:31744
    v_mfma_f32_32x32x16_bf16 v[48:63], a[108:111], v[200:203], v[48:63]
    s_add_u32 m0, s61, 24576
    s_add_u32 s63, s54, 65536
    buffer_load_dwordx4 v24, s[24:27], s63 offen offset:0 lds
    v_mfma_f32_32x32x16_bf16 v[64:79], a[104:107], v[204:207], v[64:79]
    v_mfma_f32_32x32x16_bf16 v[80:95], a[108:111], v[204:207], v[80:95]
    buffer_load_dwordx4 v25, s[24:27], s63 offen offset:1024 lds
    s_waitcnt vmcnt(16) lgkmcnt(4)
    v_mfma_f32_32x32x16_bf16 v[32:47], a[112:115], v[208:211], v[32:47]
    ds_read_b64_tr_b16 a[96:97], v26 offset:16384
    ds_read_b64_tr_b16 a[98:99], v26 offset:17408
    ds_read_b64_tr_b16 a[100:101], v27 offset:16384
    ds_read_b64_tr_b16 a[102:103], v27 offset:17408
    v_add_u32 v12, s61, v0
    s_xor_b32 s72, s3, 1
    s_mul_i32 s72, s72, 40960
    v_mfma_f32_32x32x16_bf16 v[48:63], a[116:119], v[208:211], v[48:63]
    buffer_load_dwordx4 v[248:251], v0, s[28:31], s57 offen offset:3072 sc1
    v_add_u32 v13, s72, v0
    s_xor_b32 s72, s3, 2
    s_mul_i32 s72, s72, 40960
    v_mfma_f32_32x32x16_bf16 v[64:79], a[112:115], v[212:215], v[64:79]
    buffer_load_dwordx4 v[252:255], v0, s[28:31], s58 offen offset:3072 sc1
    v_add_u32 v14, s72, v0
    s_xor_b32 s72, s3, 3
    s_mul_i32 s72, s72, 40960
    v_mfma_f32_32x32x16_bf16 v[80:95], a[116:119], v[212:215], v[80:95]
    s_add_u32 s63, s63, 14336
    buffer_load_dwordx4 v24, s[24:27], s63 offen offset:2048 lds
    v_add_u32 v15, s72, v0
    v_and_b32 v17, 0x1f0, v0
    v_lshlrev_b32 v17, 6, v17
    s_waitcnt vmcnt(17) lgkmcnt(4)
    v_mfma_f32_32x32x16_bf16 v[32:47], a[120:123], v[216:219], v[32:47]
    s_waitcnt vmcnt(15)
    ds_read_b64_tr_b16 a[104:105], v26 offset:18432
    ds_read_b64_tr_b16 a[106:107], v26 offset:19456
    ds_read_b64_tr_b16 a[108:109], v27 offset:18432
    ds_read_b64_tr_b16 a[110:111], v27 offset:19456
    v_lshrrev_b32 v18, 9, v0
    v_lshl_add_u32 v16, v18, 4, v17
    v_mfma_f32_32x32x16_bf16 v[48:63], a[124:127], v[216:219], v[48:63]
    buffer_load_dwordx4 v25, s[24:27], s63 offen offset:3072 lds
    v_mfma_f32_32x32x16_bf16 v[64:79], a[120:123], v[220:223], v[64:79]
    s_add_u32 s57, s57, 4096
    s_add_u32 s58, s58, 4096
    buffer_load_dwordx4 a[0:3], v0, s[28:31], s57 offen offset:0 sc1
    v_mfma_f32_32x32x16_bf16 v[80:95], a[124:127], v[220:223], v[80:95]
    buffer_load_dwordx4 a[4:7], v0, s[28:31], s58 offen offset:0 sc1
    s_waitcnt vmcnt(12) lgkmcnt(4)
    v_mfma_f32_32x32x16_bf16 v[32:47], a[96:99], v[224:227], v[32:47]
    ds_read_b64_tr_b16 a[112:113], v26 offset:20480
    ds_read_b64_tr_b16 a[114:115], v26 offset:21504
    ds_read_b64_tr_b16 a[116:117], v27 offset:20480
    ds_read_b64_tr_b16 a[118:119], v27 offset:21504
    v_mfma_f32_32x32x16_bf16 v[48:63], a[100:103], v[224:227], v[48:63]
    s_add_u32 m0, s61, 28672
    s_add_u32 s63, s54, 98304
    buffer_load_dwordx4 v24, s[24:27], s63 offen offset:0 lds
    v_mfma_f32_32x32x16_bf16 v[64:79], a[96:99], v[228:231], v[64:79]
    buffer_load_dwordx4 v25, s[24:27], s63 offen offset:1024 lds
    v_mfma_f32_32x32x16_bf16 v[80:95], a[100:103], v[228:231], v[80:95]
    buffer_load_dwordx4 a[8:11], v0, s[28:31], s57 offen offset:1024 sc1
    buffer_load_dwordx4 a[12:15], v0, s[28:31], s58 offen offset:1024 sc1
    s_waitcnt vmcnt(14) lgkmcnt(4)
    v_mfma_f32_32x32x16_bf16 v[32:47], a[104:107], v[232:235], v[32:47]
    ds_read_b64_tr_b16 a[120:121], v26 offset:22528
    ds_read_b64_tr_b16 a[122:123], v26 offset:23552
    ds_read_b64_tr_b16 a[124:125], v27 offset:22528
    ds_read_b64_tr_b16 a[126:127], v27 offset:23552
    v_mfma_f32_32x32x16_bf16 v[48:63], a[108:111], v[232:235], v[48:63]
    s_add_u32 m0, s61, 32768
    s_add_u32 s63, s54, 114688
    buffer_load_dwordx4 v24, s[24:27], s63 offen offset:0 lds
    v_mfma_f32_32x32x16_bf16 v[64:79], a[104:107], v[236:239], v[64:79]
    buffer_load_dwordx4 v25, s[24:27], s63 offen offset:1024 lds
    v_mfma_f32_32x32x16_bf16 v[80:95], a[108:111], v[236:239], v[80:95]
    buffer_load_dwordx4 a[16:19], v0, s[28:31], s57 offen offset:2048 sc1
    buffer_load_dwordx4 a[20:23], v0, s[28:31], s58 offen offset:2048 sc1
    s_waitcnt vmcnt(16) lgkmcnt(4)
    v_mfma_f32_32x32x16_bf16 v[32:47], a[112:115], v[240:243], v[32:47]
    s_waitcnt vmcnt(14)
    ds_read_b64_tr_b16 a[96:97], v26 offset:24576
    ds_read_b64_tr_b16 a[98:99], v26 offset:25600
    ds_read_b64_tr_b16 a[100:101], v27 offset:24576
    ds_read_b64_tr_b16 a[102:103], v27 offset:25600
    v_mfma_f32_32x32x16_bf16 v[48:63], a[116:119], v[240:243], v[48:63]
    buffer_load_dwordx4 a[24:27], v0, s[28:31], s57 offen offset:3072 sc1
    v_mfma_f32_32x32x16_bf16 v[64:79], a[112:115], v[244:247], v[64:79]
    v_mfma_f32_32x32x16_bf16 v[80:95], a[116:119], v[244:247], v[80:95]
    buffer_load_dwordx4 a[28:31], v0, s[28:31], s58 offen offset:3072 sc1
    s_waitcnt vmcnt(14) lgkmcnt(4)
    v_mfma_f32_32x32x16_bf16 v[32:47], a[120:123], v[248:251], v[32:47]
    s_waitcnt vmcnt(12)
    ds_read_b64_tr_b16 a[104:105], v26 offset:26624
    ds_read_b64_tr_b16 a[106:107], v26 offset:27648
    ds_read_b64_tr_b16 a[108:109], v27 offset:26624
    ds_read_b64_tr_b16 a[110:111], v27 offset:27648
    v_mfma_f32_32x32x16_bf16 v[48:63], a[124:127], v[248:251], v[48:63]
    v_mfma_f32_32x32x16_bf16 v[64:79], a[120:123], v[252:255], v[64:79]
    v_mfma_f32_32x32x16_bf16 v[80:95], a[124:127], v[252:255], v[80:95]
    s_waitcnt vmcnt(10) lgkmcnt(4)
    v_mfma_f32_32x32x16_bf16 v[32:47], a[96:99], a[0:3], v[32:47]
    s_waitcnt vmcnt(8)
    ds_read_b64_tr_b16 a[112:113], v26 offset:28672
    ds_read_b64_tr_b16 a[114:115], v26 offset:29696
    ds_read_b64_tr_b16 a[116:117], v27 offset:28672
    ds_read_b64_tr_b16 a[118:119], v27 offset:29696
    v_mfma_f32_32x32x16_bf16 v[48:63], a[100:103], a[0:3], v[48:63]
    v_mfma_f32_32x32x16_bf16 v[64:79], a[96:99], a[4:7], v[64:79]
    v_mfma_f32_32x32x16_bf16 v[80:95], a[100:103], a[4:7], v[80:95]
    s_waitcnt vmcnt(6) lgkmcnt(4)
    v_mfma_f32_32x32x16_bf16 v[32:47], a[104:107], a[8:11], v[32:47]
    s_waitcnt vmcnt(4)
    ds_read_b64_tr_b16 a[120:121], v26 offset:32768
    ds_read_b64_tr_b16 a[122:123], v26 offset:33792
    ds_read_b64_tr_b16 a[124:125], v27 offset:32768
    ds_read_b64_tr_b16 a[126:127], v27 offset:33792
    v_mfma_f32_32x32x16_bf16 v[48:63], a[108:111], a[8:11], v[48:63]
    v_mfma_f32_32x32x16_bf16 v[64:79], a[104:107], a[12:15], v[64:79]
    v_mfma_f32_32x32x16_bf16 v[80:95], a[108:111], a[12:15], v[80:95]
    s_waitcnt vmcnt(2) lgkmcnt(4)
    v_mfma_f32_32x32x16_bf16 v[32:47], a[112:115], a[16:19], v[32:47]
    v_mfma_f32_32x32x16_bf16 v[48:63], a[116:119], a[16:19], v[48:63]
    v_mfma_f32_32x32x16_bf16 v[64:79], a[112:115], a[20:23], v[64:79]
    v_mfma_f32_32x32x16_bf16 v[80:95], a[116:119], a[20:23], v[80:95]
    s_waitcnt vmcnt(0) lgkmcnt(0)
    v_mfma_f32_32x32x16_bf16 v[48:63], a[124:127], a[24:27], v[48:63]
    v_mfma_f32_32x32x16_bf16 v[64:79], a[120:123], a[28:31], v[64:79]
    v_mfma_f32_32x32x16_bf16 v[80:95], a[124:127], a[28:31], v[80:95]
    v_mfma_f32_32x32x16_bf16 v[32:47], a[120:123], a[24:27], v[32:47]
    s_nop 8
    ds_write_b128 v12, v[48:51] offset:0
    ds_write_b128 v12, v[52:55] offset:1024
    ds_write_b128 v12, v[56:59] offset:2048
    ds_write_b128 v12, v[60:63] offset:3072
    ds_write_b128 v12, v[64:67] offset:4096
    ds_write_b128 v12, v[68:71] offset:5120
    ds_write_b128 v12, v[72:75] offset:6144
    ds_write_b128 v12, v[76:79] offset:7168
    ds_write_b128 v12, v[80:83] offset:8192
    ds_write_b128 v12, v[84:87] offset:9216
    ds_write_b128 v12, v[88:91] offset:10240
    ds_write_b128 v12, v[92:95] offset:11264
    s_waitcnt lgkmcnt(0)
    s_barrier
    ds_read_b128 v[96:99], v13 offset:0
    ds_read_b128 v[100:103], v13 offset:1024
    ds_read_b128 v[104:107], v13 offset:2048
    ds_read_b128 v[108:111], v13 offset:3072
    ds_read_b128 v[112:115], v14 offset:4096
    ds_read_b128 v[116:119], v14 offset:5120
    ds_read_b128 v[120:123], v14 offset:6144
    ds_read_b128 v[124:127], v14 offset:7168
    ds_read_b128 v[128:131], v15 offset:8192
    ds_read_b128 v[132:135], v15 offset:9216
    ds_read_b128 v[136:139], v15 offset:10240
    ds_read_b128 v[140:143], v15 offset:11264
    s_waitcnt lgkmcnt(11)
    v_pk_add_f32 v[32:33], v[32:33], v[96:97]
    v_pk_add_f32 v[34:35], v[34:35], v[98:99]
    s_waitcnt lgkmcnt(10)
    v_pk_add_f32 v[36:37], v[36:37], v[100:101]
    v_pk_add_f32 v[38:39], v[38:39], v[102:103]
    s_waitcnt lgkmcnt(9)
    v_pk_add_f32 v[40:41], v[40:41], v[104:105]
    v_pk_add_f32 v[42:43], v[42:43], v[106:107]
    s_waitcnt lgkmcnt(8)
    v_pk_add_f32 v[44:45], v[44:45], v[108:109]
    v_pk_add_f32 v[46:47], v[46:47], v[110:111]
    s_waitcnt lgkmcnt(7)
    v_pk_add_f32 v[32:33], v[32:33], v[112:113]
    v_pk_add_f32 v[34:35], v[34:35], v[114:115]
    s_waitcnt lgkmcnt(6)
    v_pk_add_f32 v[36:37], v[36:37], v[116:117]
    v_pk_add_f32 v[38:39], v[38:39], v[118:119]
    s_waitcnt lgkmcnt(5)
    v_pk_add_f32 v[40:41], v[40:41], v[120:121]
    v_pk_add_f32 v[42:43], v[42:43], v[122:123]
    s_waitcnt lgkmcnt(4)
    v_pk_add_f32 v[44:45], v[44:45], v[124:125]
    v_pk_add_f32 v[46:47], v[46:47], v[126:127]
    s_waitcnt lgkmcnt(3)
    v_pk_add_f32 v[32:33], v[32:33], v[128:129]
    v_pk_add_f32 v[34:35], v[34:35], v[130:131]
    s_waitcnt lgkmcnt(2)
    v_pk_add_f32 v[36:37], v[36:37], v[132:133]
    v_pk_add_f32 v[38:39], v[38:39], v[134:135]
    s_waitcnt lgkmcnt(1)
    v_pk_add_f32 v[40:41], v[40:41], v[136:137]
    v_pk_add_f32 v[42:43], v[42:43], v[138:139]
    s_waitcnt lgkmcnt(0)
    v_pk_add_f32 v[44:45], v[44:45], v[140:141]
    v_pk_add_f32 v[46:47], v[46:47], v[142:143]
    v_cvt_pk_bf16_f32 v48, v32, v33
    v_cvt_pk_bf16_f32 v49, v34, v35
    v_cvt_pk_bf16_f32 v50, v36, v37
    v_cvt_pk_bf16_f32 v51, v38, v39
    v_cvt_pk_bf16_f32 v52, v40, v41
    v_cvt_pk_bf16_f32 v53, v42, v43
    v_cvt_pk_bf16_f32 v54, v44, v45
    v_cvt_pk_bf16_f32 v55, v46, v47
    s_nop 0
    v_permlane32_swap_b32 v48, v50
    v_permlane32_swap_b32 v49, v51
    v_permlane32_swap_b32 v52, v54
    v_permlane32_swap_b32 v53, v55
    buffer_store_dwordx4 v[48:51], v16, s[32:35], s64 offen offset:0
    buffer_store_dwordx4 v[52:55], v16, s[32:35], s64 offen offset:32
    s_endpgm
L_dbgspinB:
    s_add_u32 s100, s100, 1
    s_cmp_gt_u32 s100, 100000
    s_cbranch_scc1 L_dbgokB
    s_sleep 2
    buffer_load_dword v30, off, s[36:39], s1 sc1
    s_waitcnt vmcnt(0)
    v_readfirstlane_b32 s2, v30
    s_cmp_lg_u32 s2, 0
    s_cbranch_scc0 L_dbgspinB
    s_branch L_dbgokB
L_hspinB:
    s_add_u32 s100, s100, 1
    s_cmp_gt_u32 s100, 100000
    s_cbranch_scc1 L_hokB
    s_sleep 1
    buffer_load_dword v11, v29, s[28:31], 0 offen offset:0 sc1
    s_waitcnt vmcnt(0)
    v_cmp_ne_u32 vcc, 1, v11
    s_nop 4
    s_and_b32 vcc_lo, vcc_lo, 0xffffffff
    s_cbranch_scc1 L_hspinB
    s_branch L_hokB
L_mspinB:
    s_add_u32 s100, s100, 1
    s_cmp_gt_u32 s100, 100000
    s_cbranch_scc1 L_mokB
    s_sleep 1
    buffer_load_dword v11, v29, s[28:31], 0 offen offset:128 sc1
    s_waitcnt vmcnt(0)
    v_cmp_ne_u32 vcc, 1, v11
    s_nop 4
    s_and_b32 vcc_lo, vcc_lo, 0x0f0f0f0f
    s_cbranch_scc1 L_mspinB
    s_branch L_mokB
L_ospinB:
    s_add_u32 s100, s100, 1
    s_cmp_gt_u32 s100, 100000
    s_cbranch_scc1 L_ookB
    s_sleep 1
    buffer_load_dword v11, v29, s[28:31], 0 offen offset:128 sc1
    s_waitcnt vmcnt(0)
    v_cmp_ne_u32 vcc, 1, v11
    s_nop 4
    s_and_b32 vcc_lo, vcc_lo, 0xf0f0f0f0
    s_cbranch_scc1 L_ospinB
    s_branch L_ookB
.p2align 6
L_typeA:
    s_lshr_b32 s0, s5, 2
    s_and_b32 s73, s5, 1
    s_cmp_eq_u32 s3, 1
    s_cselect_b32 s12, s42, s40
    s_cselect_b32 s13, s43, s41
    s_mul_i32 s72, s0, 896
    s_add_u32 s72, s72, 768
    s_lshl_b32 s74, s0, 8
    s_lshl_b32 s73, s73, 7
    s_add_u32 s74, s74, s73
    s_and_b32 s63, s3, 1
    s_lshl_b32 s63, s63, 10
    s_add_u32 s63, s63, s74
    s_movk_i32 s50, 3584
    s_mov_b32 s14, 1839104
    s_cmp_ge_u32 s3, 2
    s_cselect_b32 s12, s16, s12
    s_cselect_b32 s13, s17, s13
    s_cselect_b32 s72, s63, s72
    s_cselect_b32 s50, 3072, s50
    s_cselect_b32 s14, 1576960, s14
    s_cselect_b32 s63, 6, 5
    s_cmp_eq_u32 s3, 1
    s_cselect_b32 s74, 64, 0
    s_sub_u32 s12, s12, 4096
    s_subb_u32 s13, s13, 0
    s_mov_b32 s15, 0x20000
    s_add_u32 s72, s72, 4096
    s_mov_b32 s52, s72
    v_lshrrev_b32 v66, 3, v80
    v_mul_lo_u32 v66, v66, s50
    v_bfe_u32 v67, v80, 4, 1
    v_lshlrev_b32 v67, s63, v67
    v_and_b32 v68, 0x70, v0
    v_xor_b32 v67, v67, v68
    v_xor_b32 v67, s74, v67
    v_add3_u32 v66, v66, v67, s72
    s_lshl_b32 s73, s50, 3
    s_xor_b32 s72, s51, 0
    s_mul_i32 s72, s72, s73
    s_sub_u32 s72, s72, 0
    v_add_u32 v16, s72, v66
    s_lshr_b32 s74, s50, 1
    s_mul_i32 s40, s64, s74
    s_lshl_b32 s63, s50, 5
    s_add_u32 s63, s63, s40
    s_add_u32 m0, s61, 0
    s_nop 0
    buffer_load_dwordx4 v16, s[12:15], s40 offen offset:0 lds
    s_add_u32 m0, s61, 4096
    s_nop 0
    buffer_load_dwordx4 v16, s[12:15], s63 offen lds
    s_lshl_b32 s56, s4, 7
    s_sub_i32 s56, s56, 16
    s_max_i32 s56, s56, 0
    s_lshl_b32 s72, s3, 2
    s_add_u32 s56, s56, s72
    s_lshl_b32 s56, s56, 10
    v_lshrrev_b32 v67, 4, v80
    v_lshlrev_b32 v64, 10, v67
    v_and_b32 v67, 0xf0, v0
    v_add_u32 v64, v67, v64
    v_add_u32 v64, s56, v64
    buffer_load_dwordx4 v[32:35], v64, s[8:11], 0 offen offset:0
    buffer_load_dwordx4 v[36:39], v64, s[8:11], 0 offen offset:256
    buffer_load_dwordx4 v[40:43], v64, s[8:11], 0 offen offset:512
    buffer_load_dwordx4 v[44:47], v64, s[8:11], 0 offen offset:768
    s_xor_b32 s72, s51, 1
    s_mul_i32 s72, s72, s73
    s_sub_u32 s72, s72, 1024
    v_add_u32 v17, s72, v66
    s_xor_b32 s72, s51, 2
    s_mul_i32 s72, s72, s73
    s_sub_u32 s72, s72, 2048
    v_add_u32 v18, s72, v66
    s_xor_b32 s72, s51, 3
    s_mul_i32 s72, s72, s73
    s_sub_u32 s72, s72, 3072
    v_add_u32 v19, s72, v66
    s_add_u32 s65, s64, 128
    s_and_b32 s65, s65, 0x380
    s_add_u32 s66, s65, 128
    s_and_b32 s66, s66, 0x380
    s_add_u32 s67, s66, 128
    s_and_b32 s67, s67, 0x380
    s_add_u32 s68, s67, 128
    s_and_b32 s68, s68, 0x380
    s_add_u32 s69, s68, 128
    s_and_b32 s69, s69, 0x380
    s_add_u32 s70, s69, 128
    s_and_b32 s70, s70, 0x380
    s_add_u32 s71, s70, 128
    s_and_b32 s71, s71, 0x380
    s_mul_i32 s41, s65, s74
    s_mul_i32 s42, s66, s74
    s_mul_i32 s43, s67, s74
    s_mul_i32 s44, s68, s74
    s_mul_i32 s45, s69, s74
    s_mul_i32 s46, s70, s74
    s_mul_i32 s47, s71, s74
    s_lshl_b32 s50, s50, 5
    s_mov_b32 s62, 0xffff0000
    s_mov_b32 s100, 0
    v_mov_b32 v65, 0x3f803f80
    s_sub_u32 s16, s16, 4096
    s_subb_u32 s17, s17, 0
    s_mov_b32 s18, 1576960
    s_mov_b32 s19, 0x20000
    s_mov_b32 s26, 524288
    s_mov_b32 s27, 0x20000
    s_mov_b32 s22, 1835008
    s_mov_b32 s23, 0x20000
    s_mov_b32 s34, 2097152
    s_mov_b32 s35, 0x20000
    s_mov_b32 s38, 256
    s_mov_b32 s39, 0x20000
    s_mov_b32 s30, 10551296
    s_mov_b32 s31, 0x20000
    v_and_b32 v66, 31, v80
    v_lshlrev_b32 v67, 7, v66
    v_add_u32 v67, s61, v67
    v_bfe_u32 v68, v80, 1, 3
    v_lshrrev_b32 v69, 5, v80
    v_xor_b32 v68, v68, v69
    v_xor_b32 v68, s51, v68
    v_lshl_add_u32 v52, v68, 4, v67
    v_xor_b32 v53, 32, v52
    v_xor_b32 v54, 64, v52
    v_xor_b32 v55, 96, v52
    v_bfe_u32 v81, v80, 2, 2
    v_and_b32 v82, 3, v80
    v_lshlrev_b32 v82, 3, v82
    v_bfe_u32 v69, v80, 3, 1
    v_bfe_u32 v68, v80, 4, 1
    v_lshrrev_b32 v66, 5, v80
    v_lshl_add_u32 v66, v66, 3, v81
    v_lshl_add_u32 v66, v66, 7, v82
    v_mul_u32_u24 v67, 41024, v68
    v_add_u32 v67, v67, v66
    v_lshl_add_u32 v1, v69, 5, v67
    s_and_b32 s72, s5, 1
    s_lshl_b32 s72, s72, 6
    v_xor_b32 v1, s72, v1
    v_xor_b32 v2, 32, v1
    v_lshl_add_u32 v67, v68, 5, v66
    v_lshl_add_u32 v67, v69, 6, v67
    v_add_u32 v5, 81920, v67
    v_xor_b32 v6, 64, v5
    v_add_u32 v7, 40960, v5
    v_add_u32 v8, 40960, v6
    v_lshrrev_b32 v66, 4, v80
    v_lshl_add_u32 v66, v66, 3, v81
    v_lshl_add_u32 v66, v66, 7, v82
    v_lshlrev_b32 v67, 6, v69
    s_lshl_b32 s72, s3, 5
    v_xor_b32 v67, s72, v67
    v_add_u32 v66, v66, v67
    v_add_u32 v9, 122880, v66
    v_lshrrev_b32 v66, 5, v80
    v_lshl_add_u32 v66, v66, 2, v81
    v_lshl_add_u32 v66, v66, 7, v82
    v_add_u32 v66, s61, v66
    v_lshl_add_u32 v66, v68, 5, v66
    s_and_b32 s73, s3, 1
    v_xor_b32 v67, s73, v69
    v_lshl_add_u32 v26, v67, 6, v66
    v_xor_b32 v27, 64, v26
    v_lshrrev_b32 v66, 3, v80
    v_lshlrev_b32 v66, 10, v66
    v_lshlrev_b32 v67, 6, v68
    v_and_b32 v69, 0x70, v0
    v_xor_b32 v67, v67, v69
    v_add_u32 v24, v66, v67
    v_add_u32 v25, 7168, v24
    s_lshl_b32 s72, s3, 7
    s_add_u32 s72, s72, s64
    s_and_b32 s48, s72, 0x380
    s_xor_b32 s49, s48, 0x200
    s_mul_i32 s48, s48, 1536
    s_mul_i32 s49, s49, 1536
    s_and_b32 s73, s5, 1
    s_lshl_b32 s73, s73, 7
    s_lshl_b32 s72, s0, 8
    s_add_u32 s73, s73, s72
    s_add_u32 s73, s73, 6144
    v_lshrrev_b32 v66, 3, v80
    v_mul_u32_u24 v66, 3072, v66
    v_add3_u32 v66, v66, v67, s73
    s_xor_b32 s72, s51, 0
    s_mul_i32 s72, s72, 24576
    s_sub_u32 s72, s72, 0
    v_add_u32 v20, s72, v66
    s_xor_b32 s72, s51, 1
    s_mul_i32 s72, s72, 24576
    s_sub_u32 s72, s72, 1024
    v_add_u32 v21, s72, v66
    s_xor_b32 s72, s51, 2
    s_mul_i32 s72, s72, 24576
    s_sub_u32 s72, s72, 2048
    v_add_u32 v22, s72, v66
    s_xor_b32 s72, s51, 3
    s_mul_i32 s72, s72, 24576
    s_sub_u32 s72, s72, 3072
    v_add_u32 v23, s72, v66
    v_lshrrev_b32 v66, 4, v80
    s_lshl_b32 s72, s3, 2
    v_add_u32 v67, s72, v66
    v_and_b32 v67, 7, v67
    v_lshlrev_b32 v66, 10, v66
    v_add_u32 v66, s61, v66
    s_lshl_b32 s72, s6, 3
    v_and_b32 v68, 15, v80
    v_subrev_u32 v68, s72, v68
    v_add_u32 v69, 0, v68
    v_and_b32 v69, 63, v69
    v_xor_b32 v69, v69, v67
    v_lshl_add_u32 v56, v69, 4, v66
    v_add_u32 v69, 16, v68
    v_and_b32 v69, 63, v69
    v_xor_b32 v69, v69, v67
    v_lshl_add_u32 v57, v69, 4, v66
    v_add_u32 v69, 32, v68
    v_and_b32 v69, 63, v69
    v_xor_b32 v69, v69, v67
    v_lshl_add_u32 v58, v69, 4, v66
    v_add_u32 v69, 48, v68
    v_and_b32 v69, 63, v69
    v_xor_b32 v69, v69, v67
    v_lshl_add_u32 v59, v69, 4, v66
    v_mul_u32_u24 v67, 40960, v81
    v_and_b32 v66, 3, v80
    v_lshl_add_u32 v67, v66, 10, v67
    v_lshrrev_b32 v66, 4, v80
    v_and_b32 v68, 7, v80
    v_xor_b32 v66, v66, v68
    v_xor_b32 v66, s51, v66
    v_lshl_add_u32 v28, v66, 4, v67
    v_xor_b32 v29, 64, v28
    s_lshl_b32 s1, s4, 2
    s_lshl_b32 s59, s4, 2
    s_add_u32 s59, s59, s3
    s_mul_i32 s59, s59, 147456
    s_mul_i32 s72, s0, 28672
    s_add_u32 s52, s59, s72
    s_and_b32 s73, s5, 1
    s_lshl_b32 s73, s73, 11
    s_add_u32 s52, s52, s73
    s_add_u32 s52, s52, 57344
    s_lshl_b32 s72, s0, 13
    s_add_u32 s59, s59, s72
    s_lshl_b32 s73, s73, 1
    s_add_u32 s59, s59, s73
    s_lshl_b32 s72, s60, 7
    s_mul_i32 s53, s3, 458752
    s_add_u32 s53, s53, s72
    s_lshl_b32 s54, s3, 17
    s_add_u32 s54, s54, s72
    s_lshl_b32 s72, s7, 1
    s_lshr_b32 s73, s3, 1
    s_add_u32 s74, s72, s73
    s_xor_b32 s63, s74, 1
    s_mul_i32 s74, s74, 147456
    s_mul_i32 s63, s63, 147456
    s_mul_i32 s72, s3, 28672
    s_add_u32 s72, s72, 32768
    s_add_u32 s55, s74, s72
    s_add_u32 s56, s63, s72
    s_lshl_b32 s72, s3, 13
    s_add_u32 s57, s74, s72
    s_add_u32 s58, s63, s72
    s_lshr_b32 s72, s7, 2
    s_mul_i32 s73, s72, 52
    s_lshr_b32 s73, s73, 8
    s_mul_i32 s73, s73, 5
    s_sub_u32 s72, s72, s73
    s_lshr_b32 s73, s72, 1
    s_add_u32 s73, s73, s72
    s_lshl_b32 s75, s73, 12
    s_add_u32 s72, s72, 1
    s_cmp_eq_u32 s72, 5
    s_cselect_b32 s72, 0, s72
    s_lshr_b32 s73, s72, 1
    s_add_u32 s73, s73, s72
    s_lshl_b32 s76, s73, 12
    s_add_u32 s72, s72, 1
    s_cmp_eq_u32 s72, 5
    s_cselect_b32 s72, 0, s72
    s_lshr_b32 s73, s72, 1
    s_add_u32 s73, s73, s72
    s_lshl_b32 s77, s73, 12
    s_add_u32 s72, s72, 1
    s_cmp_eq_u32 s72, 5
    s_cselect_b32 s72, 0, s72
    s_lshr_b32 s73, s72, 1
    s_add_u32 s73, s73, s72
    s_lshl_b32 s78, s73, 12
    s_add_u32 s72, s72, 1
    s_cmp_eq_u32 s72, 5
    s_cselect_b32 s72, 0, s72
    s_lshr_b32 s73, s72, 1
    s_add_u32 s73, s73, s72
    s_lshl_b32 s79, s73, 12
    s_add_u32 m0, s61, 12288
    s_nop 0
    buffer_load_dwordx4 v48, s[8:11], s65 offen offset:0 lds
    buffer_load_dwordx4 v49, s[8:11], s65 offen offset:1024 lds
    buffer_load_dwordx4 v50, s[8:11], s65 offen offset:2048 lds
    buffer_load_dwordx4 v51, s[8:11], s65 offen offset:3072 lds
    s_add_u32 m0, s61, 16384
    s_nop 0
    buffer_load_dwordx4 v48, s[8:11], s66 offen offset:0 lds
    buffer_load_dwordx4 v49, s[8:11], s66 offen offset:1024 lds
    buffer_load_dwordx4 v50, s[8:11], s66 offen offset:2048 lds
    buffer_load_dwordx4 v51, s[8:11], s66 offen offset:3072 lds
    s_add_u32 m0, s61, 20480
    s_nop 0
    buffer_load_dwordx4 v48, s[8:11], s67 offen offset:0 lds
    buffer_load_dwordx4 v49, s[8:11], s67 offen offset:1024 lds
    buffer_load_dwordx4 v50, s[8:11], s67 offen offset:2048 lds
    buffer_load_dwordx4 v51, s[8:11], s67 offen offset:3072 lds
    s_waitcnt vmcnt(12)
    v_dot2_f32_bf16 v77, v32, v65, 0
    v_dot2_f32_bf16 v79, v32, v32, 0
    v_dot2_f32_bf16 v78, v33, v65, 0
    v_dot2_f32_bf16 v64, v33, v33, 0
    v_dot2_f32_bf16 v77, v34, v65, v77
    v_dot2_f32_bf16 v79, v34, v34, v79
    v_dot2_f32_bf16 v78, v35, v65, v78
    v_dot2_f32_bf16 v64, v35, v35, v64
    v_dot2_f32_bf16 v77, v36, v65, v77
    v_dot2_f32_bf16 v79, v36, v36, v79
    v_dot2_f32_bf16 v78, v37, v65, v78
    v_dot2_f32_bf16 v64, v37, v37, v64
    v_dot2_f32_bf16 v77, v38, v65, v77
    v_dot2_f32_bf16 v79, v38, v38, v79
    s_add_u32 m0, s61, 24576
    s_nop 0
    buffer_load_dwordx4 v48, s[8:11], s68 offen offset:0 lds
    v_dot2_f32_bf16 v78, v39, v65, v78
    v_dot2_f32_bf16 v64, v39, v39, v64
    v_dot2_f32_bf16 v77, v40, v65, v77
    v_dot2_f32_bf16 v79, v40, v40, v79
    v_dot2_f32_bf16 v78, v41, v65, v78
    v_dot2_f32_bf16 v64, v41, v41, v64
    v_dot2_f32_bf16 v77, v42, v65, v77
    v_dot2_f32_bf16 v79, v42, v42, v79
    v_dot2_f32_bf16 v78, v43, v65, v78
    v_dot2_f32_bf16 v64, v43, v43, v64
    v_dot2_f32_bf16 v77, v44, v65, v77
    v_dot2_f32_bf16 v79, v44, v44, v79
    v_dot2_f32_bf16 v78, v45, v65, v78
    v_dot2_f32_bf16 v64, v45, v45, v64
    v_dot2_f32_bf16 v77, v46, v65, v77
    buffer_load_dwordx4 v49, s[8:11], s68 offen offset:1024 lds
    v_dot2_f32_bf16 v79, v46, v46, v79
    v_dot2_f32_bf16 v78, v47, v65, v78
    v_dot2_f32_bf16 v64, v47, v47, v64
    s_nop 2
    v_add_f32 v77, v77, v78
    v_add_f32 v79, v79, v64
    s_nop 0
    v_add_f32_dpp v77, v77, v77 row_ror:8 row_mask:0xf bank_mask:0xf
    v_add_f32_dpp v79, v79, v79 row_ror:8 row_mask:0xf bank_mask:0xf
    s_nop 0
    v_add_f32_dpp v77, v77, v77 row_ror:4 row_mask:0xf bank_mask:0xf
    v_add_f32_dpp v79, v79, v79 row_ror:4 row_mask:0xf bank_mask:0xf
    s_nop 0
    v_add_f32_dpp v77, v77, v77 row_ror:2 row_mask:0xf bank_mask:0xf
    v_add_f32_dpp v79, v79, v79 row_ror:2 row_mask:0xf bank_mask:0xf
    buffer_load_dwordx4 v50, s[8:11], s68 offen offset:2048 lds
    s_nop 0
    v_add_f32_dpp v77, v77, v77 row_ror:1 row_mask:0xf bank_mask:0xf
    v_add_f32_dpp v79, v79, v79 row_ror:1 row_mask:0xf bank_mask:0xf
    v_mul_f32 v77, 0x3b000000, v77
    v_mul_f32 v79, 0x3b000000, v79
    v_fma_f32 v79, -v77, v77, v79
    v_max_f32 v79, 0, v79
    v_cvt_pk_bf16_f32 v66, v77, v79
    v_and_b32 v67, s62, v66
    v_add_f32 v67, 0x3727c5ac, v67
    v_cvt_pk_bf16_f32 v67, v67, v67
    v_and_b32 v67, s62, v67
    v_sqrt_f32 v67, v67
    v_lshlrev_b32 v66, 16, v66
    v_cvt_pk_bf16_f32 v67, v67, v67
    buffer_load_dwordx4 v51, s[8:11], s68 offen offset:3072 lds
    v_and_b32 v67, s62, v67
    v_rcp_f32 v70, v67
    s_nop 0
    v_mul_f32_e64 v71, -v66, v70
    v_lshlrev_b32 v66, 16, v32
    v_and_b32 v67, s62, v32
    v_pk_fma_f32 v[66:67], v[66:67], v[70:71], v[70:71] op_sel:[0,0,1] op_sel_hi:[1,0,1]
    v_cvt_pk_bf16_f32 v32, v66, v67
    v_lshlrev_b32 v68, 16, v33
    v_and_b32 v69, s62, v33
    v_pk_fma_f32 v[68:69], v[68:69], v[70:71], v[70:71] op_sel:[0,0,1] op_sel_hi:[1,0,1]
    v_cvt_pk_bf16_f32 v33, v68, v69
    v_lshlrev_b32 v66, 16, v34
    v_and_b32 v67, s62, v34
    v_pk_fma_f32 v[66:67], v[66:67], v[70:71], v[70:71] op_sel:[0,0,1] op_sel_hi:[1,0,1]
    s_add_u32 m0, s61, 28672
    s_nop 0
    buffer_load_dwordx4 v48, s[8:11], s69 offen offset:0 lds
    v_cvt_pk_bf16_f32 v34, v66, v67
    v_lshlrev_b32 v68, 16, v35
    v_and_b32 v69, s62, v35
    v_pk_fma_f32 v[68:69], v[68:69], v[70:71], v[70:71] op_sel:[0,0,1] op_sel_hi:[1,0,1]
    v_cvt_pk_bf16_f32 v35, v68, v69
    v_lshlrev_b32 v66, 16, v36
    v_and_b32 v67, s62, v36
    v_pk_fma_f32 v[66:67], v[66:67], v[70:71], v[70:71] op_sel:[0,0,1] op_sel_hi:[1,0,1]
    v_cvt_pk_bf16_f32 v36, v66, v67
    v_lshlrev_b32 v68, 16, v37
    v_and_b32 v69, s62, v37
    v_pk_fma_f32 v[68:69], v[68:69], v[70:71], v[70:71] op_sel:[0,0,1] op_sel_hi:[1,0,1]
    v_cvt_pk_bf16_f32 v37, v68, v69
    v_lshlrev_b32 v66, 16, v38
    v_and_b32 v67, s62, v38
    buffer_load_dwordx4 v49, s[8:11], s69 offen offset:1024 lds
    v_pk_fma_f32 v[66:67], v[66:67], v[70:71], v[70:71] op_sel:[0,0,1] op_sel_hi:[1,0,1]
    v_cvt_pk_bf16_f32 v38, v66, v67
    v_lshlrev_b32 v68, 16, v39
    v_and_b32 v69, s62, v39
    v_pk_fma_f32 v[68:69], v[68:69], v[70:71], v[70:71] op_sel:[0,0,1] op_sel_hi:[1,0,1]
    v_cvt_pk_bf16_f32 v39, v68, v69
    v_lshlrev_b32 v66, 16, v40
    v_and_b32 v67, s62, v40
    v_pk_fma_f32 v[66:67], v[66:67], v[70:71], v[70:71] op_sel:[0,0,1] op_sel_hi:[1,0,1]
    v_cvt_pk_bf16_f32 v40, v66, v67
    v_lshlrev_b32 v68, 16, v41
    v_and_b32 v69, s62, v41
    v_pk_fma_f32 v[68:69], v[68:69], v[70:71], v[70:71] op_sel:[0,0,1] op_sel_hi:[1,0,1]
    v_cvt_pk_bf16_f32 v41, v68, v69
    v_lshlrev_b32 v66, 16, v42
    buffer_load_dwordx4 v50, s[8:11], s69 offen offset:2048 lds
    v_and_b32 v67, s62, v42
    v_pk_fma_f32 v[66:67], v[66:67], v[70:71], v[70:71] op_sel:[0,0,1] op_sel_hi:[1,0,1]
    v_cvt_pk_bf16_f32 v42, v66, v67
    v_lshlrev_b32 v68, 16, v43
    v_and_b32 v69, s62, v43
    v_pk_fma_f32 v[68:69], v[68:69], v[70:71], v[70:71] op_sel:[0,0,1] op_sel_hi:[1,0,1]
    v_cvt_pk_bf16_f32 v43, v68, v69
    v_lshlrev_b32 v66, 16, v44
    v_and_b32 v67, s62, v44
    v_pk_fma_f32 v[66:67], v[66:67], v[70:71], v[70:71] op_sel:[0,0,1] op_sel_hi:[1,0,1]
    v_cvt_pk_bf16_f32 v44, v66, v67
    v_lshlrev_b32 v68, 16, v45
    v_and_b32 v69, s62, v45
    v_pk_fma_f32 v[68:69], v[68:69], v[70:71], v[70:71] op_sel:[0,0,1] op_sel_hi:[1,0,1]
    v_cvt_pk_bf16_f32 v45, v68, v69
    buffer_load_dwordx4 v51, s[8:11], s69 offen offset:3072 lds
    v_lshlrev_b32 v66, 16, v46
    v_and_b32 v67, s62, v46
    v_pk_fma_f32 v[66:67], v[66:67], v[70:71], v[70:71] op_sel:[0,0,1] op_sel_hi:[1,0,1]
    v_cvt_pk_bf16_f32 v46, v66, v67
    v_lshlrev_b32 v68, 16, v47
    v_and_b32 v69, s62, v47
    v_pk_fma_f32 v[68:69], v[68:69], v[70:71], v[70:71] op_sel:[0,0,1] op_sel_hi:[1,0,1]
    v_cvt_pk_bf16_f32 v47, v68, v69
    ds_read_b128 v[128:131], v52 offset:8192
    ds_read_b128 v[132:135], v53 offset:8192
    ds_read_b128 v[136:139], v54 offset:8192
    ds_read_b128 v[140:143], v55 offset:8192
    s_waitcnt vmcnt(16)
    ds_read_b128 v[144:147], v52 offset:12288
    ds_read_b128 v[148:151], v53 offset:12288
    s_add_u32 m0, s61, 32768
    s_nop 0
    buffer_load_dwordx4 v48, s[8:11], s70 offen offset:0 lds
    ds_read_b128 v[152:155], v54 offset:12288
    ds_read_b128 v[156:159], v55 offset:12288
    s_waitcnt lgkmcnt(6)
    v_dot2_f32_bf16 v60, v128, v65, 0
    v_dot2_f32_bf16 v62, v128, v128, 0
    v_dot2_f32_bf16 v61, v129, v65, 0
    v_dot2_f32_bf16 v63, v129, v129, 0
    v_dot2_f32_bf16 v60, v130, v65, v60
    v_dot2_f32_bf16 v62, v130, v130, v62
    v_dot2_f32_bf16 v61, v131, v65, v61
    v_dot2_f32_bf16 v63, v131, v131, v63
    v_dot2_f32_bf16 v60, v132, v65, v60
    v_dot2_f32_bf16 v62, v132, v132, v62
    v_dot2_f32_bf16 v61, v133, v65, v61
    v_dot2_f32_bf16 v63, v133, v133, v63
    buffer_load_dwordx4 v49, s[8:11], s70 offen offset:1024 lds
    v_dot2_f32_bf16 v60, v134, v65, v60
    v_dot2_f32_bf16 v62, v134, v134, v62
    v_dot2_f32_bf16 v61, v135, v65, v61
    v_dot2_f32_bf16 v63, v135, v135, v63
    s_waitcnt lgkmcnt(4)
    v_dot2_f32_bf16 v60, v136, v65, v60
    v_dot2_f32_bf16 v62, v136, v136, v62
    v_dot2_f32_bf16 v61, v137, v65, v61
    v_dot2_f32_bf16 v63, v137, v137, v63
    v_dot2_f32_bf16 v60, v138, v65, v60
    v_dot2_f32_bf16 v62, v138, v138, v62
    v_dot2_f32_bf16 v61, v139, v65, v61
    v_dot2_f32_bf16 v63, v139, v139, v63
    v_dot2_f32_bf16 v60, v140, v65, v60
    v_dot2_f32_bf16 v62, v140, v140, v62
    buffer_load_dwordx4 v50, s[8:11], s70 offen offset:2048 lds
    v_dot2_f32_bf16 v61, v141, v65, v61
    v_dot2_f32_bf16 v63, v141, v141, v63
    v_dot2_f32_bf16 v60, v142, v65, v60
    v_dot2_f32_bf16 v62, v142, v142, v62
    v_dot2_f32_bf16 v61, v143, v65, v61
    v_dot2_f32_bf16 v63, v143, v143, v63
    s_waitcnt vmcnt(15)
    ds_read_b128 v[160:163], v52 offset:16384
    ds_read_b128 v[164:167], v53 offset:16384
    ds_read_b128 v[168:171], v54 offset:16384
    ds_read_b128 v[172:175], v55 offset:16384
    s_waitcnt lgkmcnt(6)
    v_dot2_f32_bf16 v60, v144, v65, v60
    v_dot2_f32_bf16 v62, v144, v144, v62
    v_dot2_f32_bf16 v61, v145, v65, v61
    buffer_load_dwordx4 v51, s[8:11], s70 offen offset:3072 lds
    v_dot2_f32_bf16 v63, v145, v145, v63
    v_dot2_f32_bf16 v60, v146, v65, v60
    v_dot2_f32_bf16 v62, v146, v146, v62
    v_dot2_f32_bf16 v61, v147, v65, v61
    v_dot2_f32_bf16 v63, v147, v147, v63
    v_dot2_f32_bf16 v60, v148, v65, v60
    v_dot2_f32_bf16 v62, v148, v148, v62
    v_dot2_f32_bf16 v61, v149, v65, v61
    v_dot2_f32_bf16 v63, v149, v149, v63
    v_dot2_f32_bf16 v60, v150, v65, v60
    v_dot2_f32_bf16 v62, v150, v150, v62
    v_dot2_f32_bf16 v61, v151, v65, v61
    v_dot2_f32_bf16 v63, v151, v151, v63
    s_waitcnt lgkmcnt(4)
    v_dot2_f32_bf16 v60, v152, v65, v60
    s_add_u32 m0, s61, 36864
    s_nop 0
    buffer_load_dwordx4 v48, s[8:11], s71 offen offset:0 lds
    v_dot2_f32_bf16 v62, v152, v152, v62
    v_dot2_f32_bf16 v61, v153, v65, v61
    v_dot2_f32_bf16 v63, v153, v153, v63
    v_dot2_f32_bf16 v60, v154, v65, v60
    v_dot2_f32_bf16 v62, v154, v154, v62
    v_dot2_f32_bf16 v61, v155, v65, v61
    v_dot2_f32_bf16 v63, v155, v155, v63
    v_dot2_f32_bf16 v60, v156, v65, v60
    v_dot2_f32_bf16 v62, v156, v156, v62
    v_dot2_f32_bf16 v61, v157, v65, v61
    v_dot2_f32_bf16 v63, v157, v157, v63
    v_dot2_f32_bf16 v60, v158, v65, v60
    v_dot2_f32_bf16 v62, v158, v158, v62
    v_dot2_f32_bf16 v61, v159, v65, v61
    v_dot2_f32_bf16 v63, v159, v159, v63
    buffer_load_dwordx4 v49, s[8:11], s71 offen offset:1024 lds
    s_waitcnt vmcnt(14)
    ds_read_b128 v[176:179], v52 offset:20480
    ds_read_b128 v[180:183], v53 offset:20480
    ds_read_b128 v[184:187], v54 offset:20480
    ds_read_b128 v[188:191], v55 offset:20480
    s_waitcnt lgkmcnt(6)
    v_dot2_f32_bf16 v60, v160, v65, v60
    v_dot2_f32_bf16 v62, v160, v160, v62
    v_dot2_f32_bf16 v61, v161, v65, v61
    v_dot2_f32_bf16 v63, v161, v161, v63
    v_dot2_f32_bf16 v60, v162, v65, v60
    v_dot2_f32_bf16 v62, v162, v162, v62
    v_dot2_f32_bf16 v61, v163, v65, v61
    v_dot2_f32_bf16 v63, v163, v163, v63
    v_dot2_f32_bf16 v60, v164, v65, v60
    buffer_load_dwordx4 v50, s[8:11], s71 offen offset:2048 lds
    v_dot2_f32_bf16 v62, v164, v164, v62
    v_dot2_f32_bf16 v61, v165, v65, v61
    v_dot2_f32_bf16 v63, v165, v165, v63
    v_dot2_f32_bf16 v60, v166, v65, v60
    v_dot2_f32_bf16 v62, v166, v166, v62
    v_dot2_f32_bf16 v61, v167, v65, v61
    v_dot2_f32_bf16 v63, v167, v167, v63
    s_waitcnt lgkmcnt(4)
    v_dot2_f32_bf16 v60, v168, v65, v60
    v_dot2_f32_bf16 v62, v168, v168, v62
    v_dot2_f32_bf16 v61, v169, v65, v61
    v_dot2_f32_bf16 v63, v169, v169, v63
    v_dot2_f32_bf16 v60, v170, v65, v60
    v_dot2_f32_bf16 v62, v170, v170, v62
    v_dot2_f32_bf16 v61, v171, v65, v61
    buffer_load_dwordx4 v51, s[8:11], s71 offen offset:3072 lds
    v_dot2_f32_bf16 v63, v171, v171, v63
    v_dot2_f32_bf16 v60, v172, v65, v60
    v_dot2_f32_bf16 v62, v172, v172, v62
    v_dot2_f32_bf16 v61, v173, v65, v61
    v_dot2_f32_bf16 v63, v173, v173, v63
    v_dot2_f32_bf16 v60, v174, v65, v60
    v_dot2_f32_bf16 v62, v174, v174, v62
    v_dot2_f32_bf16 v61, v175, v65, v61
    v_dot2_f32_bf16 v63, v175, v175, v63
    s_waitcnt vmcnt(12)
    ds_read_b128 v[192:195], v52 offset:24576
    ds_read_b128 v[196:199], v53 offset:24576
    ds_read_b128 v[200:203], v54 offset:24576
    ds_read_b128 v[204:207], v55 offset:24576
    s_waitcnt lgkmcnt(6)
    s_add_u32 m0, s61, 0
    s_nop 0
    buffer_load_dwordx4 v17, s[12:15], s40 offen offset:1024 lds
    v_dot2_f32_bf16 v60, v176, v65, v60
    v_dot2_f32_bf16 v62, v176, v176, v62
    v_dot2_f32_bf16 v61, v177, v65, v61
    v_dot2_f32_bf16 v63, v177, v177, v63
    v_dot2_f32_bf16 v60, v178, v65, v60
    v_dot2_f32_bf16 v62, v178, v178, v62
    v_dot2_f32_bf16 v61, v179, v65, v61
    v_dot2_f32_bf16 v63, v179, v179, v63
    v_dot2_f32_bf16 v60, v180, v65, v60
    v_dot2_f32_bf16 v62, v180, v180, v62
    v_dot2_f32_bf16 v61, v181, v65, v61
    v_dot2_f32_bf16 v63, v181, v181, v63
    v_dot2_f32_bf16 v60, v182, v65, v60
    v_dot2_f32_bf16 v62, v182, v182, v62
    v_dot2_f32_bf16 v61, v183, v65, v61
    buffer_load_dwordx4 v18, s[12:15], s40 offen offset:2048 lds
    v_dot2_f32_bf16 v63, v183, v183, v63
    s_waitcnt lgkmcnt(4)
    v_dot2_f32_bf16 v60, v184, v65, v60
    v_dot2_f32_bf16 v62, v184, v184, v62
    v_dot2_f32_bf16 v61, v185, v65, v61
    v_dot2_f32_bf16 v63, v185, v185, v63
    v_dot2_f32_bf16 v60, v186, v65, v60
    v_dot2_f32_bf16 v62, v186, v186, v62
    v_dot2_f32_bf16 v61, v187, v65, v61
    v_dot2_f32_bf16 v63, v187, v187, v63
    v_dot2_f32_bf16 v60, v188, v65, v60
    v_dot2_f32_bf16 v62, v188, v188, v62
    v_dot2_f32_bf16 v61, v189, v65, v61
    v_dot2_f32_bf16 v63, v189, v189, v63
    v_dot2_f32_bf16 v60, v190, v65, v60
    buffer_load_dwordx4 v19, s[12:15], s40 offen offset:3072 lds
    v_dot2_f32_bf16 v62, v190, v190, v62
    v_dot2_f32_bf16 v61, v191, v65, v61
    v_dot2_f32_bf16 v63, v191, v191, v63
    s_waitcnt vmcnt(11)
    ds_read_b128 v[208:211], v52 offset:28672
    ds_read_b128 v[212:215], v53 offset:28672
    ds_read_b128 v[216:219], v54 offset:28672
    ds_read_b128 v[220:223], v55 offset:28672
    s_waitcnt lgkmcnt(6)
    v_dot2_f32_bf16 v60, v192, v65, v60
    v_dot2_f32_bf16 v62, v192, v192, v62
    v_dot2_f32_bf16 v61, v193, v65, v61
    v_dot2_f32_bf16 v63, v193, v193, v63
    v_dot2_f32_bf16 v60, v194, v65, v60
    v_dot2_f32_bf16 v62, v194, v194, v62
    s_add_u32 m0, s61, 4096
    s_add_u32 s40, s40, s50
    buffer_load_dwordx4 v17, s[12:15], s40 offen offset:1024 lds
    v_dot2_f32_bf16 v61, v195, v65, v61
    v_dot2_f32_bf16 v63, v195, v195, v63
    v_dot2_f32_bf16 v60, v196, v65, v60
    v_dot2_f32_bf16 v62, v196, v196, v62
    v_dot2_f32_bf16 v61, v197, v65, v61
    v_dot2_f32_bf16 v63, v197, v197, v63
    v_dot2_f32_bf16 v60, v198, v65, v60
    v_dot2_f32_bf16 v62, v198, v198, v62
    v_dot2_f32_bf16 v61, v199, v65, v61
    v_dot2_f32_bf16 v63, v199, v199, v63
    s_waitcnt lgkmcnt(4)
    v_dot2_f32_bf16 v60, v200, v65, v60
    v_dot2_f32_bf16 v62, v200, v200, v62
    v_dot2_f32_bf16 v61, v201, v65, v61
    v_dot2_f32_bf16 v63, v201, v201, v63
    buffer_load_dwordx4 v18, s[12:15], s40 offen offset:2048 lds
    v_dot2_f32_bf16 v60, v202, v65, v60
    v_dot2_f32_bf16 v62, v202, v202, v62
    v_dot2_f32_bf16 v61, v203, v65, v61
    v_dot2_f32_bf16 v63, v203, v203, v63
    v_dot2_f32_bf16 v60, v204, v65, v60
    v_dot2_f32_bf16 v62, v204, v204, v62
    v_dot2_f32_bf16 v61, v205, v65, v61
    v_dot2_f32_bf16 v63, v205, v205, v63
    v_dot2_f32_bf16 v60, v206, v65, v60
    v_dot2_f32_bf16 v62, v206, v206, v62
    v_dot2_f32_bf16 v61, v207, v65, v61
    v_dot2_f32_bf16 v63, v207, v207, v63
    s_waitcnt vmcnt(9)
    ds_read_b128 v[224:227], v52 offset:32768
    ds_read_b128 v[228:231], v53 offset:32768
    buffer_load_dwordx4 v19, s[12:15], s40 offen offset:3072 lds
    ds_read_b128 v[232:235], v54 offset:32768
    ds_read_b128 v[236:239], v55 offset:32768
    s_waitcnt lgkmcnt(6)
    v_dot2_f32_bf16 v60, v208, v65, v60
    v_dot2_f32_bf16 v62, v208, v208, v62
    v_dot2_f32_bf16 v61, v209, v65, v61
    v_dot2_f32_bf16 v63, v209, v209, v63
    v_dot2_f32_bf16 v60, v210, v65, v60
    v_dot2_f32_bf16 v62, v210, v210, v62
    v_dot2_f32_bf16 v61, v211, v65, v61
    v_dot2_f32_bf16 v63, v211, v211, v63
    v_dot2_f32_bf16 v60, v212, v65, v60
    v_dot2_f32_bf16 v62, v212, v212, v62
    v_dot2_f32_bf16 v61, v213, v65, v61
    v_dot2_f32_bf16 v63, v213, v213, v63
    s_add_u32 m0, s61, 8192
    s_nop 0
    buffer_load_dwordx4 v16, s[12:15], s41 offen offset:0 lds
    v_dot2_f32_bf16 v60, v214, v65, v60
    v_dot2_f32_bf16 v62, v214, v214, v62
    v_dot2_f32_bf16 v61, v215, v65, v61
    v_dot2_f32_bf16 v63, v215, v215, v63
    s_waitcnt lgkmcnt(4)
    v_dot2_f32_bf16 v60, v216, v65, v60
    v_dot2_f32_bf16 v62, v216, v216, v62
    v_dot2_f32_bf16 v61, v217, v65, v61
    v_dot2_f32_bf16 v63, v217, v217, v63
    v_dot2_f32_bf16 v60, v218, v65, v60
    v_dot2_f32_bf16 v62, v218, v218, v62
    v_dot2_f32_bf16 v61, v219, v65, v61
    v_dot2_f32_bf16 v63, v219, v219, v63
    v_dot2_f32_bf16 v60, v220, v65, v60
    v_dot2_f32_bf16 v62, v220, v220, v62
    buffer_load_dwordx4 v17, s[12:15], s41 offen offset:1024 lds
    v_dot2_f32_bf16 v61, v221, v65, v61
    v_dot2_f32_bf16 v63, v221, v221, v63
    v_dot2_f32_bf16 v60, v222, v65, v60
    v_dot2_f32_bf16 v62, v222, v222, v62
    v_dot2_f32_bf16 v61, v223, v65, v61
    v_dot2_f32_bf16 v63, v223, v223, v63
    s_waitcnt vmcnt(8)
    ds_read_b128 v[240:243], v52 offset:36864
    ds_read_b128 v[244:247], v53 offset:36864
    ds_read_b128 v[248:251], v54 offset:36864
    ds_read_b128 v[252:255], v55 offset:36864
    s_waitcnt lgkmcnt(6)
    v_dot2_f32_bf16 v60, v224, v65, v60
    v_dot2_f32_bf16 v62, v224, v224, v62
    v_dot2_f32_bf16 v61, v225, v65, v61
    buffer_load_dwordx4 v18, s[12:15], s41 offen offset:2048 lds
    v_dot2_f32_bf16 v63, v225, v225, v63
    v_dot2_f32_bf16 v60, v226, v65, v60
    v_dot2_f32_bf16 v62, v226, v226, v62
    v_dot2_f32_bf16 v61, v227, v65, v61
    v_dot2_f32_bf16 v63, v227, v227, v63
    v_dot2_f32_bf16 v60, v228, v65, v60
    v_dot2_f32_bf16 v62, v228, v228, v62
    v_dot2_f32_bf16 v61, v229, v65, v61
    v_dot2_f32_bf16 v63, v229, v229, v63
    v_dot2_f32_bf16 v60, v230, v65, v60
    v_dot2_f32_bf16 v62, v230, v230, v62
    v_dot2_f32_bf16 v61, v231, v65, v61
    v_dot2_f32_bf16 v63, v231, v231, v63
    s_waitcnt lgkmcnt(4)
    v_dot2_f32_bf16 v60, v232, v65, v60
    buffer_load_dwordx4 v19, s[12:15], s41 offen offset:3072 lds
    v_dot2_f32_bf16 v62, v232, v232, v62
    v_dot2_f32_bf16 v61, v233, v65, v61
    v_dot2_f32_bf16 v63, v233, v233, v63
    v_dot2_f32_bf16 v60, v234, v65, v60
    v_dot2_f32_bf16 v62, v234, v234, v62
    v_dot2_f32_bf16 v61, v235, v65, v61
    v_dot2_f32_bf16 v63, v235, v235, v63
    v_dot2_f32_bf16 v60, v236, v65, v60
    v_dot2_f32_bf16 v62, v236, v236, v62
    v_dot2_f32_bf16 v61, v237, v65, v61
    v_dot2_f32_bf16 v63, v237, v237, v63
    v_dot2_f32_bf16 v60, v238, v65, v60
    v_dot2_f32_bf16 v62, v238, v238, v62
    v_dot2_f32_bf16 v61, v239, v65, v61
    v_dot2_f32_bf16 v63, v239, v239, v63
    s_add_u32 m0, s61, 12288
    s_add_u32 s41, s41, s50
    buffer_load_dwordx4 v16, s[12:15], s41 offen offset:0 lds
    s_waitcnt lgkmcnt(0)
    ds_write_b128 v56, v[32:35] offset:36864
    ds_write_b128 v57, v[36:39] offset:36864
    ds_write_b128 v58, v[40:43] offset:36864
    ds_write_b128 v59, v[44:47] offset:36864
    s_waitcnt vmcnt(5) lgkmcnt(0)
    s_barrier
    ds_read_b64_tr_b16 a[96:97], v1 offset:0
    ds_read_b64_tr_b16 a[98:99], v1 offset:512
    ds_read_b64_tr_b16 a[100:101], v2 offset:0
    ds_read_b64_tr_b16 a[102:103], v2 offset:512
    ds_read_b64_tr_b16 a[104:105], v5 offset:0
    ds_read_b64_tr_b16 a[106:107], v5 offset:512
    ds_read_b64_tr_b16 a[108:109], v6 offset:0
    ds_read_b64_tr_b16 a[110:111], v6 offset:512
    ds_read_b64_tr_b16 a[112:113], v7 offset:0
    ds_read_b64_tr_b16 a[114:115], v7 offset:512
    ds_read_b64_tr_b16 a[116:117], v8 offset:0
    ds_read_b64_tr_b16 a[118:119], v8 offset:512
    v_dot2_f32_bf16 v60, v240, v65, v60
    v_dot2_f32_bf16 v62, v240, v240, v62
    v_dot2_f32_bf16 v61, v241, v65, v61
    v_dot2_f32_bf16 v63, v241, v241, v63
    v_dot2_f32_bf16 v60, v242, v65, v60
    v_dot2_f32_bf16 v62, v242, v242, v62
    v_dot2_f32_bf16 v61, v243, v65, v61
    v_dot2_f32_bf16 v63, v243, v243, v63
    v_dot2_f32_bf16 v60, v244, v65, v60
    v_dot2_f32_bf16 v62, v244, v244, v62
    v_dot2_f32_bf16 v61, v245, v65, v61
    v_dot2_f32_bf16 v63, v245, v245, v63
    v_dot2_f32_bf16 v60, v246, v65, v60
    v_dot2_f32_bf16 v62, v246, v246, v62
    v_dot2_f32_bf16 v61, v247, v65, v61
    v_dot2_f32_bf16 v63, v247, v247, v63
    v_dot2_f32_bf16 v60, v248, v65, v60
    v_dot2_f32_bf16 v62, v248, v248, v62
    v_dot2_f32_bf16 v61, v249, v65, v61
    v_dot2_f32_bf16 v63, v249, v249, v63
    v_dot2_f32_bf16 v60, v250, v65, v60
    v_dot2_f32_bf16 v62, v250, v250, v62
    v_dot2_f32_bf16 v61, v251, v65, v61
    v_dot2_f32_bf16 v63, v251, v251, v63
    v_dot2_f32_bf16 v60, v252, v65, v60
    v_dot2_f32_bf16 v62, v252, v252, v62
    v_dot2_f32_bf16 v61, v253, v65, v61
    v_dot2_f32_bf16 v63, v253, v253, v63
    v_dot2_f32_bf16 v60, v254, v65, v60
    v_dot2_f32_bf16 v62, v254, v254, v62
    v_dot2_f32_bf16 v61, v255, v65, v61
    v_dot2_f32_bf16 v63, v255, v255, v63
    s_nop 1
    v_add_f32 v60, v60, v61
    v_add_f32 v62, v62, v63
    v_mov_b32 v61, v60
    v_mov_b32 v63, v62
    s_nop 0
    v_permlane32_swap_b32 v60, v61
    v_permlane32_swap_b32 v62, v63
    v_add_f32 v60, v60, v61
    v_add_f32 v62, v62, v63
    v_mul_f32 v60, 0x3b000000, v60
    v_mul_f32 v62, 0x3b000000, v62
    v_fma_f32 v62, -v60, v60, v62
    v_max_f32 v62, 0, v62
    v_cvt_pk_bf16_f32 v66, v60, v62
    v_and_b32 v67, s62, v66
    v_add_f32 v67, 0x3727c5ac, v67
    v_cvt_pk_bf16_f32 v67, v67, v67
    v_and_b32 v67, s62, v67
    v_sqrt_f32 v67, v67
    v_lshlrev_b32 v66, 16, v66
    v_cvt_pk_bf16_f32 v67, v67, v67
    v_and_b32 v67, s62, v67
    v_rcp_f32 v10, v67
    s_nop 0
    v_mul_f32_e64 v11, -v66, v10
    v_lshlrev_b32 v12, 16, v128
    v_and_b32 v13, s62, v128
    v_pk_fma_f32 v[12:13], v[12:13], v[10:11], v[10:11] op_sel:[0,0,1] op_sel_hi:[1,0,1]
    v_cvt_pk_bf16_f32 v128, v12, v13
    v_lshlrev_b32 v14, 16, v129
    v_and_b32 v15, s62, v129
    v_pk_fma_f32 v[14:15], v[14:15], v[10:11], v[10:11] op_sel:[0,0,1] op_sel_hi:[1,0,1]
    v_cvt_pk_bf16_f32 v129, v14, v15
    v_lshlrev_b32 v12, 16, v130
    v_and_b32 v13, s62, v130
    v_pk_fma_f32 v[12:13], v[12:13], v[10:11], v[10:11] op_sel:[0,0,1] op_sel_hi:[1,0,1]
    v_cvt_pk_bf16_f32 v130, v12, v13
    v_lshlrev_b32 v14, 16, v131
    v_and_b32 v15, s62, v131
    v_pk_fma_f32 v[14:15], v[14:15], v[10:11], v[10:11] op_sel:[0,0,1] op_sel_hi:[1,0,1]
    v_cvt_pk_bf16_f32 v131, v14, v15
    buffer_load_dwordx4 v17, s[12:15], s41 offen offset:1024 lds
    s_nop 0
    s_waitcnt lgkmcnt(6)
    v_mfma_f32_32x32x16_bf16 v[32:47], a[96:99], v[128:131], 0
    ds_read_b64_tr_b16 a[120:121], v1 offset:2048
    ds_read_b64_tr_b16 a[122:123], v1 offset:2560
    buffer_load_dwordx4 v18, s[12:15], s41 offen offset:2048 lds
    v_lshlrev_b32 v12, 16, v132
    v_mfma_f32_32x32x16_bf16 v[48:63], a[100:103], v[128:131], 0
    ds_read_b64_tr_b16 a[124:125], v2 offset:2048
    ds_read_b64_tr_b16 a[126:127], v2 offset:2560
    buffer_load_dwordx4 v19, s[12:15], s41 offen offset:3072 lds
    v_and_b32 v13, s62, v132
    v_fma_f32 v12, v12, v10, v11
    v_mfma_f32_32x32x16_bf16 v[64:79], a[104:107], v[128:131], 0
    ds_read_b64_tr_b16 a[96:97], v5 offset:2048
    ds_read_b64_tr_b16 a[98:99], v5 offset:2560
    s_add_u32 m0, s61, 16384
    s_nop 0
    buffer_load_dwordx4 v16, s[12:15], s42 offen offset:0 lds
    v_fma_f32 v13, v13, v10, v11
    v_cvt_pk_bf16_f32 v132, v12, v13
    v_lshlrev_b32 v14, 16, v133
    v_and_b32 v15, s62, v133
    v_fma_f32 v14, v14, v10, v11
    s_waitcnt lgkmcnt(6)
    v_mfma_f32_32x32x16_bf16 v[80:95], a[108:111], v[128:131], 0
    ds_read_b64_tr_b16 a[100:101], v6 offset:2048
    ds_read_b64_tr_b16 a[102:103], v6 offset:2560
    buffer_load_dwordx4 v17, s[12:15], s42 offen offset:1024 lds
    v_fma_f32 v15, v15, v10, v11
    v_cvt_pk_bf16_f32 v133, v14, v15
    v_lshlrev_b32 v12, 16, v134
    v_and_b32 v13, s62, v134
    v_fma_f32 v12, v12, v10, v11
    v_fma_f32 v13, v13, v10, v11
    v_mfma_f32_32x32x16_bf16 v[96:111], a[112:115], v[128:131], 0
    ds_read_b64_tr_b16 a[104:105], v7 offset:2048
    ds_read_b64_tr_b16 a[106:107], v7 offset:2560
    buffer_load_dwordx4 v18, s[12:15], s42 offen offset:2048 lds
    v_cvt_pk_bf16_f32 v134, v12, v13
    v_lshlrev_b32 v14, 16, v135
    v_and_b32 v15, s62, v135
    v_fma_f32 v14, v14, v10, v11
    v_fma_f32 v15, v15, v10, v11
    v_cvt_pk_bf16_f32 v135, v14, v15
    v_mfma_f32_32x32x16_bf16 v[112:127], a[116:119], v[128:131], 0
    ds_read_b64_tr_b16 a[108:109], v8 offset:2048
    ds_read_b64_tr_b16 a[110:111], v8 offset:2560
    buffer_load_dwordx4 v19, s[12:15], s42 offen offset:3072 lds
    v_lshlrev_b32 v12, 16, v136
    v_and_b32 v13, s62, v136
    s_waitcnt lgkmcnt(6)
    v_mfma_f32_32x32x16_bf16 v[32:47], a[120:123], v[132:135], v[32:47]
    ds_read_b128 a[72:75], v28 offset:36864
    ds_read_b64_tr_b16 a[112:113], v9 offset:0
    ds_read_b64_tr_b16 a[114:115], v9 offset:512
    s_add_u32 m0, s61, 20480
    s_add_u32 s42, s42, s50
    buffer_load_dwordx4 v16, s[12:15], s42 offen offset:0 lds
    v_mfma_f32_32x32x16_bf16 v[48:63], a[124:127], v[132:135], v[48:63]
    ds_read_b64_tr_b16 a[116:117], v1 offset:4096
    ds_read_b64_tr_b16 a[118:119], v1 offset:4608
    buffer_load_dwordx4 v17, s[12:15], s42 offen offset:1024 lds
    v_fma_f32 v12, v12, v10, v11
    v_fma_f32 v13, v13, v10, v11
    v_mfma_f32_32x32x16_bf16 v[64:79], a[96:99], v[132:135], v[64:79]
    ds_read_b64_tr_b16 a[120:121], v2 offset:4096
    ds_read_b64_tr_b16 a[122:123], v2 offset:4608
    buffer_load_dwordx4 v18, s[12:15], s42 offen offset:2048 lds
    v_cvt_pk_bf16_f32 v136, v12, v13
    v_lshlrev_b32 v14, 16, v137
    s_waitcnt lgkmcnt(7)
    v_mfma_f32_32x32x16_bf16 v[80:95], a[100:103], v[132:135], v[80:95]
    ds_read_b64_tr_b16 a[124:125], v5 offset:4096
    ds_read_b64_tr_b16 a[126:127], v5 offset:4608
    buffer_load_dwordx4 v19, s[12:15], s42 offen offset:3072 lds
    v_and_b32 v15, s62, v137
    v_fma_f32 v14, v14, v10, v11
    v_mfma_f32_32x32x16_bf16 v[96:111], a[104:107], v[132:135], v[96:111]
    ds_read_b64_tr_b16 a[96:97], v6 offset:4096
    ds_read_b64_tr_b16 a[98:99], v6 offset:4608
    s_add_u32 m0, s61, 24576
    s_nop 0
    buffer_load_dwordx4 v16, s[12:15], s43 offen offset:0 lds
    v_fma_f32 v15, v15, v10, v11
    v_cvt_pk_bf16_f32 v137, v14, v15
    v_lshlrev_b32 v12, 16, v138
    v_and_b32 v13, s62, v138
    v_fma_f32 v12, v12, v10, v11
    v_fma_f32 v13, v13, v10, v11
    v_mfma_f32_32x32x16_bf16 v[112:127], a[108:111], v[132:135], v[112:127]
    ds_read_b64_tr_b16 a[100:101], v7 offset:4096
    ds_read_b64_tr_b16 a[102:103], v7 offset:4608
    buffer_load_dwordx4 v17, s[12:15], s43 offen offset:1024 lds
    v_cvt_pk_bf16_f32 v138, v12, v13
    v_lshlrev_b32 v14, 16, v139
    v_and_b32 v15, s62, v139
    v_fma_f32 v14, v14, v10, v11
    v_fma_f32 v15, v15, v10, v11
    v_cvt_pk_bf16_f32 v139, v14, v15
    s_waitcnt lgkmcnt(6)
    v_mfma_f32_16x16x32_bf16 a[64:67], a[112:115], a[72:75], 0
    ds_read_b64_tr_b16 a[104:105], v8 offset:4096
    ds_read_b64_tr_b16 a[106:107], v8 offset:4608
    v_mfma_f32_32x32x16_bf16 v[32:47], a[116:119], v[136:139], v[32:47]
    ds_read_b64_tr_b16 a[108:109], v1 offset:6144
    ds_read_b64_tr_b16 a[110:111], v1 offset:6656
    buffer_load_dwordx4 v18, s[12:15], s43 offen offset:2048 lds
    v_lshlrev_b32 v12, 16, v140
    v_and_b32 v13, s62, v140
    v_mfma_f32_32x32x16_bf16 v[48:63], a[120:123], v[136:139], v[48:63]
    ds_read_b64_tr_b16 a[112:113], v2 offset:6144
    ds_read_b64_tr_b16 a[114:115], v2 offset:6656
    buffer_load_dwordx4 v19, s[12:15], s43 offen offset:3072 lds
    v_fma_f32 v12, v12, v10, v11
    v_fma_f32 v13, v13, v10, v11
    s_waitcnt lgkmcnt(6)
    v_mfma_f32_32x32x16_bf16 v[64:79], a[124:127], v[136:139], v[64:79]
    ds_read_b64_tr_b16 a[116:117], v5 offset:6144
    ds_read_b64_tr_b16 a[118:119], v5 offset:6656
    s_add_u32 m0, s61, 28672
    s_add_u32 s43, s43, s50
    buffer_load_dwordx4 v16, s[12:15], s43 offen offset:0 lds
    v_cvt_pk_bf16_f32 v140, v12, v13
    v_lshlrev_b32 v14, 16, v141
    v_and_b32 v15, s62, v141
    v_fma_f32 v14, v14, v10, v11
    v_mfma_f32_32x32x16_bf16 v[80:95], a[96:99], v[136:139], v[80:95]
    ds_read_b64_tr_b16 a[120:121], v6 offset:6144
    ds_read_b64_tr_b16 a[122:123], v6 offset:6656
    buffer_load_dwordx4 v17, s[12:15], s43 offen offset:1024 lds
    v_fma_f32 v15, v15, v10, v11
    v_cvt_pk_bf16_f32 v141, v14, v15
    v_lshlrev_b32 v12, 16, v142
    v_and_b32 v13, s62, v142
    v_fma_f32 v12, v12, v10, v11
    v_fma_f32 v13, v13, v10, v11
    v_mfma_f32_32x32x16_bf16 v[96:111], a[100:103], v[136:139], v[96:111]
    ds_read_b64_tr_b16 a[124:125], v7 offset:6144
    ds_read_b64_tr_b16 a[126:127], v7 offset:6656
    buffer_load_dwordx4 v18, s[12:15], s43 offen offset:2048 lds
    v_cvt_pk_bf16_f32 v142, v12, v13
    v_lshlrev_b32 v14, 16, v143
    v_and_b32 v15, s62, v143
    v_fma_f32 v14, v14, v10, v11
    v_fma_f32 v15, v15, v10, v11
    v_cvt_pk_bf16_f32 v143, v14, v15
    s_waitcnt lgkmcnt(6)
    v_mfma_f32_32x32x16_bf16 v[112:127], a[104:107], v[136:139], v[112:127]
    ds_read_b64_tr_b16 a[96:97], v8 offset:6144
    ds_read_b64_tr_b16 a[98:99], v8 offset:6656
    buffer_load_dwordx4 v19, s[12:15], s43 offen offset:3072 lds
    v_lshlrev_b32 v12, 16, v144
    v_mfma_f32_32x32x16_bf16 v[32:47], a[108:111], v[140:143], v[32:47]
    ds_read_b128 a[76:79], v29 offset:36864
    ds_read_b64_tr_b16 a[100:101], v9 offset:4096
    ds_read_b64_tr_b16 a[102:103], v9 offset:4608
    v_and_b32 v13, s62, v144
    v_fma_f32 v12, v12, v10, v11
    v_fma_f32 v13, v13, v10, v11
    v_mfma_f32_32x32x16_bf16 v[48:63], a[112:115], v[140:143], v[48:63]
    s_waitcnt vmcnt(16)
    s_barrier
    ds_read_b64_tr_b16 a[104:105], v1 offset:8192
    ds_read_b64_tr_b16 a[106:107], v1 offset:8704
    s_add_u32 m0, s61, 32768
    s_lshl_b32 s63, s75, 4
    s_waitcnt lgkmcnt(7)
    v_mfma_f32_32x32x16_bf16 v[64:79], a[116:119], v[140:143], v[64:79]
    ds_read_b64_tr_b16 a[108:109], v2 offset:8192
    ds_read_b64_tr_b16 a[110:111], v2 offset:8704
    s_add_u32 s63, s63, s53
    buffer_load_dwordx4 v24, s[20:23], s63 offen offset:0 lds
    v_mfma_f32_32x32x16_bf16 v[80:95], a[120:123], v[140:143], v[80:95]
    ds_read_b64_tr_b16 a[112:113], v5 offset:8192
    ds_read_b64_tr_b16 a[114:115], v5 offset:8704
    buffer_load_dwordx4 v25, s[20:23], s63 offen offset:1024 lds
    v_cvt_pk_bf16_f32 v144, v12, v13
    v_lshlrev_b32 v14, 16, v145
    v_and_b32 v15, s62, v145
    v_fma_f32 v14, v14, v10, v11
    v_mfma_f32_32x32x16_bf16 v[96:111], a[124:127], v[140:143], v[96:111]
    ds_read_b64_tr_b16 a[116:117], v6 offset:8192
    ds_read_b64_tr_b16 a[118:119], v6 offset:8704
    s_add_u32 s63, s63, 14336
    buffer_load_dwordx4 v24, s[20:23], s63 offen offset:2048 lds
    v_fma_f32 v15, v15, v10, v11
    v_cvt_pk_bf16_f32 v145, v14, v15
    v_lshlrev_b32 v12, 16, v146
    v_and_b32 v13, s62, v146
    v_fma_f32 v12, v12, v10, v11
    v_fma_f32 v13, v13, v10, v11
    s_waitcnt lgkmcnt(6)
    v_mfma_f32_32x32x16_bf16 v[112:127], a[96:99], v[140:143], v[112:127]
    ds_read_b64_tr_b16 a[120:121], v7 offset:8192
    ds_read_b64_tr_b16 a[122:123], v7 offset:8704
    buffer_load_dwordx4 v25, s[20:23], s63 offen offset:3072 lds
    v_cvt_pk_bf16_f32 v146, v12, v13
    v_lshlrev_b32 v14, 16, v147
    v_and_b32 v15, s62, v147
    v_fma_f32 v14, v14, v10, v11
    v_fma_f32 v15, v15, v10, v11
    v_cvt_pk_bf16_f32 v147, v14, v15
    v_mfma_f32_16x16x32_bf16 a[64:67], a[100:103], a[76:79], a[64:67]
    ds_read_b64_tr_b16 a[124:125], v8 offset:8192
    ds_read_b64_tr_b16 a[126:127], v8 offset:8704
    v_mfma_f32_32x32x16_bf16 v[32:47], a[104:107], v[144:147], v[32:47]
    ds_read_b64_tr_b16 a[96:97], v1 offset:10240
    ds_read_b64_tr_b16 a[98:99], v1 offset:10752
    v_lshlrev_b32 v12, 16, v148
    v_and_b32 v13, s62, v148
    v_fma_f32 v12, v12, v10, v11
    v_fma_f32 v13, v13, v10, v11
    s_waitcnt lgkmcnt(6)
    v_mfma_f32_32x32x16_bf16 v[48:63], a[108:111], v[144:147], v[48:63]
    ds_read_b64_tr_b16 a[100:101], v2 offset:10240
    ds_read_b64_tr_b16 a[102:103], v2 offset:10752
    v_cvt_pk_bf16_f32 v148, v12, v13
    v_lshlrev_b32 v14, 16, v149
    v_and_b32 v15, s62, v149
    v_mfma_f32_32x32x16_bf16 v[64:79], a[112:115], v[144:147], v[64:79]
    ds_read_b64_tr_b16 a[104:105], v5 offset:10240
    ds_read_b64_tr_b16 a[106:107], v5 offset:10752
    v_fma_f32 v14, v14, v10, v11
    v_fma_f32 v15, v15, v10, v11
    v_cvt_pk_bf16_f32 v149, v14, v15
    v_lshlrev_b32 v12, 16, v150
    v_mfma_f32_32x32x16_bf16 v[80:95], a[116:119], v[144:147], v[80:95]
    ds_read_b64_tr_b16 a[108:109], v6 offset:10240
    ds_read_b64_tr_b16 a[110:111], v6 offset:10752
    v_and_b32 v13, s62, v150
    v_fma_f32 v12, v12, v10, v11
    v_fma_f32 v13, v13, v10, v11
    v_cvt_pk_bf16_f32 v150, v12, v13
    s_waitcnt lgkmcnt(6)
    v_mfma_f32_32x32x16_bf16 v[96:111], a[120:123], v[144:147], v[96:111]
    ds_read_b64_tr_b16 a[112:113], v7 offset:10240
    ds_read_b64_tr_b16 a[114:115], v7 offset:10752
    v_lshlrev_b32 v14, 16, v151
    v_and_b32 v15, s62, v151
    v_fma_f32 v14, v14, v10, v11
    v_fma_f32 v15, v15, v10, v11
    v_cvt_pk_bf16_f32 v151, v14, v15
    v_mfma_f32_32x32x16_bf16 v[112:127], a[124:127], v[144:147], v[112:127]
    ds_read_b64_tr_b16 a[116:117], v8 offset:10240
    ds_read_b64_tr_b16 a[118:119], v8 offset:10752
    v_lshlrev_b32 v12, 16, v152
    v_and_b32 v13, s62, v152
    v_fma_f32 v12, v12, v10, v11
    v_fma_f32 v13, v13, v10, v11
    v_mfma_f32_32x32x16_bf16 v[32:47], a[96:99], v[148:151], v[32:47]
    ds_read_b128 a[72:75], v28 offset:36992
    ds_read_b64_tr_b16 a[120:121], v9 offset:8192
    ds_read_b64_tr_b16 a[122:123], v9 offset:8704
    v_cvt_pk_bf16_f32 v152, v12, v13
    v_lshlrev_b32 v14, 16, v153
    v_and_b32 v15, s62, v153
    s_waitcnt lgkmcnt(7)
    v_mfma_f32_32x32x16_bf16 v[48:63], a[100:103], v[148:151], v[48:63]
    ds_read_b64_tr_b16 a[124:125], v1 offset:12288
    ds_read_b64_tr_b16 a[126:127], v1 offset:12800
    v_fma_f32 v14, v14, v10, v11
    v_fma_f32 v15, v15, v10, v11
    v_cvt_pk_bf16_f32 v153, v14, v15
    v_mfma_f32_32x32x16_bf16 v[64:79], a[104:107], v[148:151], v[64:79]
    ds_read_b64_tr_b16 a[96:97], v2 offset:12288
    ds_read_b64_tr_b16 a[98:99], v2 offset:12800
    v_lshlrev_b32 v12, 16, v154
    v_and_b32 v13, s62, v154
    v_fma_f32 v12, v12, v10, v11
    v_fma_f32 v13, v13, v10, v11
    v_mfma_f32_32x32x16_bf16 v[80:95], a[108:111], v[148:151], v[80:95]
    ds_read_b64_tr_b16 a[100:101], v5 offset:12288
    ds_read_b64_tr_b16 a[102:103], v5 offset:12800
    v_cvt_pk_bf16_f32 v154, v12, v13
    v_lshlrev_b32 v14, 16, v155
    v_and_b32 v15, s62, v155
    v_fma_f32 v14, v14, v10, v11
    s_waitcnt lgkmcnt(6)
    v_mfma_f32_32x32x16_bf16 v[96:111], a[112:115], v[148:151], v[96:111]
    ds_read_b64_tr_b16 a[104:105], v6 offset:12288
    ds_read_b64_tr_b16 a[106:107], v6 offset:12800
    v_fma_f32 v15, v15, v10, v11
    v_cvt_pk_bf16_f32 v155, v14, v15
    v_lshlrev_b32 v12, 16, v156
    v_mfma_f32_32x32x16_bf16 v[112:127], a[116:119], v[148:151], v[112:127]
    ds_read_b64_tr_b16 a[108:109], v7 offset:12288
    ds_read_b64_tr_b16 a[110:111], v7 offset:12800
    v_and_b32 v13, s62, v156
    v_fma_f32 v12, v12, v10, v11
    v_fma_f32 v13, v13, v10, v11
    v_cvt_pk_bf16_f32 v156, v12, v13
    v_mfma_f32_16x16x32_bf16 a[64:67], a[120:123], a[72:75], a[64:67]
    ds_read_b64_tr_b16 a[112:113], v8 offset:12288
    ds_read_b64_tr_b16 a[114:115], v8 offset:12800
    s_waitcnt lgkmcnt(6)
    v_mfma_f32_32x32x16_bf16 v[32:47], a[124:127], v[152:155], v[32:47]
    ds_read_b64_tr_b16 a[116:117], v1 offset:14336
    ds_read_b64_tr_b16 a[118:119], v1 offset:14848
    v_lshlrev_b32 v14, 16, v157
    v_and_b32 v15, s62, v157
    v_fma_f32 v14, v14, v10, v11
    v_mfma_f32_32x32x16_bf16 v[48:63], a[96:99], v[152:155], v[48:63]
    ds_read_b64_tr_b16 a[120:121], v2 offset:14336
    ds_read_b64_tr_b16 a[122:123], v2 offset:14848
    v_fma_f32 v15, v15, v10, v11
    v_cvt_pk_bf16_f32 v157, v14, v15
    v_lshlrev_b32 v12, 16, v158
    v_and_b32 v13, s62, v158
    v_mfma_f32_32x32x16_bf16 v[64:79], a[100:103], v[152:155], v[64:79]
    ds_read_b64_tr_b16 a[124:125], v5 offset:14336
    ds_read_b64_tr_b16 a[126:127], v5 offset:14848
    v_fma_f32 v12, v12, v10, v11
    v_fma_f32 v13, v13, v10, v11
    v_cvt_pk_bf16_f32 v158, v12, v13
    v_lshlrev_b32 v14, 16, v159
    s_waitcnt lgkmcnt(6)
    v_mfma_f32_32x32x16_bf16 v[80:95], a[104:107], v[152:155], v[80:95]
    ds_read_b64_tr_b16 a[96:97], v6 offset:14336
    ds_read_b64_tr_b16 a[98:99], v6 offset:14848
    v_and_b32 v15, s62, v159
    v_fma_f32 v14, v14, v10, v11
    v_fma_f32 v15, v15, v10, v11
    v_mfma_f32_32x32x16_bf16 v[96:111], a[108:111], v[152:155], v[96:111]
    ds_read_b64_tr_b16 a[100:101], v7 offset:14336
    ds_read_b64_tr_b16 a[102:103], v7 offset:14848
    v_cvt_pk_bf16_f32 v159, v14, v15
    v_lshlrev_b32 v12, 16, v160
    v_and_b32 v13, s62, v160
    v_fma_f32 v12, v12, v10, v11
    v_mfma_f32_32x32x16_bf16 v[112:127], a[112:115], v[152:155], v[112:127]
    ds_read_b64_tr_b16 a[104:105], v8 offset:14336
    ds_read_b64_tr_b16 a[106:107], v8 offset:14848
    v_fma_f32 v13, v13, v10, v11
    v_cvt_pk_bf16_f32 v160, v12, v13
    v_lshlrev_b32 v14, 16, v161
    v_and_b32 v15, s62, v161
    s_waitcnt lgkmcnt(6)
    v_mfma_f32_32x32x16_bf16 v[32:47], a[116:119], v[156:159], v[32:47]
    ds_read_b128 a[76:79], v29 offset:36992
    ds_read_b64_tr_b16 a[108:109], v9 offset:12288
    ds_read_b64_tr_b16 a[110:111], v9 offset:12800
    v_fma_f32 v14, v14, v10, v11
    v_fma_f32 v15, v15, v10, v11
    v_mfma_f32_32x32x16_bf16 v[48:63], a[120:123], v[156:159], v[48:63]
    s_waitcnt vmcnt(12)
    s_barrier
    ds_read_b64_tr_b16 a[112:113], v1 offset:16384
    ds_read_b64_tr_b16 a[114:115], v1 offset:16896
    s_waitcnt vmcnt(2)
    ds_read_b64_tr_b16 a[128:129], v26 offset:32768
    s_add_u32 m0, s61, 0
    s_nop 0
    buffer_load_dwordx4 v16, s[12:15], s44 offen offset:0 lds
    v_mfma_f32_32x32x16_bf16 v[64:79], a[124:127], v[156:159], v[64:79]
    ds_read_b64_tr_b16 a[116:117], v2 offset:16384
    ds_read_b64_tr_b16 a[118:119], v2 offset:16896
    ds_read_b64_tr_b16 a[130:131], v26 offset:33792
    buffer_load_dwordx4 v17, s[12:15], s44 offen offset:1024 lds
    v_cvt_pk_bf16_f32 v161, v14, v15
    s_waitcnt lgkmcnt(9)
    v_mfma_f32_32x32x16_bf16 v[80:95], a[96:99], v[156:159], v[80:95]
    ds_read_b64_tr_b16 a[120:121], v5 offset:16384
    ds_read_b64_tr_b16 a[122:123], v5 offset:16896
    ds_read_b64_tr_b16 a[132:133], v27 offset:32768
    buffer_load_dwordx4 v18, s[12:15], s44 offen offset:2048 lds
    v_mfma_f32_32x32x16_bf16 v[96:111], a[100:103], v[156:159], v[96:111]
    ds_read_b64_tr_b16 a[124:125], v6 offset:16384
    ds_read_b64_tr_b16 a[126:127], v6 offset:16896
    ds_read_b64_tr_b16 a[134:135], v27 offset:33792
    buffer_load_dwordx4 v19, s[12:15], s44 offen offset:3072 lds
    v_lshlrev_b32 v12, 16, v162
    v_and_b32 v13, s62, v162
    v_fma_f32 v12, v12, v10, v11
    v_fma_f32 v13, v13, v10, v11
    v_mfma_f32_32x32x16_bf16 v[112:127], a[104:107], v[156:159], v[112:127]
    s_waitcnt lgkmcnt(14)
    ds_read_b64_tr_b16 a[96:97], v7 offset:16384
    s_waitcnt lgkmcnt(14)
    ds_read_b64_tr_b16 a[98:99], v7 offset:16896
    s_waitcnt vmcnt(4)
    s_add_u32 m0, s61, 4096
    s_add_u32 s44, s44, s50
    buffer_load_dwordx4 v16, s[12:15], s44 offen offset:0 lds
    v_cvt_pk_bf16_f32 v162, v12, v13
    v_lshlrev_b32 v14, 16, v163
    v_and_b32 v15, s62, v163
    v_fma_f32 v14, v14, v10, v11
    v_fma_f32 v15, v15, v10, v11
    v_cvt_pk_bf16_f32 v163, v14, v15
    s_waitcnt lgkmcnt(9)
    v_mfma_f32_16x16x32_bf16 a[64:67], a[108:111], a[76:79], a[64:67]
    ds_read_b64_tr_b16 a[100:101], v8 offset:16384
    ds_read_b64_tr_b16 a[102:103], v8 offset:16896
    v_mfma_f32_32x32x16_bf16 v[32:47], a[112:115], v[160:163], v[32:47]
    ds_read_b64_tr_b16 a[104:105], v1 offset:18432
    ds_read_b64_tr_b16 a[106:107], v1 offset:18944
    ds_read_b64_tr_b16 a[136:137], v26 offset:34816
    buffer_load_dwordx4 v17, s[12:15], s44 offen offset:1024 lds
    v_lshlrev_b32 v12, 16, v164
    v_mfma_f32_32x32x16_bf16 v[48:63], a[116:119], v[160:163], v[48:63]
    ds_read_b64_tr_b16 a[108:109], v2 offset:18432
    s_waitcnt lgkmcnt(14)
    ds_read_b64_tr_b16 a[110:111], v2 offset:18944
    buffer_load_dwordx4 v18, s[12:15], s44 offen offset:2048 lds
    v_and_b32 v13, s62, v164
    v_fma_f32 v12, v12, v10, v11
    s_waitcnt lgkmcnt(7)
    v_mfma_f32_32x32x16_bf16 v[64:79], a[120:123], v[160:163], v[64:79]
    ds_read_b64_tr_b16 a[112:113], v5 offset:18432
    ds_read_b64_tr_b16 a[114:115], v5 offset:18944
    ds_read_b64_tr_b16 a[138:139], v26 offset:35840
    buffer_load_dwordx4 v19, s[12:15], s44 offen offset:3072 lds
    v_fma_f32 v13, v13, v10, v11
    v_cvt_pk_bf16_f32 v164, v12, v13
    v_lshlrev_b32 v14, 16, v165
    v_and_b32 v15, s62, v165
    v_fma_f32 v14, v14, v10, v11
    v_mfma_f32_32x32x16_bf16 v[80:95], a[124:127], v[160:163], v[80:95]
    ds_read_b64_tr_b16 a[116:117], v6 offset:18432
    ds_read_b64_tr_b16 a[118:119], v6 offset:18944
    ds_read_b64_tr_b16 a[140:141], v27 offset:34816
    v_fma_f32 v15, v15, v10, v11
    v_cvt_pk_bf16_f32 v165, v14, v15
    v_lshlrev_b32 v12, 16, v166
    v_and_b32 v13, s62, v166
    v_fma_f32 v12, v12, v10, v11
    v_fma_f32 v13, v13, v10, v11
    v_mfma_f32_32x32x16_bf16 v[96:111], a[96:99], v[160:163], v[96:111]
    ds_read_b64_tr_b16 a[120:121], v7 offset:18432
    ds_read_b64_tr_b16 a[122:123], v7 offset:18944
    v_cvt_pk_bf16_f32 v166, v12, v13
    v_lshlrev_b32 v14, 16, v167
    v_and_b32 v15, s62, v167
    v_fma_f32 v14, v14, v10, v11
    v_fma_f32 v15, v15, v10, v11
    v_cvt_pk_bf16_f32 v167, v14, v15
    s_waitcnt lgkmcnt(8)
    v_mfma_f32_32x32x16_bf16 v[112:127], a[100:103], v[160:163], v[112:127]
    ds_read_b64_tr_b16 a[124:125], v8 offset:18432
    ds_read_b64_tr_b16 a[126:127], v8 offset:18944
    ds_read_b64_tr_b16 a[142:143], v27 offset:35840
    s_waitcnt lgkmcnt(0)
    s_add_u32 m0, s61, 32768
    v_mfma_f32_32x32x16_bf16 v[32:47], a[104:107], v[164:167], v[32:47]
    ds_read_b128 a[72:75], v28 offset:37120
    ds_read_b64_tr_b16 a[96:97], v9 offset:16384
    ds_read_b64_tr_b16 a[98:99], v9 offset:16896
    s_lshl_b32 s63, s75, 4
    s_add_u32 s63, s63, s53
    s_add_u32 s63, s63, 32768
    buffer_load_dwordx4 v24, s[20:23], s63 offen offset:0 lds
    v_mfma_f32_32x32x16_bf16 v[48:63], a[108:111], v[164:167], v[48:63]
    ds_read_b64_tr_b16 a[100:101], v1 offset:20480
    ds_read_b64_tr_b16 a[102:103], v1 offset:20992
    buffer_load_dwordx4 v25, s[20:23], s63 offen offset:1024 lds
    v_lshlrev_b32 v12, 16, v168
    v_and_b32 v13, s62, v168
    v_mfma_f32_32x32x16_bf16 v[64:79], a[112:115], v[164:167], v[64:79]
    ds_read_b64_tr_b16 a[104:105], v2 offset:20480
    ds_read_b64_tr_b16 a[106:107], v2 offset:20992
    s_add_u32 s63, s63, 14336
    buffer_load_dwordx4 v24, s[20:23], s63 offen offset:2048 lds
    v_fma_f32 v12, v12, v10, v11
    v_mfma_f32_32x32x16_bf16 v[80:95], a[116:119], v[164:167], v[80:95]
    ds_read_b64_tr_b16 a[108:109], v5 offset:20480
    ds_read_b64_tr_b16 a[110:111], v5 offset:20992
    buffer_load_dwordx4 v25, s[20:23], s63 offen offset:3072 lds
    v_fma_f32 v13, v13, v10, v11
    v_cvt_pk_bf16_f32 v168, v12, v13
    v_lshlrev_b32 v14, 16, v169
    v_and_b32 v15, s62, v169
    v_fma_f32 v14, v14, v10, v11
    v_mfma_f32_32x32x16_bf16 v[96:111], a[120:123], v[164:167], v[96:111]
    ds_read_b64_tr_b16 a[112:113], v6 offset:20480
    ds_read_b64_tr_b16 a[114:115], v6 offset:20992
    v_fma_f32 v15, v15, v10, v11
    v_cvt_pk_bf16_f32 v169, v14, v15
    v_lshlrev_b32 v12, 16, v170
    v_and_b32 v13, s62, v170
    v_fma_f32 v12, v12, v10, v11
    v_fma_f32 v13, v13, v10, v11
    s_waitcnt lgkmcnt(6)
    v_mfma_f32_32x32x16_bf16 v[112:127], a[124:127], v[164:167], v[112:127]
    ds_read_b64_tr_b16 a[116:117], v7 offset:20480
    ds_read_b64_tr_b16 a[118:119], v7 offset:20992
    v_cvt_pk_bf16_f32 v170, v12, v13
    v_lshlrev_b32 v14, 16, v171
    v_and_b32 v15, s62, v171
    v_fma_f32 v14, v14, v10, v11
    v_fma_f32 v15, v15, v10, v11
    v_cvt_pk_bf16_f32 v171, v14, v15
    v_mfma_f32_16x16x32_bf16 a[64:67], a[96:99], a[72:75], a[64:67]
    ds_read_b64_tr_b16 a[120:121], v8 offset:20480
    ds_read_b64_tr_b16 a[122:123], v8 offset:20992
    v_mfma_f32_32x32x16_bf16 v[32:47], a[100:103], v[168:171], v[32:47]
    ds_read_b64_tr_b16 a[124:125], v1 offset:22528
    ds_read_b64_tr_b16 a[126:127], v1 offset:23040
    v_lshlrev_b32 v12, 16, v172
    v_and_b32 v13, s62, v172
    v_fma_f32 v12, v12, v10, v11
    v_fma_f32 v13, v13, v10, v11
    s_waitcnt lgkmcnt(6)
    v_mfma_f32_32x32x16_bf16 v[48:63], a[104:107], v[168:171], v[48:63]
    ds_read_b64_tr_b16 a[96:97], v2 offset:22528
    ds_read_b64_tr_b16 a[98:99], v2 offset:23040
    v_cvt_pk_bf16_f32 v172, v12, v13
    v_lshlrev_b32 v14, 16, v173
    v_and_b32 v15, s62, v173
    v_mfma_f32_32x32x16_bf16 v[64:79], a[108:111], v[168:171], v[64:79]
    ds_read_b64_tr_b16 a[100:101], v5 offset:22528
    ds_read_b64_tr_b16 a[102:103], v5 offset:23040
    v_fma_f32 v14, v14, v10, v11
    v_fma_f32 v15, v15, v10, v11
    v_cvt_pk_bf16_f32 v173, v14, v15
    v_lshlrev_b32 v12, 16, v174
    v_mfma_f32_32x32x16_bf16 v[80:95], a[112:115], v[168:171], v[80:95]
    ds_read_b64_tr_b16 a[104:105], v6 offset:22528
    ds_read_b64_tr_b16 a[106:107], v6 offset:23040
    v_and_b32 v13, s62, v174
    v_fma_f32 v12, v12, v10, v11
    v_fma_f32 v13, v13, v10, v11
    v_cvt_pk_bf16_f32 v174, v12, v13
    s_waitcnt lgkmcnt(6)
    v_mfma_f32_32x32x16_bf16 v[96:111], a[116:119], v[168:171], v[96:111]
    ds_read_b64_tr_b16 a[108:109], v7 offset:22528
    ds_read_b64_tr_b16 a[110:111], v7 offset:23040
    v_lshlrev_b32 v14, 16, v175
    v_and_b32 v15, s62, v175
    v_fma_f32 v14, v14, v10, v11
    v_fma_f32 v15, v15, v10, v11
    v_cvt_pk_bf16_f32 v175, v14, v15
    v_mfma_f32_32x32x16_bf16 v[112:127], a[120:123], v[168:171], v[112:127]
    ds_read_b64_tr_b16 a[112:113], v8 offset:22528
    ds_read_b64_tr_b16 a[114:115], v8 offset:23040
    v_lshlrev_b32 v12, 16, v176
    v_and_b32 v13, s62, v176
    v_fma_f32 v12, v12, v10, v11
    v_fma_f32 v13, v13, v10, v11
    v_mfma_f32_32x32x16_bf16 v[32:47], a[124:127], v[172:175], v[32:47]
    ds_read_b128 a[76:79], v29 offset:37120
    ds_read_b64_tr_b16 a[116:117], v9 offset:20480
    ds_read_b64_tr_b16 a[118:119], v9 offset:20992
    v_cvt_pk_bf16_f32 v176, v12, v13
    v_lshlrev_b32 v14, 16, v177
    v_and_b32 v15, s62, v177
    s_waitcnt lgkmcnt(7)
    v_mfma_f32_32x32x16_bf16 v[48:63], a[96:99], v[172:175], v[48:63]
    s_barrier
    ds_read_b64_tr_b16 a[120:121], v1 offset:24576
    ds_read_b64_tr_b16 a[122:123], v1 offset:25088
    s_add_u32 m0, s61, 8192
    s_nop 0
    buffer_load_dwordx4 v16, s[12:15], s45 offen offset:0 lds
    v_mfma_f32_32x32x16_bf16 v[64:79], a[100:103], v[172:175], v[64:79]
    ds_read_b64_tr_b16 a[124:125], v2 offset:24576
    ds_read_b64_tr_b16 a[126:127], v2 offset:25088
    buffer_load_dwordx4 v17, s[12:15], s45 offen offset:1024 lds
    v_fma_f32 v14, v14, v10, v11
    v_fma_f32 v15, v15, v10, v11
    v_mfma_f32_32x32x16_bf16 v[80:95], a[104:107], v[172:175], v[80:95]
    ds_read_b64_tr_b16 a[96:97], v5 offset:24576
    ds_read_b64_tr_b16 a[98:99], v5 offset:25088
    buffer_load_dwordx4 v18, s[12:15], s45 offen offset:2048 lds
    v_cvt_pk_bf16_f32 v177, v14, v15
    v_lshlrev_b32 v12, 16, v178
    s_waitcnt lgkmcnt(6)
    v_mfma_f32_32x32x16_bf16 v[96:111], a[108:111], v[172:175], v[96:111]
    ds_read_b64_tr_b16 a[100:101], v6 offset:24576
    ds_read_b64_tr_b16 a[102:103], v6 offset:25088
    buffer_load_dwordx4 v19, s[12:15], s45 offen offset:3072 lds
    v_and_b32 v13, s62, v178
    v_fma_f32 v12, v12, v10, v11
    v_fma_f32 v13, v13, v10, v11
    v_mfma_f32_32x32x16_bf16 v[112:127], a[112:115], v[172:175], v[112:127]
    ds_read_b64_tr_b16 a[104:105], v7 offset:24576
    ds_read_b64_tr_b16 a[106:107], v7 offset:25088
    s_add_u32 m0, s61, 12288
    s_add_u32 s45, s45, s50
    buffer_load_dwordx4 v16, s[12:15], s45 offen offset:0 lds
    v_cvt_pk_bf16_f32 v178, v12, v13
    v_lshlrev_b32 v14, 16, v179
    v_and_b32 v15, s62, v179
    v_fma_f32 v14, v14, v10, v11
    v_fma_f32 v15, v15, v10, v11
    v_cvt_pk_bf16_f32 v179, v14, v15
    v_mfma_f32_16x16x32_bf16 a[64:67], a[116:119], a[76:79], a[64:67]
    ds_read_b64_tr_b16 a[108:109], v8 offset:24576
    ds_read_b64_tr_b16 a[110:111], v8 offset:25088
    s_waitcnt lgkmcnt(6)
    v_mfma_f32_32x32x16_bf16 v[32:47], a[120:123], v[176:179], v[32:47]
    ds_read_b64_tr_b16 a[112:113], v1 offset:26624
    ds_read_b64_tr_b16 a[114:115], v1 offset:27136
    s_waitcnt vmcnt(7)
    ds_read_b64_tr_b16 a[144:145], v26 offset:32768
    buffer_load_dwordx4 v17, s[12:15], s45 offen offset:1024 lds
    v_mfma_f32_32x32x16_bf16 v[48:63], a[124:127], v[176:179], v[48:63]
    ds_read_b64_tr_b16 a[116:117], v2 offset:26624
    ds_read_b64_tr_b16 a[118:119], v2 offset:27136
    ds_read_b64_tr_b16 a[146:147], v26 offset:33792
    buffer_load_dwordx4 v18, s[12:15], s45 offen offset:2048 lds
    v_lshlrev_b32 v12, 16, v180
    v_and_b32 v13, s62, v180
    v_mfma_f32_32x32x16_bf16 v[64:79], a[96:99], v[176:179], v[64:79]
    ds_read_b64_tr_b16 a[120:121], v5 offset:26624
    ds_read_b64_tr_b16 a[122:123], v5 offset:27136
    ds_read_b64_tr_b16 a[148:149], v27 offset:32768
    buffer_load_dwordx4 v19, s[12:15], s45 offen offset:3072 lds
    v_fma_f32 v12, v12, v10, v11
    v_fma_f32 v13, v13, v10, v11
    v_cvt_pk_bf16_f32 v180, v12, v13
    v_lshlrev_b32 v14, 16, v181
    v_and_b32 v15, s62, v181
    v_fma_f32 v14, v14, v10, v11
    s_waitcnt lgkmcnt(9)
    v_mfma_f32_32x32x16_bf16 v[80:95], a[100:103], v[176:179], v[80:95]
    ds_read_b64_tr_b16 a[124:125], v6 offset:26624
    ds_read_b64_tr_b16 a[126:127], v6 offset:27136
    ds_read_b64_tr_b16 a[150:151], v27 offset:33792
    buffer_load_dword v30, off, s[36:39], s1 sc1
    v_fma_f32 v15, v15, v10, v11
    v_cvt_pk_bf16_f32 v181, v14, v15
    v_lshlrev_b32 v12, 16, v182
    v_and_b32 v13, s62, v182
    v_fma_f32 v12, v12, v10, v11
    v_fma_f32 v13, v13, v10, v11
    v_mfma_f32_32x32x16_bf16 v[96:111], a[104:107], v[176:179], v[96:111]
    ds_read_b64_tr_b16 a[96:97], v7 offset:26624
    ds_read_b64_tr_b16 a[98:99], v7 offset:27136
    s_waitcnt vmcnt(9)
    ds_read_b64_tr_b16 a[152:153], v26 offset:34816
    v_cvt_pk_bf16_f32 v182, v12, v13
    v_lshlrev_b32 v14, 16, v183
    v_and_b32 v15, s62, v183
    v_fma_f32 v14, v14, v10, v11
    v_fma_f32 v15, v15, v10, v11
    v_cvt_pk_bf16_f32 v183, v14, v15
    v_mfma_f32_32x32x16_bf16 v[112:127], a[108:111], v[176:179], v[112:127]
    s_waitcnt lgkmcnt(14)
    ds_read_b64_tr_b16 a[100:101], v8 offset:26624
    s_waitcnt lgkmcnt(14)
    ds_read_b64_tr_b16 a[102:103], v8 offset:27136
    v_lshlrev_b32 v12, 16, v184
    v_and_b32 v13, s62, v184
    v_fma_f32 v12, v12, v10, v11
    v_fma_f32 v13, v13, v10, v11
    s_waitcnt lgkmcnt(9)
    v_mfma_f32_32x32x16_bf16 v[32:47], a[112:115], v[180:183], v[32:47]
    ds_read_b128 a[72:75], v28 offset:37248
    ds_read_b64_tr_b16 a[104:105], v9 offset:24576
    ds_read_b64_tr_b16 a[106:107], v9 offset:25088
    ds_read_b64_tr_b16 a[154:155], v26 offset:35840
    v_cvt_pk_bf16_f32 v184, v12, v13
    v_mfma_f32_32x32x16_bf16 v[48:63], a[116:119], v[180:183], v[48:63]
    ds_read_b64_tr_b16 a[108:109], v1 offset:28672
    ds_read_b64_tr_b16 a[110:111], v1 offset:29184
    v_lshlrev_b32 v14, 16, v185
    v_and_b32 v15, s62, v185
    v_fma_f32 v14, v14, v10, v11
    v_fma_f32 v15, v15, v10, v11
    v_mfma_f32_32x32x16_bf16 v[64:79], a[120:123], v[180:183], v[64:79]
    s_waitcnt lgkmcnt(14)
    ds_read_b64_tr_b16 a[112:113], v2 offset:28672
    s_waitcnt lgkmcnt(14)
    ds_read_b64_tr_b16 a[114:115], v2 offset:29184
    v_cvt_pk_bf16_f32 v185, v14, v15
    v_lshlrev_b32 v12, 16, v186
    v_and_b32 v13, s62, v186
    v_fma_f32 v12, v12, v10, v11
    s_waitcnt lgkmcnt(8)
    v_mfma_f32_32x32x16_bf16 v[80:95], a[124:127], v[180:183], v[80:95]
    ds_read_b64_tr_b16 a[116:117], v5 offset:28672
    ds_read_b64_tr_b16 a[118:119], v5 offset:29184
    ds_read_b64_tr_b16 a[156:157], v27 offset:34816
    v_fma_f32 v13, v13, v10, v11
    v_cvt_pk_bf16_f32 v186, v12, v13
    v_mfma_f32_32x32x16_bf16 v[96:111], a[96:99], v[180:183], v[96:111]
    ds_read_b64_tr_b16 a[120:121], v6 offset:28672
    ds_read_b64_tr_b16 a[122:123], v6 offset:29184
    ds_read_b64_tr_b16 a[158:159], v27 offset:35840
    s_waitcnt lgkmcnt(0)
    s_add_u32 m0, s61, 32768
    s_lshl_b32 s63, s76, 4
    v_mfma_f32_32x32x16_bf16 v[112:127], a[100:103], v[180:183], v[112:127]
    ds_read_b64_tr_b16 a[124:125], v7 offset:28672
    ds_read_b64_tr_b16 a[126:127], v7 offset:29184
    s_add_u32 s63, s63, s53
    buffer_load_dwordx4 v24, s[20:23], s63 offen offset:0 lds
    v_lshlrev_b32 v14, 16, v187
    v_and_b32 v15, s62, v187
    v_fma_f32 v14, v14, v10, v11
    v_fma_f32 v15, v15, v10, v11
    v_cvt_pk_bf16_f32 v187, v14, v15
    v_mfma_f32_16x16x32_bf16 a[64:67], a[104:107], a[72:75], a[64:67]
    ds_read_b64_tr_b16 a[96:97], v8 offset:28672
    ds_read_b64_tr_b16 a[98:99], v8 offset:29184
    v_mfma_f32_32x32x16_bf16 v[32:47], a[108:111], v[184:187], v[32:47]
    ds_read_b64_tr_b16 a[100:101], v1 offset:30720
    ds_read_b64_tr_b16 a[102:103], v1 offset:31232
    buffer_load_dwordx4 v25, s[20:23], s63 offen offset:1024 lds
    v_lshlrev_b32 v12, 16, v188
    v_and_b32 v13, s62, v188
    v_mfma_f32_32x32x16_bf16 v[48:63], a[112:115], v[184:187], v[48:63]
    ds_read_b64_tr_b16 a[104:105], v2 offset:30720
    ds_read_b64_tr_b16 a[106:107], v2 offset:31232
    s_add_u32 s63, s63, 14336
    buffer_load_dwordx4 v24, s[20:23], s63 offen offset:2048 lds
    v_fma_f32 v12, v12, v10, v11
    s_waitcnt lgkmcnt(6)
    v_mfma_f32_32x32x16_bf16 v[64:79], a[116:119], v[184:187], v[64:79]
    ds_read_b64_tr_b16 a[108:109], v5 offset:30720
    ds_read_b64_tr_b16 a[110:111], v5 offset:31232
    buffer_load_dwordx4 v25, s[20:23], s63 offen offset:3072 lds
    v_fma_f32 v13, v13, v10, v11
    v_cvt_pk_bf16_f32 v188, v12, v13
    v_lshlrev_b32 v14, 16, v189
    v_and_b32 v15, s62, v189
    v_fma_f32 v14, v14, v10, v11
    v_mfma_f32_32x32x16_bf16 v[80:95], a[120:123], v[184:187], v[80:95]
    ds_read_b64_tr_b16 a[112:113], v6 offset:30720
    ds_read_b64_tr_b16 a[114:115], v6 offset:31232
    v_fma_f32 v15, v15, v10, v11
    v_cvt_pk_bf16_f32 v189, v14, v15
    v_lshlrev_b32 v12, 16, v190
    v_and_b32 v13, s62, v190
    v_fma_f32 v12, v12, v10, v11
    v_fma_f32 v13, v13, v10, v11
    v_mfma_f32_32x32x16_bf16 v[96:111], a[124:127], v[184:187], v[96:111]
    ds_read_b64_tr_b16 a[116:117], v7 offset:30720
    ds_read_b64_tr_b16 a[118:119], v7 offset:31232
    v_cvt_pk_bf16_f32 v190, v12, v13
    v_lshlrev_b32 v14, 16, v191
    v_and_b32 v15, s62, v191
    v_fma_f32 v14, v14, v10, v11
    v_fma_f32 v15, v15, v10, v11
    v_cvt_pk_bf16_f32 v191, v14, v15
    s_waitcnt lgkmcnt(6)
    v_mfma_f32_32x32x16_bf16 v[112:127], a[96:99], v[184:187], v[112:127]
    ds_read_b64_tr_b16 a[120:121], v8 offset:30720
    ds_read_b64_tr_b16 a[122:123], v8 offset:31232
    v_lshlrev_b32 v12, 16, v192
    v_and_b32 v13, s62, v192
    v_fma_f32 v12, v12, v10, v11
    v_mfma_f32_32x32x16_bf16 v[32:47], a[100:103], v[188:191], v[32:47]
    ds_read_b128 a[76:79], v29 offset:37248
    ds_read_b64_tr_b16 a[124:125], v9 offset:28672
    ds_read_b64_tr_b16 a[126:127], v9 offset:29184
    v_fma_f32 v13, v13, v10, v11
    v_cvt_pk_bf16_f32 v192, v12, v13
    v_lshlrev_b32 v14, 16, v193
    v_mfma_f32_32x32x16_bf16 v[48:63], a[104:107], v[188:191], v[48:63]
    s_barrier
    ds_read_b64_tr_b16 a[96:97], v1 offset:0
    ds_read_b64_tr_b16 a[98:99], v1 offset:512
    s_add_u32 m0, s61, 16384
    s_nop 0
    buffer_load_dwordx4 v16, s[12:15], s46 offen offset:0 lds
    s_waitcnt lgkmcnt(7)
    v_mfma_f32_32x32x16_bf16 v[64:79], a[108:111], v[188:191], v[64:79]
    ds_read_b64_tr_b16 a[100:101], v2 offset:0
    ds_read_b64_tr_b16 a[102:103], v2 offset:512
    buffer_load_dwordx4 v17, s[12:15], s46 offen offset:1024 lds
    v_and_b32 v15, s62, v193
    v_mfma_f32_32x32x16_bf16 v[80:95], a[112:115], v[188:191], v[80:95]
    ds_read_b64_tr_b16 a[104:105], v5 offset:0
    ds_read_b64_tr_b16 a[106:107], v5 offset:512
    buffer_load_dwordx4 v18, s[12:15], s46 offen offset:2048 lds
    v_fma_f32 v14, v14, v10, v11
    v_fma_f32 v15, v15, v10, v11
    v_mfma_f32_32x32x16_bf16 v[96:111], a[116:119], v[188:191], v[96:111]
    ds_read_b64_tr_b16 a[108:109], v6 offset:0
    ds_read_b64_tr_b16 a[110:111], v6 offset:512
    buffer_load_dwordx4 v19, s[12:15], s46 offen offset:3072 lds
    v_cvt_pk_bf16_f32 v193, v14, v15
    v_lshlrev_b32 v12, 16, v194
    v_and_b32 v13, s62, v194
    v_fma_f32 v12, v12, v10, v11
    v_fma_f32 v13, v13, v10, v11
    s_waitcnt lgkmcnt(6)
    v_mfma_f32_32x32x16_bf16 v[112:127], a[120:123], v[188:191], v[112:127]
    ds_read_b64_tr_b16 a[112:113], v7 offset:0
    ds_read_b64_tr_b16 a[114:115], v7 offset:512
    s_add_u32 m0, s61, 20480
    s_add_u32 s46, s46, s50
    buffer_load_dwordx4 v16, s[12:15], s46 offen offset:0 lds
    v_cvt_pk_bf16_f32 v194, v12, v13
    v_lshlrev_b32 v14, 16, v195
    v_and_b32 v15, s62, v195
    v_fma_f32 v14, v14, v10, v11
    v_fma_f32 v15, v15, v10, v11
    v_cvt_pk_bf16_f32 v195, v14, v15
    v_mfma_f32_16x16x32_bf16 a[64:67], a[124:127], a[76:79], a[64:67]
    ds_read_b64_tr_b16 a[116:117], v8 offset:0
    ds_read_b64_tr_b16 a[118:119], v8 offset:512
    v_mfma_f32_32x32x16_bf16 v[32:47], a[96:99], v[192:195], v[32:47]
    ds_read_b64_tr_b16 a[120:121], v1 offset:2048
    ds_read_b64_tr_b16 a[122:123], v1 offset:2560
    buffer_load_dwordx4 v17, s[12:15], s46 offen offset:1024 lds
    v_lshlrev_b32 v12, 16, v196
    v_and_b32 v13, s62, v196
    s_waitcnt lgkmcnt(6)
    v_mfma_f32_32x32x16_bf16 v[48:63], a[100:103], v[192:195], v[48:63]
    ds_read_b64_tr_b16 a[124:125], v2 offset:2048
    ds_read_b64_tr_b16 a[126:127], v2 offset:2560
    buffer_load_dwordx4 v18, s[12:15], s46 offen offset:2048 lds
    v_fma_f32 v12, v12, v10, v11
    v_mfma_f32_32x32x16_bf16 v[64:79], a[104:107], v[192:195], v[64:79]
    ds_read_b64_tr_b16 a[96:97], v5 offset:2048
    ds_read_b64_tr_b16 a[98:99], v5 offset:2560
    buffer_load_dwordx4 v19, s[12:15], s46 offen offset:3072 lds
    v_fma_f32 v13, v13, v10, v11
    v_cvt_pk_bf16_f32 v196, v12, v13
    v_lshlrev_b32 v14, 16, v197
    v_and_b32 v15, s62, v197
    v_fma_f32 v14, v14, v10, v11
    v_mfma_f32_32x32x16_bf16 v[80:95], a[108:111], v[192:195], v[80:95]
    ds_read_b64_tr_b16 a[100:101], v6 offset:2048
    ds_read_b64_tr_b16 a[102:103], v6 offset:2560
    v_fma_f32 v15, v15, v10, v11
    v_cvt_pk_bf16_f32 v197, v14, v15
    v_lshlrev_b32 v12, 16, v198
    v_and_b32 v13, s62, v198
    v_fma_f32 v12, v12, v10, v11
    v_fma_f32 v13, v13, v10, v11
    s_waitcnt lgkmcnt(6)
    v_mfma_f32_32x32x16_bf16 v[96:111], a[112:115], v[192:195], v[96:111]
    ds_read_b64_tr_b16 a[104:105], v7 offset:2048
    ds_read_b64_tr_b16 a[106:107], v7 offset:2560
    v_cvt_pk_bf16_f32 v198, v12, v13
    v_lshlrev_b32 v14, 16, v199
    v_and_b32 v15, s62, v199
    v_fma_f32 v14, v14, v10, v11
    v_fma_f32 v15, v15, v10, v11
    v_cvt_pk_bf16_f32 v199, v14, v15
    v_mfma_f32_32x32x16_bf16 v[112:127], a[116:119], v[192:195], v[112:127]
    ds_read_b64_tr_b16 a[108:109], v8 offset:2048
    ds_read_b64_tr_b16 a[110:111], v8 offset:2560
    v_lshlrev_b32 v12, 16, v200
    v_and_b32 v13, s62, v200
    v_fma_f32 v12, v12, v10, v11
    v_fma_f32 v13, v13, v10, v11
    v_mfma_f32_32x32x16_bf16 v[32:47], a[120:123], v[196:199], v[32:47]
    ds_read_b128 a[72:75], v28 offset:37376
    ds_read_b64_tr_b16 a[112:113], v9 offset:0
    ds_read_b64_tr_b16 a[114:115], v9 offset:512
    s_waitcnt vmcnt(10)
    ds_read_b64_tr_b16 a[160:161], v26 offset:32768
    v_cvt_pk_bf16_f32 v200, v12, v13
    v_lshlrev_b32 v14, 16, v201
    s_waitcnt lgkmcnt(8)
    v_mfma_f32_32x32x16_bf16 v[48:63], a[124:127], v[196:199], v[48:63]
    ds_read_b64_tr_b16 a[116:117], v1 offset:4096
    ds_read_b64_tr_b16 a[118:119], v1 offset:4608
    ds_read_b64_tr_b16 a[162:163], v26 offset:33792
    v_and_b32 v15, s62, v201
    v_fma_f32 v14, v14, v10, v11
    v_mfma_f32_32x32x16_bf16 v[64:79], a[96:99], v[196:199], v[64:79]
    ds_read_b64_tr_b16 a[120:121], v2 offset:4096
    ds_read_b64_tr_b16 a[122:123], v2 offset:4608
    ds_read_b64_tr_b16 a[164:165], v27 offset:32768
    v_fma_f32 v15, v15, v10, v11
    v_cvt_pk_bf16_f32 v201, v14, v15
    v_lshlrev_b32 v12, 16, v202
    v_mfma_f32_32x32x16_bf16 v[80:95], a[100:103], v[196:199], v[80:95]
    ds_read_b64_tr_b16 a[124:125], v5 offset:4096
    s_waitcnt lgkmcnt(14)
    ds_read_b64_tr_b16 a[126:127], v5 offset:4608
    v_and_b32 v13, s62, v202
    v_fma_f32 v12, v12, v10, v11
    v_fma_f32 v13, v13, v10, v11
    v_cvt_pk_bf16_f32 v202, v12, v13
    s_waitcnt lgkmcnt(9)
    v_mfma_f32_32x32x16_bf16 v[96:111], a[104:107], v[196:199], v[96:111]
    ds_read_b64_tr_b16 a[96:97], v6 offset:4096
    ds_read_b64_tr_b16 a[98:99], v6 offset:4608
    ds_read_b64_tr_b16 a[166:167], v27 offset:33792
    v_lshlrev_b32 v14, 16, v203
    v_and_b32 v15, s62, v203
    v_mfma_f32_32x32x16_bf16 v[112:127], a[108:111], v[196:199], v[112:127]
    ds_read_b64_tr_b16 a[100:101], v7 offset:4096
    ds_read_b64_tr_b16 a[102:103], v7 offset:4608
    s_waitcnt vmcnt(8)
    ds_read_b64_tr_b16 a[168:169], v26 offset:34816
    v_fma_f32 v14, v14, v10, v11
    v_fma_f32 v15, v15, v10, v11
    v_cvt_pk_bf16_f32 v203, v14, v15
    v_mfma_f32_16x16x32_bf16 a[64:67], a[112:115], a[72:75], a[64:67]
    s_waitcnt lgkmcnt(14)
    ds_read_b64_tr_b16 a[104:105], v8 offset:4096
    s_waitcnt lgkmcnt(14)
    ds_read_b64_tr_b16 a[106:107], v8 offset:4608
    s_waitcnt lgkmcnt(8)
    v_mfma_f32_32x32x16_bf16 v[32:47], a[116:119], v[200:203], v[32:47]
    ds_read_b64_tr_b16 a[108:109], v1 offset:6144
    ds_read_b64_tr_b16 a[110:111], v1 offset:6656
    ds_read_b64_tr_b16 a[170:171], v26 offset:35840
    v_lshlrev_b32 v12, 16, v204
    v_and_b32 v13, s62, v204
    v_mfma_f32_32x32x16_bf16 v[48:63], a[120:123], v[200:203], v[48:63]
    ds_read_b64_tr_b16 a[112:113], v2 offset:6144
    ds_read_b64_tr_b16 a[114:115], v2 offset:6656
    ds_read_b64_tr_b16 a[172:173], v27 offset:34816
    v_fma_f32 v12, v12, v10, v11
    v_fma_f32 v13, v13, v10, v11
    v_cvt_pk_bf16_f32 v204, v12, v13
    v_mfma_f32_32x32x16_bf16 v[64:79], a[124:127], v[200:203], v[64:79]
    ds_read_b64_tr_b16 a[116:117], v5 offset:6144
    s_waitcnt lgkmcnt(14)
    ds_read_b64_tr_b16 a[118:119], v5 offset:6656
    v_lshlrev_b32 v14, 16, v205
    v_and_b32 v15, s62, v205
    v_fma_f32 v14, v14, v10, v11
    v_fma_f32 v15, v15, v10, v11
    s_waitcnt lgkmcnt(8)
    v_mfma_f32_32x32x16_bf16 v[80:95], a[96:99], v[200:203], v[80:95]
    ds_read_b64_tr_b16 a[120:121], v6 offset:6144
    ds_read_b64_tr_b16 a[122:123], v6 offset:6656
    ds_read_b64_tr_b16 a[174:175], v27 offset:35840
    s_waitcnt lgkmcnt(0)
    s_add_u32 m0, s61, 32768
    v_cvt_pk_bf16_f32 v205, v14, v15
    v_lshlrev_b32 v12, 16, v206
    v_and_b32 v13, s62, v206
    v_fma_f32 v12, v12, v10, v11
    v_fma_f32 v13, v13, v10, v11
    v_mfma_f32_32x32x16_bf16 v[96:111], a[100:103], v[200:203], v[96:111]
    ds_read_b64_tr_b16 a[124:125], v7 offset:6144
    ds_read_b64_tr_b16 a[126:127], v7 offset:6656
    s_lshl_b32 s63, s76, 4
    s_add_u32 s63, s63, s53
    s_add_u32 s63, s63, 32768
    buffer_load_dwordx4 v24, s[20:23], s63 offen offset:0 lds
    v_cvt_pk_bf16_f32 v206, v12, v13
    v_lshlrev_b32 v14, 16, v207
    v_and_b32 v15, s62, v207
    v_fma_f32 v14, v14, v10, v11
    v_fma_f32 v15, v15, v10, v11
    v_cvt_pk_bf16_f32 v207, v14, v15
    v_mfma_f32_32x32x16_bf16 v[112:127], a[104:107], v[200:203], v[112:127]
    ds_read_b64_tr_b16 a[96:97], v8 offset:6144
    ds_read_b64_tr_b16 a[98:99], v8 offset:6656
    buffer_load_dwordx4 v25, s[20:23], s63 offen offset:1024 lds
    v_lshlrev_b32 v12, 16, v208
    v_and_b32 v13, s62, v208
    v_mfma_f32_32x32x16_bf16 v[32:47], a[108:111], v[204:207], v[32:47]
    ds_read_b128 a[76:79], v29 offset:37376
    ds_read_b64_tr_b16 a[100:101], v9 offset:4096
    ds_read_b64_tr_b16 a[102:103], v9 offset:4608
    s_add_u32 s63, s63, 14336
    buffer_load_dwordx4 v24, s[20:23], s63 offen offset:2048 lds
    v_mfma_f32_32x32x16_bf16 v[48:63], a[112:115], v[204:207], v[48:63]
    s_barrier
    ds_read_b64_tr_b16 a[104:105], v1 offset:8192
    ds_read_b64_tr_b16 a[106:107], v1 offset:8704
    buffer_load_dwordx4 v25, s[20:23], s63 offen offset:3072 lds
    v_fma_f32 v12, v12, v10, v11
    v_mfma_f32_32x32x16_bf16 v[64:79], a[116:119], v[204:207], v[64:79]
    ds_read_b64_tr_b16 a[108:109], v2 offset:8192
    ds_read_b64_tr_b16 a[110:111], v2 offset:8704
    s_add_u32 m0, s61, 24576
    s_nop 0
    buffer_load_dwordx4 v16, s[12:15], s47 offen offset:0 lds
    v_fma_f32 v13, v13, v10, v11
    s_waitcnt lgkmcnt(7)
    v_mfma_f32_32x32x16_bf16 v[80:95], a[120:123], v[204:207], v[80:95]
    ds_read_b64_tr_b16 a[112:113], v5 offset:8192
    ds_read_b64_tr_b16 a[114:115], v5 offset:8704
    buffer_load_dwordx4 v17, s[12:15], s47 offen offset:1024 lds
    v_cvt_pk_bf16_f32 v208, v12, v13
    v_lshlrev_b32 v14, 16, v209
    v_and_b32 v15, s62, v209
    v_fma_f32 v14, v14, v10, v11
    v_mfma_f32_32x32x16_bf16 v[96:111], a[124:127], v[204:207], v[96:111]
    ds_read_b64_tr_b16 a[116:117], v6 offset:8192
    ds_read_b64_tr_b16 a[118:119], v6 offset:8704
    buffer_load_dwordx4 v18, s[12:15], s47 offen offset:2048 lds
    v_fma_f32 v15, v15, v10, v11
    v_cvt_pk_bf16_f32 v209, v14, v15
    v_lshlrev_b32 v12, 16, v210
    v_and_b32 v13, s62, v210
    v_fma_f32 v12, v12, v10, v11
    v_fma_f32 v13, v13, v10, v11
    v_mfma_f32_32x32x16_bf16 v[112:127], a[96:99], v[204:207], v[112:127]
    ds_read_b64_tr_b16 a[120:121], v7 offset:8192
    ds_read_b64_tr_b16 a[122:123], v7 offset:8704
    buffer_load_dwordx4 v19, s[12:15], s47 offen offset:3072 lds
    v_cvt_pk_bf16_f32 v210, v12, v13
    v_lshlrev_b32 v14, 16, v211
    v_and_b32 v15, s62, v211
    v_fma_f32 v14, v14, v10, v11
    v_fma_f32 v15, v15, v10, v11
    v_cvt_pk_bf16_f32 v211, v14, v15
    s_waitcnt lgkmcnt(6)
    v_mfma_f32_16x16x32_bf16 a[64:67], a[100:103], a[76:79], a[64:67]
    ds_read_b64_tr_b16 a[124:125], v8 offset:8192
    ds_read_b64_tr_b16 a[126:127], v8 offset:8704
    v_mfma_f32_32x32x16_bf16 v[32:47], a[104:107], v[208:211], v[32:47]
    ds_read_b64_tr_b16 a[96:97], v1 offset:10240
    ds_read_b64_tr_b16 a[98:99], v1 offset:10752
    s_add_u32 m0, s61, 28672
    s_add_u32 s47, s47, s50
    buffer_load_dwordx4 v16, s[12:15], s47 offen offset:0 lds
    v_mfma_f32_32x32x16_bf16 v[48:63], a[108:111], v[208:211], v[48:63]
    ds_read_b64_tr_b16 a[100:101], v2 offset:10240
    ds_read_b64_tr_b16 a[102:103], v2 offset:10752
    buffer_load_dwordx4 v17, s[12:15], s47 offen offset:1024 lds
    v_lshlrev_b32 v12, 16, v212
    v_and_b32 v13, s62, v212
    s_waitcnt lgkmcnt(6)
    v_mfma_f32_32x32x16_bf16 v[64:79], a[112:115], v[208:211], v[64:79]
    ds_read_b64_tr_b16 a[104:105], v5 offset:10240
    ds_read_b64_tr_b16 a[106:107], v5 offset:10752
    buffer_load_dwordx4 v18, s[12:15], s47 offen offset:2048 lds
    v_fma_f32 v12, v12, v10, v11
    v_fma_f32 v13, v13, v10, v11
    v_cvt_pk_bf16_f32 v212, v12, v13
    v_lshlrev_b32 v14, 16, v213
    v_and_b32 v15, s62, v213
    v_fma_f32 v14, v14, v10, v11
    v_mfma_f32_32x32x16_bf16 v[80:95], a[116:119], v[208:211], v[80:95]
    ds_read_b64_tr_b16 a[108:109], v6 offset:10240
    ds_read_b64_tr_b16 a[110:111], v6 offset:10752
    buffer_load_dwordx4 v19, s[12:15], s47 offen offset:3072 lds
    v_fma_f32 v15, v15, v10, v11
    v_cvt_pk_bf16_f32 v213, v14, v15
    v_lshlrev_b32 v12, 16, v214
    v_and_b32 v13, s62, v214
    v_fma_f32 v12, v12, v10, v11
    v_fma_f32 v13, v13, v10, v11
    v_mfma_f32_32x32x16_bf16 v[96:111], a[120:123], v[208:211], v[96:111]
    ds_read_b64_tr_b16 a[112:113], v7 offset:10240
    ds_read_b64_tr_b16 a[114:115], v7 offset:10752
    v_cvt_pk_bf16_f32 v214, v12, v13
    v_lshlrev_b32 v14, 16, v215
    v_and_b32 v15, s62, v215
    v_fma_f32 v14, v14, v10, v11
    v_fma_f32 v15, v15, v10, v11
    v_cvt_pk_bf16_f32 v215, v14, v15
    s_waitcnt lgkmcnt(6)
    v_mfma_f32_32x32x16_bf16 v[112:127], a[124:127], v[208:211], v[112:127]
    ds_read_b64_tr_b16 a[116:117], v8 offset:10240
    ds_read_b64_tr_b16 a[118:119], v8 offset:10752
    v_lshlrev_b32 v12, 16, v216
    v_and_b32 v13, s62, v216
    v_fma_f32 v12, v12, v10, v11
    v_mfma_f32_32x32x16_bf16 v[32:47], a[96:99], v[212:215], v[32:47]
    ds_read_b128 a[72:75], v28 offset:37504
    ds_read_b64_tr_b16 a[120:121], v9 offset:8192
    ds_read_b64_tr_b16 a[122:123], v9 offset:8704
    v_fma_f32 v13, v13, v10, v11
    v_cvt_pk_bf16_f32 v216, v12, v13
    v_lshlrev_b32 v14, 16, v217
    v_mfma_f32_32x32x16_bf16 v[48:63], a[100:103], v[212:215], v[48:63]
    ds_read_b64_tr_b16 a[124:125], v1 offset:12288
    ds_read_b64_tr_b16 a[126:127], v1 offset:12800
    v_and_b32 v15, s62, v217
    v_fma_f32 v14, v14, v10, v11
    v_fma_f32 v15, v15, v10, v11
    v_cvt_pk_bf16_f32 v217, v14, v15
    s_waitcnt lgkmcnt(7)
    v_mfma_f32_32x32x16_bf16 v[64:79], a[104:107], v[212:215], v[64:79]
    ds_read_b64_tr_b16 a[96:97], v2 offset:12288
    ds_read_b64_tr_b16 a[98:99], v2 offset:12800
    v_lshlrev_b32 v12, 16, v218
    v_and_b32 v13, s62, v218
    v_fma_f32 v12, v12, v10, v11
    v_mfma_f32_32x32x16_bf16 v[80:95], a[108:111], v[212:215], v[80:95]
    ds_read_b64_tr_b16 a[100:101], v5 offset:12288
    ds_read_b64_tr_b16 a[102:103], v5 offset:12800
    v_fma_f32 v13, v13, v10, v11
    v_cvt_pk_bf16_f32 v218, v12, v13
    v_lshlrev_b32 v14, 16, v219
    v_and_b32 v15, s62, v219
    v_mfma_f32_32x32x16_bf16 v[96:111], a[112:115], v[212:215], v[96:111]
    ds_read_b64_tr_b16 a[104:105], v6 offset:12288
    ds_read_b64_tr_b16 a[106:107], v6 offset:12800
    v_fma_f32 v14, v14, v10, v11
    v_fma_f32 v15, v15, v10, v11
    v_cvt_pk_bf16_f32 v219, v14, v15
    v_lshlrev_b32 v12, 16, v220
    s_waitcnt lgkmcnt(6)
    v_mfma_f32_32x32x16_bf16 v[112:127], a[116:119], v[212:215], v[112:127]
    ds_read_b64_tr_b16 a[108:109], v7 offset:12288
    ds_read_b64_tr_b16 a[110:111], v7 offset:12800
    v_and_b32 v13, s62, v220
    v_fma_f32 v12, v12, v10, v11
    v_fma_f32 v13, v13, v10, v11
    v_mfma_f32_16x16x32_bf16 a[64:67], a[120:123], a[72:75], a[64:67]
    ds_read_b64_tr_b16 a[112:113], v8 offset:12288
    ds_read_b64_tr_b16 a[114:115], v8 offset:12800
    v_mfma_f32_32x32x16_bf16 v[32:47], a[124:127], v[216:219], v[32:47]
    ds_read_b64_tr_b16 a[116:117], v1 offset:14336
    ds_read_b64_tr_b16 a[118:119], v1 offset:14848
    s_waitcnt vmcnt(10)
    ds_read_b64_tr_b16 a[176:177], v26 offset:32768
    v_cvt_pk_bf16_f32 v220, v12, v13
    v_lshlrev_b32 v14, 16, v221
    v_and_b32 v15, s62, v221
    s_waitcnt lgkmcnt(7)
    v_mfma_f32_32x32x16_bf16 v[48:63], a[96:99], v[216:219], v[48:63]
    ds_read_b64_tr_b16 a[120:121], v2 offset:14336
    ds_read_b64_tr_b16 a[122:123], v2 offset:14848
    ds_read_b64_tr_b16 a[178:179], v26 offset:33792
    v_fma_f32 v14, v14, v10, v11
    v_fma_f32 v15, v15, v10, v11
    v_mfma_f32_32x32x16_bf16 v[64:79], a[100:103], v[216:219], v[64:79]
    ds_read_b64_tr_b16 a[124:125], v5 offset:14336
    ds_read_b64_tr_b16 a[126:127], v5 offset:14848
    ds_read_b64_tr_b16 a[180:181], v27 offset:32768
    v_cvt_pk_bf16_f32 v221, v14, v15
    v_lshlrev_b32 v12, 16, v222
    v_and_b32 v13, s62, v222
    v_mfma_f32_32x32x16_bf16 v[80:95], a[104:107], v[216:219], v[80:95]
    ds_read_b64_tr_b16 a[96:97], v6 offset:14336
    ds_read_b64_tr_b16 a[98:99], v6 offset:14848
    v_fma_f32 v12, v12, v10, v11
    v_fma_f32 v13, v13, v10, v11
    v_cvt_pk_bf16_f32 v222, v12, v13
    v_lshlrev_b32 v14, 16, v223
    s_waitcnt lgkmcnt(9)
    v_mfma_f32_32x32x16_bf16 v[96:111], a[108:111], v[216:219], v[96:111]
    ds_read_b64_tr_b16 a[100:101], v7 offset:14336
    ds_read_b64_tr_b16 a[102:103], v7 offset:14848
    ds_read_b64_tr_b16 a[182:183], v27 offset:33792
    v_and_b32 v15, s62, v223
    v_fma_f32 v14, v14, v10, v11
    v_fma_f32 v15, v15, v10, v11
    v_cvt_pk_bf16_f32 v223, v14, v15
    v_mfma_f32_32x32x16_bf16 v[112:127], a[112:115], v[216:219], v[112:127]
    ds_read_b64_tr_b16 a[104:105], v8 offset:14336
    ds_read_b64_tr_b16 a[106:107], v8 offset:14848
    s_waitcnt vmcnt(8)
    ds_read_b64_tr_b16 a[184:185], v26 offset:34816
    v_lshlrev_b32 v12, 16, v224
    v_and_b32 v13, s62, v224
    v_fma_f32 v12, v12, v10, v11
    v_mfma_f32_32x32x16_bf16 v[32:47], a[116:119], v[220:223], v[32:47]
    s_waitcnt lgkmcnt(14)
    ds_read_b128 a[76:79], v29 offset:37504
    s_waitcnt lgkmcnt(14)
    ds_read_b64_tr_b16 a[108:109], v9 offset:12288
    s_waitcnt lgkmcnt(14)
    ds_read_b64_tr_b16 a[110:111], v9 offset:12800
    v_fma_f32 v13, v13, v10, v11
    v_cvt_pk_bf16_f32 v224, v12, v13
    v_lshlrev_b32 v14, 16, v225
    s_waitcnt lgkmcnt(9)
    v_mfma_f32_32x32x16_bf16 v[48:63], a[120:123], v[220:223], v[48:63]
    s_barrier
    ds_read_b64_tr_b16 a[112:113], v1 offset:16384
    ds_read_b64_tr_b16 a[114:115], v1 offset:16896
    ds_read_b64_tr_b16 a[186:187], v26 offset:35840
    s_add_u32 m0, s61, 0
    s_nop 0
    buffer_load_dwordx4 v20, s[16:19], s48 offen offset:0 lds
    v_mfma_f32_32x32x16_bf16 v[64:79], a[124:127], v[220:223], v[64:79]
    ds_read_b64_tr_b16 a[116:117], v2 offset:16384
    ds_read_b64_tr_b16 a[118:119], v2 offset:16896
    ds_read_b64_tr_b16 a[188:189], v27 offset:34816
    buffer_load_dwordx4 v21, s[16:19], s48 offen offset:1024 lds
    v_and_b32 v15, s62, v225
    v_mfma_f32_32x32x16_bf16 v[80:95], a[96:99], v[220:223], v[80:95]
    s_waitcnt lgkmcnt(14)
    ds_read_b64_tr_b16 a[120:121], v5 offset:16384
    s_waitcnt lgkmcnt(14)
    ds_read_b64_tr_b16 a[122:123], v5 offset:16896
    buffer_load_dwordx4 v22, s[16:19], s48 offen offset:2048 lds
    v_fma_f32 v14, v14, v10, v11
    v_fma_f32 v15, v15, v10, v11
    s_waitcnt lgkmcnt(8)
    v_mfma_f32_32x32x16_bf16 v[96:111], a[100:103], v[220:223], v[96:111]
    ds_read_b64_tr_b16 a[124:125], v6 offset:16384
    ds_read_b64_tr_b16 a[126:127], v6 offset:16896
    ds_read_b64_tr_b16 a[190:191], v27 offset:35840
    buffer_load_dwordx4 v23, s[16:19], s48 offen offset:3072 lds
    v_cvt_pk_bf16_f32 v225, v14, v15
    v_lshlrev_b32 v12, 16, v226
    v_and_b32 v13, s62, v226
    v_fma_f32 v12, v12, v10, v11
    v_fma_f32 v13, v13, v10, v11
    v_mfma_f32_32x32x16_bf16 v[112:127], a[104:107], v[220:223], v[112:127]
    ds_read_b64_tr_b16 a[96:97], v7 offset:16384
    ds_read_b64_tr_b16 a[98:99], v7 offset:16896
    s_waitcnt lgkmcnt(2)
    s_add_u32 m0, s61, 32768
    s_lshl_b32 s63, s77, 4
    s_add_u32 s63, s63, s53
    buffer_load_dwordx4 v24, s[20:23], s63 offen offset:0 lds
    v_cvt_pk_bf16_f32 v226, v12, v13
    v_lshlrev_b32 v14, 16, v227
    v_and_b32 v15, s62, v227
    v_fma_f32 v14, v14, v10, v11
    v_fma_f32 v15, v15, v10, v11
    v_cvt_pk_bf16_f32 v227, v14, v15
    v_mfma_f32_16x16x32_bf16 a[64:67], a[108:111], a[76:79], a[64:67]
    ds_read_b64_tr_b16 a[100:101], v8 offset:16384
    ds_read_b64_tr_b16 a[102:103], v8 offset:16896
    v_mfma_f32_32x32x16_bf16 v[32:47], a[112:115], v[224:227], v[32:47]
    ds_read_b64_tr_b16 a[104:105], v1 offset:18432
    ds_read_b64_tr_b16 a[106:107], v1 offset:18944
    buffer_load_dwordx4 v25, s[20:23], s63 offen offset:1024 lds
    v_readfirstlane_b32 s2, v30
    s_cmp_lg_u32 s2, 0
    s_cbranch_scc0 L_dbgspinA
L_dbgokA:
    v_mfma_f32_32x32x16_bf16 v[48:63], a[116:119], v[224:227], v[48:63]
    ds_read_b64_tr_b16 a[108:109], v2 offset:18432
    ds_read_b64_tr_b16 a[110:111], v2 offset:18944
    s_add_u32 s63, s63, 14336
    buffer_load_dwordx4 v24, s[20:23], s63 offen offset:2048 lds
    v_lshlrev_b32 v12, 16, v228
    v_and_b32 v13, s62, v228
    v_mfma_f32_32x32x16_bf16 v[64:79], a[120:123], v[224:227], v[64:79]
    ds_read_b64_tr_b16 a[112:113], v5 offset:18432
    ds_read_b64_tr_b16 a[114:115], v5 offset:18944
    buffer_load_dwordx4 v25, s[20:23], s63 offen offset:3072 lds
    v_fma_f32 v12, v12, v10, v11
    v_fma_f32 v13, v13, v10, v11
    v_cvt_pk_bf16_f32 v228, v12, v13
    v_lshlrev_b32 v14, 16, v229
    v_and_b32 v15, s62, v229
    v_fma_f32 v14, v14, v10, v11
    s_waitcnt lgkmcnt(6)
    v_mfma_f32_32x32x16_bf16 v[80:95], a[124:127], v[224:227], v[80:95]
    ds_read_b64_tr_b16 a[116:117], v6 offset:18432
    ds_read_b64_tr_b16 a[118:119], v6 offset:18944
    s_add_u32 m0, s61, 4096
    s_add_u32 s48, s48, 98304
    buffer_load_dwordx4 v20, s[16:19], s48 offen offset:0 lds
    v_fma_f32 v15, v15, v10, v11
    v_cvt_pk_bf16_f32 v229, v14, v15
    v_lshlrev_b32 v12, 16, v230
    v_and_b32 v13, s62, v230
    v_fma_f32 v12, v12, v10, v11
    v_fma_f32 v13, v13, v10, v11
    v_mfma_f32_32x32x16_bf16 v[96:111], a[96:99], v[224:227], v[96:111]
    ds_read_b64_tr_b16 a[120:121], v7 offset:18432
    ds_read_b64_tr_b16 a[122:123], v7 offset:18944
    buffer_load_dwordx4 v21, s[16:19], s48 offen offset:1024 lds
    v_cvt_pk_bf16_f32 v230, v12, v13
    v_lshlrev_b32 v14, 16, v231
    v_and_b32 v15, s62, v231
    v_fma_f32 v14, v14, v10, v11
    v_fma_f32 v15, v15, v10, v11
    v_cvt_pk_bf16_f32 v231, v14, v15
    v_subrev_u32 v3, 122880, v9
    v_mfma_f32_32x32x16_bf16 v[112:127], a[100:103], v[224:227], v[112:127]
    ds_read_b64_tr_b16 a[124:125], v8 offset:18432
    ds_read_b64_tr_b16 a[126:127], v8 offset:18944
    buffer_load_dwordx4 v22, s[16:19], s48 offen offset:2048 lds
    v_lshlrev_b32 v12, 16, v232
    v_and_b32 v13, s62, v232
    s_waitcnt lgkmcnt(6)
    v_mfma_f32_32x32x16_bf16 v[32:47], a[104:107], v[228:231], v[32:47]
    ds_read_b128 a[72:75], v28 offset:37632
    ds_read_b64_tr_b16 a[96:97], v9 offset:16384
    ds_read_b64_tr_b16 a[98:99], v9 offset:16896
    buffer_load_dwordx4 v23, s[16:19], s48 offen offset:3072 lds
    v_mfma_f32_32x32x16_bf16 v[48:63], a[108:111], v[228:231], v[48:63]
    ds_read_b64_tr_b16 a[100:101], v1 offset:20480
    ds_read_b64_tr_b16 a[102:103], v1 offset:20992
    v_fma_f32 v12, v12, v10, v11
    v_fma_f32 v13, v13, v10, v11
    v_cvt_pk_bf16_f32 v232, v12, v13
    v_lshlrev_b32 v14, 16, v233
    v_mfma_f32_32x32x16_bf16 v[64:79], a[112:115], v[228:231], v[64:79]
    ds_read_b64_tr_b16 a[104:105], v2 offset:20480
    ds_read_b64_tr_b16 a[106:107], v2 offset:20992
    v_and_b32 v15, s62, v233
    v_fma_f32 v14, v14, v10, v11
    v_fma_f32 v15, v15, v10, v11
    v_cvt_pk_bf16_f32 v233, v14, v15
    s_waitcnt lgkmcnt(7)
    v_mfma_f32_32x32x16_bf16 v[80:95], a[116:119], v[228:231], v[80:95]
    ds_read_b64_tr_b16 a[108:109], v5 offset:20480
    ds_read_b64_tr_b16 a[110:111], v5 offset:20992
    v_lshlrev_b32 v12, 16, v234
    v_and_b32 v13, s62, v234
    v_fma_f32 v12, v12, v10, v11
    v_mfma_f32_32x32x16_bf16 v[96:111], a[120:123], v[228:231], v[96:111]
    ds_read_b64_tr_b16 a[112:113], v6 offset:20480
    ds_read_b64_tr_b16 a[114:115], v6 offset:20992
    v_fma_f32 v13, v13, v10, v11
    v_cvt_pk_bf16_f32 v234, v12, v13
    v_lshlrev_b32 v14, 16, v235
    v_and_b32 v15, s62, v235
    v_mfma_f32_32x32x16_bf16 v[112:127], a[124:127], v[228:231], v[112:127]
    ds_read_b64_tr_b16 a[116:117], v7 offset:20480
    ds_read_b64_tr_b16 a[118:119], v7 offset:20992
    v_fma_f32 v14, v14, v10, v11
    v_fma_f32 v15, v15, v10, v11
    v_cvt_pk_bf16_f32 v235, v14, v15
    v_lshlrev_b32 v12, 16, v236
    s_waitcnt lgkmcnt(6)
    v_mfma_f32_16x16x32_bf16 a[64:67], a[96:99], a[72:75], a[64:67]
    ds_read_b64_tr_b16 a[120:121], v8 offset:20480
    ds_read_b64_tr_b16 a[122:123], v8 offset:20992
    v_mfma_f32_32x32x16_bf16 v[32:47], a[100:103], v[232:235], v[32:47]
    ds_read_b64_tr_b16 a[124:125], v1 offset:22528
    ds_read_b64_tr_b16 a[126:127], v1 offset:23040
    v_and_b32 v13, s62, v236
    v_fma_f32 v12, v12, v10, v11
    v_fma_f32 v13, v13, v10, v11
    v_cvt_pk_bf16_f32 v236, v12, v13
    v_mfma_f32_32x32x16_bf16 v[48:63], a[104:107], v[232:235], v[48:63]
    ds_read_b64_tr_b16 a[96:97], v2 offset:22528
    ds_read_b64_tr_b16 a[98:99], v2 offset:23040
    v_lshlrev_b32 v14, 16, v237
    v_and_b32 v15, s62, v237
    v_fma_f32 v14, v14, v10, v11
    v_subrev_u32 v4, 81920, v9
    s_waitcnt lgkmcnt(6)
    v_mfma_f32_32x32x16_bf16 v[64:79], a[108:111], v[232:235], v[64:79]
    ds_read_b64_tr_b16 a[100:101], v5 offset:22528
    ds_read_b64_tr_b16 a[102:103], v5 offset:23040
    v_fma_f32 v15, v15, v10, v11
    v_cvt_pk_bf16_f32 v237, v14, v15
    v_lshlrev_b32 v12, 16, v238
    v_mfma_f32_32x32x16_bf16 v[80:95], a[112:115], v[232:235], v[80:95]
    ds_read_b64_tr_b16 a[104:105], v6 offset:22528
    ds_read_b64_tr_b16 a[106:107], v6 offset:23040
    v_and_b32 v13, s62, v238
    v_fma_f32 v12, v12, v10, v11
    v_fma_f32 v13, v13, v10, v11
    v_cvt_pk_bf16_f32 v238, v12, v13
    v_mfma_f32_32x32x16_bf16 v[96:111], a[116:119], v[232:235], v[96:111]
    ds_read_b64_tr_b16 a[108:109], v7 offset:22528
    ds_read_b64_tr_b16 a[110:111], v7 offset:23040
    v_lshlrev_b32 v14, 16, v239
    v_and_b32 v15, s62, v239
    v_fma_f32 v14, v14, v10, v11
    v_fma_f32 v15, v15, v10, v11
    v_cvt_pk_bf16_f32 v239, v14, v15
    s_waitcnt lgkmcnt(6)
    v_mfma_f32_32x32x16_bf16 v[112:127], a[120:123], v[232:235], v[112:127]
    ds_read_b64_tr_b16 a[112:113], v8 offset:22528
    ds_read_b64_tr_b16 a[114:115], v8 offset:23040
    s_waitcnt vmcnt(6)
    ds_read_b64_tr_b16 a[192:193], v26 offset:32768
    v_lshlrev_b32 v12, 16, v240
    v_and_b32 v13, s62, v240
    v_mfma_f32_32x32x16_bf16 v[32:47], a[124:127], v[236:239], v[32:47]
    ds_read_b128 a[76:79], v29 offset:37632
    ds_read_b64_tr_b16 a[116:117], v9 offset:20480
    ds_read_b64_tr_b16 a[118:119], v9 offset:20992
    ds_read_b64_tr_b16 a[194:195], v26 offset:33792
    v_fma_f32 v12, v12, v10, v11
    v_fma_f32 v13, v13, v10, v11
    v_mfma_f32_32x32x16_bf16 v[48:63], a[96:99], v[236:239], v[48:63]
    s_barrier
    ds_read_b64_tr_b16 a[120:121], v1 offset:24576
    ds_read_b64_tr_b16 a[122:123], v1 offset:25088
    s_add_u32 m0, s61, 8192
    s_nop 0
    buffer_load_dwordx4 v20, s[16:19], s49 offen offset:0 lds
    s_waitcnt lgkmcnt(9)
    v_mfma_f32_32x32x16_bf16 v[64:79], a[100:103], v[236:239], v[64:79]
    ds_read_b64_tr_b16 a[124:125], v2 offset:24576
    ds_read_b64_tr_b16 a[126:127], v2 offset:25088
    ds_read_b64_tr_b16 a[196:197], v27 offset:32768
    buffer_load_dwordx4 v21, s[16:19], s49 offen offset:1024 lds
    v_mfma_f32_32x32x16_bf16 v[80:95], a[104:107], v[236:239], v[80:95]
    ds_read_b64_tr_b16 a[96:97], v5 offset:24576
    ds_read_b64_tr_b16 a[98:99], v5 offset:25088
    ds_read_b64_tr_b16 a[198:199], v27 offset:33792
    buffer_load_dwordx4 v22, s[16:19], s49 offen offset:2048 lds
    v_cvt_pk_bf16_f32 v240, v12, v13
    v_lshlrev_b32 v14, 16, v241
    v_and_b32 v15, s62, v241
    v_fma_f32 v14, v14, v10, v11
    v_mfma_f32_32x32x16_bf16 v[96:111], a[108:111], v[236:239], v[96:111]
    s_waitcnt lgkmcnt(14)
    ds_read_b64_tr_b16 a[100:101], v6 offset:24576
    s_waitcnt lgkmcnt(14)
    ds_read_b64_tr_b16 a[102:103], v6 offset:25088
    s_waitcnt vmcnt(7)
    buffer_load_dwordx4 v23, s[16:19], s49 offen offset:3072 lds
    v_fma_f32 v15, v15, v10, v11
    v_cvt_pk_bf16_f32 v241, v14, v15
    v_lshlrev_b32 v12, 16, v242
    v_and_b32 v13, s62, v242
    v_fma_f32 v12, v12, v10, v11
    v_fma_f32 v13, v13, v10, v11
    s_waitcnt lgkmcnt(8)
    v_mfma_f32_32x32x16_bf16 v[112:127], a[112:115], v[236:239], v[112:127]
    ds_read_b64_tr_b16 a[104:105], v7 offset:24576
    ds_read_b64_tr_b16 a[106:107], v7 offset:25088
    ds_read_b64_tr_b16 a[200:201], v26 offset:34816
    s_add_u32 m0, s61, 12288
    s_add_u32 s49, s49, 98304
    buffer_load_dwordx4 v20, s[16:19], s49 offen offset:0 lds
    v_cvt_pk_bf16_f32 v242, v12, v13
    v_lshlrev_b32 v14, 16, v243
    v_and_b32 v15, s62, v243
    v_fma_f32 v14, v14, v10, v11
    v_fma_f32 v15, v15, v10, v11
    v_cvt_pk_bf16_f32 v243, v14, v15
    v_subrev_u32 v16, 81920, v5
    v_mfma_f32_16x16x32_bf16 a[64:67], a[116:119], a[76:79], a[64:67]
    ds_read_b64_tr_b16 a[108:109], v8 offset:24576
    ds_read_b64_tr_b16 a[110:111], v8 offset:25088
    v_mfma_f32_32x32x16_bf16 v[32:47], a[120:123], v[240:243], v[32:47]
    ds_read_b64_tr_b16 a[112:113], v1 offset:26624
    ds_read_b64_tr_b16 a[114:115], v1 offset:27136
    buffer_load_dwordx4 v21, s[16:19], s49 offen offset:1024 lds
    v_subrev_u32 v31, 40960, v9
    v_lshlrev_b32 v12, 16, v244
    s_waitcnt lgkmcnt(7)
    v_mfma_f32_32x32x16_bf16 v[48:63], a[124:127], v[240:243], v[48:63]
    ds_read_b64_tr_b16 a[116:117], v2 offset:26624
    ds_read_b64_tr_b16 a[118:119], v2 offset:27136
    ds_read_b64_tr_b16 a[202:203], v26 offset:35840
    buffer_load_dwordx4 v22, s[16:19], s49 offen offset:2048 lds
    v_and_b32 v13, s62, v244
    v_mfma_f32_32x32x16_bf16 v[64:79], a[96:99], v[240:243], v[64:79]
    ds_read_b64_tr_b16 a[120:121], v5 offset:26624
    ds_read_b64_tr_b16 a[122:123], v5 offset:27136
    ds_read_b64_tr_b16 a[204:205], v27 offset:34816
    buffer_load_dwordx4 v23, s[16:19], s49 offen offset:3072 lds
    v_fma_f32 v12, v12, v10, v11
    v_fma_f32 v13, v13, v10, v11
    v_cvt_pk_bf16_f32 v244, v12, v13
    v_lshlrev_b32 v14, 16, v245
    v_and_b32 v15, s62, v245
    v_fma_f32 v14, v14, v10, v11
    v_mfma_f32_32x32x16_bf16 v[80:95], a[100:103], v[240:243], v[80:95]
    ds_read_b64_tr_b16 a[124:125], v6 offset:26624
    ds_read_b64_tr_b16 a[126:127], v6 offset:27136
    v_fma_f32 v15, v15, v10, v11
    v_cvt_pk_bf16_f32 v245, v14, v15
    v_lshlrev_b32 v12, 16, v246
    v_and_b32 v13, s62, v246
    v_fma_f32 v12, v12, v10, v11
    v_fma_f32 v13, v13, v10, v11
    v_subrev_u32 v17, 40960, v5
    s_waitcnt lgkmcnt(8)
    v_mfma_f32_32x32x16_bf16 v[96:111], a[104:107], v[240:243], v[96:111]
    ds_read_b64_tr_b16 a[96:97], v7 offset:26624
    ds_read_b64_tr_b16 a[98:99], v7 offset:27136
    ds_read_b64_tr_b16 a[206:207], v27 offset:35840
    s_waitcnt lgkmcnt(0)
    s_add_u32 m0, s61, 32768
    v_cvt_pk_bf16_f32 v246, v12, v13
    v_lshlrev_b32 v14, 16, v247
    v_and_b32 v15, s62, v247
    v_fma_f32 v14, v14, v10, v11
    v_fma_f32 v15, v15, v10, v11
    v_cvt_pk_bf16_f32 v247, v14, v15
    v_mfma_f32_32x32x16_bf16 v[112:127], a[108:111], v[240:243], v[112:127]
    ds_read_b64_tr_b16 a[100:101], v8 offset:26624
    ds_read_b64_tr_b16 a[102:103], v8 offset:27136
    s_lshl_b32 s63, s77, 4
    s_add_u32 s63, s63, s53
    s_add_u32 s63, s63, 32768
    buffer_load_dwordx4 v24, s[20:23], s63 offen offset:0 lds
    v_mfma_f32_32x32x16_bf16 v[32:47], a[112:115], v[244:247], v[32:47]
    ds_read_b128 a[72:75], v28 offset:37760
    ds_read_b64_tr_b16 a[104:105], v9 offset:24576
    ds_read_b64_tr_b16 a[106:107], v9 offset:25088
    buffer_load_dwordx4 v25, s[20:23], s63 offen offset:1024 lds
    v_lshlrev_b32 v12, 16, v248
    v_mfma_f32_32x32x16_bf16 v[48:63], a[116:119], v[244:247], v[48:63]
    ds_read_b64_tr_b16 a[108:109], v1 offset:28672
    ds_read_b64_tr_b16 a[110:111], v1 offset:29184
    s_add_u32 s63, s63, 14336
    buffer_load_dwordx4 v24, s[20:23], s63 offen offset:2048 lds
    v_and_b32 v13, s62, v248
    v_mfma_f32_32x32x16_bf16 v[64:79], a[120:123], v[244:247], v[64:79]
    ds_read_b64_tr_b16 a[112:113], v2 offset:28672
    ds_read_b64_tr_b16 a[114:115], v2 offset:29184
    buffer_load_dwordx4 v25, s[20:23], s63 offen offset:3072 lds
    v_subrev_u32 v18, 81920, v6
    v_fma_f32 v12, v12, v10, v11
    v_mfma_f32_32x32x16_bf16 v[80:95], a[124:127], v[244:247], v[80:95]
    ds_read_b64_tr_b16 a[116:117], v5 offset:28672
    ds_read_b64_tr_b16 a[118:119], v5 offset:29184
    v_fma_f32 v13, v13, v10, v11
    v_cvt_pk_bf16_f32 v248, v12, v13
    v_lshlrev_b32 v14, 16, v249
    v_and_b32 v15, s62, v249
    v_fma_f32 v14, v14, v10, v11
    s_waitcnt lgkmcnt(6)
    v_mfma_f32_32x32x16_bf16 v[96:111], a[96:99], v[244:247], v[96:111]
    ds_read_b64_tr_b16 a[120:121], v6 offset:28672
    ds_read_b64_tr_b16 a[122:123], v6 offset:29184
    v_fma_f32 v15, v15, v10, v11
    v_cvt_pk_bf16_f32 v249, v14, v15
    v_lshlrev_b32 v12, 16, v250
    v_and_b32 v13, s62, v250
    v_fma_f32 v12, v12, v10, v11
    v_fma_f32 v13, v13, v10, v11
    v_mfma_f32_32x32x16_bf16 v[112:127], a[100:103], v[244:247], v[112:127]
    ds_read_b64_tr_b16 a[124:125], v7 offset:28672
    ds_read_b64_tr_b16 a[126:127], v7 offset:29184
    v_cvt_pk_bf16_f32 v250, v12, v13
    v_lshlrev_b32 v14, 16, v251
    v_and_b32 v15, s62, v251
    v_fma_f32 v14, v14, v10, v11
    v_fma_f32 v15, v15, v10, v11
    v_cvt_pk_bf16_f32 v251, v14, v15
    v_mfma_f32_16x16x32_bf16 a[64:67], a[104:107], a[72:75], a[64:67]
    ds_read_b64_tr_b16 a[96:97], v8 offset:28672
    ds_read_b64_tr_b16 a[98:99], v8 offset:29184
    s_waitcnt lgkmcnt(6)
    v_mfma_f32_32x32x16_bf16 v[32:47], a[108:111], v[248:251], v[32:47]
    ds_read_b64_tr_b16 a[100:101], v1 offset:30720
    ds_read_b64_tr_b16 a[102:103], v1 offset:31232
    v_subrev_u32 v19, 40960, v6
    v_lshlrev_b32 v12, 16, v252
    v_and_b32 v13, s62, v252
    v_mfma_f32_32x32x16_bf16 v[48:63], a[112:115], v[248:251], v[48:63]
    ds_read_b64_tr_b16 a[104:105], v2 offset:30720
    ds_read_b64_tr_b16 a[106:107], v2 offset:31232
    v_fma_f32 v12, v12, v10, v11
    v_fma_f32 v13, v13, v10, v11
    v_cvt_pk_bf16_f32 v252, v12, v13
    v_lshlrev_b32 v14, 16, v253
    v_mfma_f32_32x32x16_bf16 v[64:79], a[116:119], v[248:251], v[64:79]
    ds_read_b64_tr_b16 a[108:109], v5 offset:30720
    ds_read_b64_tr_b16 a[110:111], v5 offset:31232
    v_and_b32 v15, s62, v253
    v_fma_f32 v14, v14, v10, v11
    v_fma_f32 v15, v15, v10, v11
    v_cvt_pk_bf16_f32 v253, v14, v15
    s_waitcnt lgkmcnt(6)
    v_mfma_f32_32x32x16_bf16 v[80:95], a[120:123], v[248:251], v[80:95]
    ds_read_b64_tr_b16 a[112:113], v6 offset:30720
    ds_read_b64_tr_b16 a[114:115], v6 offset:31232
    v_lshlrev_b32 v12, 16, v254
    v_and_b32 v13, s62, v254
    v_fma_f32 v12, v12, v10, v11
    v_fma_f32 v13, v13, v10, v11
    v_mfma_f32_32x32x16_bf16 v[96:111], a[124:127], v[248:251], v[96:111]
    ds_read_b64_tr_b16 a[116:117], v7 offset:30720
    ds_read_b64_tr_b16 a[118:119], v7 offset:31232
    v_cvt_pk_bf16_f32 v254, v12, v13
    v_lshlrev_b32 v14, 16, v255
    v_and_b32 v15, s62, v255
    v_fma_f32 v14, v14, v10, v11
    v_fma_f32 v15, v15, v10, v11
    v_cvt_pk_bf16_f32 v255, v14, v15
    v_mfma_f32_32x32x16_bf16 v[112:127], a[96:99], v[248:251], v[112:127]
    ds_read_b64_tr_b16 a[120:121], v8 offset:30720
    ds_read_b64_tr_b16 a[122:123], v8 offset:31232
    s_waitcnt lgkmcnt(6)
    v_mfma_f32_32x32x16_bf16 v[32:47], a[100:103], v[252:255], v[32:47]
    ds_read_b128 a[76:79], v29 offset:37760
    ds_read_b64_tr_b16 a[124:125], v9 offset:28672
    ds_read_b64_tr_b16 a[126:127], v9 offset:29184
    v_mfma_f32_32x32x16_bf16 v[48:63], a[104:107], v[252:255], v[48:63]
    s_waitcnt vmcnt(12)
    s_barrier
    ds_read_b64_tr_b16 a[96:97], v16 offset:0
    ds_read_b64_tr_b16 a[98:99], v16 offset:512
    v_mfma_f32_32x32x16_bf16 v[64:79], a[108:111], v[252:255], v[64:79]
    ds_read_b64_tr_b16 a[100:101], v18 offset:0
    ds_read_b64_tr_b16 a[102:103], v18 offset:512
    s_waitcnt lgkmcnt(7)
    v_mfma_f32_32x32x16_bf16 v[80:95], a[112:115], v[252:255], v[80:95]
    ds_read_b64_tr_b16 a[104:105], v16 offset:2048
    ds_read_b64_tr_b16 a[106:107], v16 offset:2560
    v_mfma_f32_32x32x16_bf16 v[96:111], a[116:119], v[252:255], v[96:111]
    ds_read_b64_tr_b16 a[108:109], v18 offset:2048
    ds_read_b64_tr_b16 a[110:111], v18 offset:2560
    v_mfma_f32_32x32x16_bf16 v[112:127], a[120:123], v[252:255], v[112:127]
    ds_read_b128 a[72:75], v28 offset:36864
    ds_read_b64_tr_b16 a[112:113], v3 offset:0
    ds_read_b64_tr_b16 a[114:115], v3 offset:512
    s_waitcnt vmcnt(2)
    ds_read_b64_tr_b16 a[208:209], v26 offset:32768
    s_waitcnt lgkmcnt(8)
    v_mfma_f32_16x16x32_bf16 a[64:67], a[124:127], a[76:79], a[64:67]
    ds_read_b64_tr_b16 a[116:117], v16 offset:4096
    ds_read_b64_tr_b16 a[118:119], v16 offset:4608
    v_mfma_f32_32x32x16_bf16 a[32:47], a[96:99], v[128:131], 0
    ds_read_b64_tr_b16 a[120:121], v18 offset:4096
    ds_read_b64_tr_b16 a[122:123], v18 offset:4608
    ds_read_b64_tr_b16 a[210:211], v26 offset:33792
    v_mfma_f32_32x32x16_bf16 a[48:63], a[100:103], v[128:131], 0
    ds_read_b64_tr_b16 a[124:125], v16 offset:6144
    ds_read_b64_tr_b16 a[126:127], v16 offset:6656
    s_waitcnt lgkmcnt(8)
    v_mfma_f32_32x32x16_bf16 a[32:47], a[104:107], v[132:135], a[32:47]
    ds_read_b64_tr_b16 a[96:97], v18 offset:6144
    ds_read_b64_tr_b16 a[98:99], v18 offset:6656
    ds_read_b64_tr_b16 a[212:213], v27 offset:32768
    v_max_f32 v32, 0, v32
    v_max_f32 v33, 0, v33
    v_max_f32 v34, 0, v34
    v_max_f32 v35, 0, v35
    v_max_f32 v36, 0, v36
    v_max_f32 v37, 0, v37
    v_mfma_f32_32x32x16_bf16 a[48:63], a[108:111], v[132:135], a[48:63]
    ds_read_b128 a[76:79], v29 offset:36864
    ds_read_b64_tr_b16 a[100:101], v3 offset:4096
    ds_read_b64_tr_b16 a[102:103], v3 offset:4608
    ds_read_b64_tr_b16 a[214:215], v27 offset:33792
    v_max_f32 v38, 0, v38
    v_max_f32 v39, 0, v39
    v_mul_f32 v32, v32, v40
    v_mul_f32 v33, v33, v41
    v_mul_f32 v34, v34, v42
    v_mul_f32 v35, v35, v43
    v_mfma_f32_16x16x32_bf16 a[68:71], a[112:115], a[72:75], 0
    s_waitcnt lgkmcnt(14)
    ds_read_b64_tr_b16 a[104:105], v17 offset:0
    s_waitcnt lgkmcnt(14)
    ds_read_b64_tr_b16 a[106:107], v17 offset:512
    s_waitcnt lgkmcnt(9)
    v_mfma_f32_32x32x16_bf16 a[32:47], a[116:119], v[136:139], a[32:47]
    ds_read_b64_tr_b16 a[108:109], v19 offset:0
    ds_read_b64_tr_b16 a[110:111], v19 offset:512
    s_waitcnt vmcnt(0)
    ds_read_b64_tr_b16 a[216:217], v26 offset:34816
    v_mul_f32 v36, v36, v44
    v_mul_f32 v37, v37, v45
    v_mul_f32 v38, v38, v46
    v_mul_f32 v39, v39, v47
    v_cvt_pk_bf16_f32 v40, v32, v33
    v_cvt_pk_bf16_f32 v41, v34, v35
    v_mfma_f32_32x32x16_bf16 a[48:63], a[120:123], v[136:139], a[48:63]
    ds_read_b64_tr_b16 a[112:113], v17 offset:2048
    ds_read_b64_tr_b16 a[114:115], v17 offset:2560
    ds_read_b64_tr_b16 a[218:219], v26 offset:35840
    v_cvt_pk_bf16_f32 v42, v36, v37
    v_cvt_pk_bf16_f32 v43, v38, v39
    v_max_f32 v48, 0, v48
    v_max_f32 v49, 0, v49
    v_max_f32 v50, 0, v50
    v_max_f32 v51, 0, v51
    v_max_f32 v52, 0, v52
    v_mfma_f32_32x32x16_bf16 a[32:47], a[124:127], v[140:143], a[32:47]
    s_waitcnt lgkmcnt(14)
    ds_read_b64_tr_b16 a[116:117], v19 offset:2048
    s_waitcnt lgkmcnt(14)
    ds_read_b64_tr_b16 a[118:119], v19 offset:2560
    v_max_f32 v53, 0, v53
    v_max_f32 v54, 0, v54
    v_max_f32 v55, 0, v55
    v_mul_f32 v48, v48, v56
    v_mul_f32 v49, v49, v57
    v_mul_f32 v50, v50, v58
    v_mul_f32 v51, v51, v59
    v_mul_f32 v52, v52, v60
    s_waitcnt lgkmcnt(8)
    v_mfma_f32_32x32x16_bf16 a[48:63], a[96:99], v[140:143], a[48:63]
    ds_read_b128 a[72:75], v28 offset:36992
    ds_read_b64_tr_b16 a[120:121], v4 offset:0
    ds_read_b64_tr_b16 a[122:123], v4 offset:512
    ds_read_b64_tr_b16 a[220:221], v27 offset:34816
    v_mul_f32 v53, v53, v61
    v_mul_f32 v54, v54, v62
    v_mul_f32 v55, v55, v63
    v_cvt_pk_bf16_f32 v56, v48, v49
    v_cvt_pk_bf16_f32 v57, v50, v51
    v_mfma_f32_16x16x32_bf16 a[68:71], a[100:103], a[76:79], a[68:71]
    ds_read_b64_tr_b16 a[124:125], v17 offset:4096
    ds_read_b64_tr_b16 a[126:127], v17 offset:4608
    v_mfma_f32_32x32x16_bf16 a[32:47], a[104:107], v[144:147], a[32:47]
    ds_read_b64_tr_b16 a[96:97], v19 offset:4096
    s_waitcnt lgkmcnt(14)
    ds_read_b64_tr_b16 a[98:99], v19 offset:4608
    v_cvt_pk_bf16_f32 v58, v52, v53
    v_cvt_pk_bf16_f32 v59, v54, v55
    s_lshl_b32 s72, s4, 1
    s_lshr_b32 s73, s3, 1
    s_add_u32 s72, s72, s73
    s_lshl_b32 s72, s72, 11
    s_lshl_b32 s73, s5, 3
    s_add_u32 s72, s72, s73
    s_waitcnt lgkmcnt(8)
    v_mfma_f32_32x32x16_bf16 a[48:63], a[108:111], v[144:147], a[48:63]
    ds_read_b64_tr_b16 a[100:101], v17 offset:6144
    ds_read_b64_tr_b16 a[102:103], v17 offset:6656
    ds_read_b64_tr_b16 a[222:223], v27 offset:35840
    s_waitcnt lgkmcnt(0)
    s_add_u32 m0, s61, 32768
    s_and_b32 s73, s3, 1
    s_lshl_b32 s73, s73, 2
    s_add_u32 s72, s72, s73
    s_add_u32 s72, s72, 10485760
    v_mfma_f32_32x32x16_bf16 a[32:47], a[112:115], v[148:151], a[32:47]
    ds_read_b64_tr_b16 a[104:105], v19 offset:6144
    ds_read_b64_tr_b16 a[106:107], v19 offset:6656
    s_lshl_b32 s63, s78, 4
    s_add_u32 s63, s63, s53
    buffer_load_dwordx4 v24, s[20:23], s63 offen offset:0 lds
    v_lshlrev_b32 v20, 4, v0
    v_add_u32 v20, s72, v20
    v_cmp_gt_u32 vcc, 128, v0
    v_mov_b32 v21, 2146435072
    v_mfma_f32_32x32x16_bf16 a[48:63], a[116:119], v[148:151], a[48:63]
    ds_read_b128 a[76:79], v29 offset:36992
    ds_read_b64_tr_b16 a[108:109], v4 offset:4096
    ds_read_b64_tr_b16 a[110:111], v4 offset:4608
    buffer_load_dwordx4 v25, s[20:23], s63 offen offset:1024 lds
    s_lshl_b32 s72, s7, 3
    v_cndmask_b32 v20, v21, v20, vcc
    s_add_u32 s72, s72, s60
    s_lshl_b32 s72, s72, 8
    s_lshl_b32 s73, s3, 5
    v_mfma_f32_16x16x32_bf16 a[68:71], a[120:123], a[72:75], a[68:71]
    ds_read_b64_tr_b16 a[112:113], v5 offset:0
    ds_read_b64_tr_b16 a[114:115], v5 offset:512
    v_mfma_f32_32x32x16_bf16 a[32:47], a[124:127], v[152:155], a[32:47]
    ds_read_b64_tr_b16 a[116:117], v6 offset:0
    ds_read_b64_tr_b16 a[118:119], v6 offset:512
    s_add_u32 s63, s63, 14336
    buffer_load_dwordx4 v24, s[20:23], s63 offen offset:2048 lds
    s_add_u32 s72, s72, s73
    s_add_u32 s72, s72, 10485760
    v_bfe_u32 v21, v0, 4, 3
    v_lshlrev_b32 v21, 2, v21
    v_add_u32 v21, s72, v21
    v_mfma_f32_32x32x16_bf16 a[48:63], a[96:99], v[152:155], a[48:63]
    ds_read_b64_tr_b16 a[120:121], v5 offset:2048
    ds_read_b64_tr_b16 a[122:123], v5 offset:2560
    buffer_load_dwordx4 v25, s[20:23], s63 offen offset:3072 lds
    v_mov_b32 v10, 1
    s_lshl_b32 s64, s7, 16
    s_lshr_b32 s72, s3, 1
    s_lshl_b32 s72, s72, 15
    s_add_u32 s64, s64, s72
    s_lshl_b32 s72, s60, 7
    s_waitcnt lgkmcnt(6)
    v_mfma_f32_32x32x16_bf16 a[32:47], a[100:103], v[156:159], a[32:47]
    ds_read_b64_tr_b16 a[124:125], v6 offset:2048
    ds_read_b64_tr_b16 a[126:127], v6 offset:2560
    buffer_store_dwordx4 v[40:43], v0, s[28:31], s52 offen offset:0 sc1
    s_add_u32 s64, s64, s72
    s_and_b32 s72, s3, 1
    s_lshl_b32 s72, s72, 6
    s_add_u32 s64, s64, s72
    v_lshrrev_b32 v30, 6, v0
    v_mfma_f32_32x32x16_bf16 a[48:63], a[104:107], v[156:159], a[48:63]
    ds_read_b128 a[72:75], v28 offset:37120
    ds_read_b64_tr_b16 a[96:97], v31 offset:0
    ds_read_b64_tr_b16 a[98:99], v31 offset:512
    buffer_store_dwordx4 v[56:59], v0, s[28:31], s52 offen offset:1024 sc1
    v_lshlrev_b32 v30, 10, v30
    v_mfma_f32_16x16x32_bf16 a[68:71], a[108:111], a[76:79], a[68:71]
    ds_read_b64_tr_b16 a[100:101], v5 offset:4096
    ds_read_b64_tr_b16 a[102:103], v5 offset:4608
    s_waitcnt lgkmcnt(7)
    v_mfma_f32_32x32x16_bf16 a[32:47], a[112:115], v[160:163], a[32:47]
    ds_read_b64_tr_b16 a[104:105], v6 offset:4096
    ds_read_b64_tr_b16 a[106:107], v6 offset:4608
    v_lshrrev_b32 v23, 4, v0
    v_xor_b32 v23, v23, v0
    v_and_b32 v23, 0x30, v23
    v_mfma_f32_32x32x16_bf16 a[48:63], a[116:119], v[160:163], a[48:63]
    ds_read_b64_tr_b16 a[108:109], v5 offset:6144
    ds_read_b64_tr_b16 a[110:111], v5 offset:6656
    v_add_u32 v23, v23, v30
    v_and_b32 v12, 0x1f0, v0
    v_lshrrev_b32 v13, 9, v0
    v_mul_u32_u24 v13, 81920, v13
    v_mfma_f32_32x32x16_bf16 a[32:47], a[120:123], v[164:167], a[32:47]
    ds_read_b64_tr_b16 a[112:113], v6 offset:6144
    ds_read_b64_tr_b16 a[114:115], v6 offset:6656
    s_lshl_b32 s72, s3, 9
    v_add3_u32 v22, v12, v13, s72
    v_cvt_pk_bf16_f32 v96, v96, v97
    v_cvt_pk_bf16_f32 v97, v98, v99
    s_waitcnt lgkmcnt(6)
    v_mfma_f32_32x32x16_bf16 a[48:63], a[124:127], v[164:167], a[48:63]
    ds_read_b128 a[76:79], v29 offset:37120
    ds_read_b64_tr_b16 a[116:117], v31 offset:4096
    ds_read_b64_tr_b16 a[118:119], v31 offset:4608
    v_cvt_pk_bf16_f32 v98, v100, v101
    v_cvt_pk_bf16_f32 v99, v102, v103
    v_mfma_f32_16x16x32_bf16 a[68:71], a[96:99], a[72:75], a[68:71]
    ds_read_b64_tr_b16 a[120:121], v7 offset:0
    ds_read_b64_tr_b16 a[122:123], v7 offset:512
    v_mfma_f32_32x32x16_bf16 a[32:47], a[100:103], v[168:171], a[32:47]
    ds_read_b64_tr_b16 a[124:125], v8 offset:0
    ds_read_b64_tr_b16 a[126:127], v8 offset:512
    v_cvt_pk_bf16_f32 v100, v104, v105
    v_cvt_pk_bf16_f32 v101, v106, v107
    v_cvt_pk_bf16_f32 v102, v108, v109
    v_cvt_pk_bf16_f32 v103, v110, v111
    s_waitcnt lgkmcnt(7)
    v_mfma_f32_32x32x16_bf16 a[48:63], a[104:107], v[168:171], a[48:63]
    ds_read_b64_tr_b16 a[96:97], v7 offset:2048
    ds_read_b64_tr_b16 a[98:99], v7 offset:2560
    v_cvt_pk_bf16_f32 v112, v112, v113
    v_cvt_pk_bf16_f32 v113, v114, v115
    v_cvt_pk_bf16_f32 v114, v116, v117
    v_mfma_f32_32x32x16_bf16 a[32:47], a[108:111], v[172:175], a[32:47]
    ds_read_b64_tr_b16 a[100:101], v8 offset:2048
    ds_read_b64_tr_b16 a[102:103], v8 offset:2560
    v_cvt_pk_bf16_f32 v115, v118, v119
    v_cvt_pk_bf16_f32 v116, v120, v121
    v_cvt_pk_bf16_f32 v117, v122, v123
    v_cvt_pk_bf16_f32 v118, v124, v125
    v_mfma_f32_32x32x16_bf16 a[48:63], a[112:115], v[172:175], a[48:63]
    ds_read_b128 a[72:75], v28 offset:37248
    ds_read_b64_tr_b16 a[104:105], v9 offset:0
    ds_read_b64_tr_b16 a[106:107], v9 offset:512
    v_cvt_pk_bf16_f32 v119, v126, v127
    v_permlane32_swap_b32 v96, v100
    v_permlane32_swap_b32 v97, v101
    s_waitcnt lgkmcnt(7)
    v_mfma_f32_16x16x32_bf16 a[68:71], a[116:119], a[76:79], a[68:71]
    ds_read_b64_tr_b16 a[108:109], v7 offset:4096
    ds_read_b64_tr_b16 a[110:111], v7 offset:4608
    v_mfma_f32_32x32x16_bf16 a[32:47], a[120:123], v[176:179], a[32:47]
    ds_read_b64_tr_b16 a[112:113], v8 offset:4096
    ds_read_b64_tr_b16 a[114:115], v8 offset:4608
    v_permlane32_swap_b32 v98, v102
    v_permlane32_swap_b32 v99, v103
    v_permlane32_swap_b32 v112, v116
    v_permlane32_swap_b32 v113, v117
    v_mfma_f32_32x32x16_bf16 a[48:63], a[124:127], v[176:179], a[48:63]
    ds_read_b64_tr_b16 a[116:117], v7 offset:6144
    ds_read_b64_tr_b16 a[118:119], v7 offset:6656
    v_permlane32_swap_b32 v114, v118
    v_permlane32_swap_b32 v115, v119
    ds_write_b128 v22, v[96:99] offset:16640
    ds_write_b128 v22, v[100:103] offset:57600
    s_waitcnt lgkmcnt(8)
    v_mfma_f32_32x32x16_bf16 a[32:47], a[96:99], v[180:183], a[32:47]
    ds_read_b64_tr_b16 a[120:121], v8 offset:6144
    ds_read_b64_tr_b16 a[122:123], v8 offset:6656
    ds_write_b128 v22, v[112:115] offset:18944
    ds_write_b128 v22, v[116:119] offset:59904
    v_accvgpr_read_b32 v104, a64
    v_mfma_f32_32x32x16_bf16 a[48:63], a[100:103], v[180:183], a[48:63]
    ds_read_b128 a[76:79], v29 offset:37248
    ds_read_b64_tr_b16 a[124:125], v9 offset:4096
    ds_read_b64_tr_b16 a[126:127], v9 offset:4608
    s_waitcnt vmcnt(4)
    v_accvgpr_read_b32 v105, a65
    v_accvgpr_read_b32 v106, a66
    v_accvgpr_read_b32 v107, a67
    v_mfma_f32_16x16x32_bf16 a[68:71], a[104:107], a[72:75], a[68:71]
    s_barrier
    s_waitcnt lgkmcnt(14)
    ds_read_b64_tr_b16 a[96:97], v16 offset:8192
    s_waitcnt lgkmcnt(14)
    ds_read_b64_tr_b16 a[98:99], v16 offset:8704
    s_waitcnt lgkmcnt(11)
    v_mfma_f32_32x32x16_bf16 a[32:47], a[108:111], v[184:187], a[32:47]
    ds_read_b64_tr_b16 a[100:101], v18 offset:8192
    ds_read_b64_tr_b16 a[102:103], v18 offset:8704
    ds_read_b64_tr_b16 a[224:225], v26 offset:32768
    s_add_u32 m0, s61, 30720
    s_nop 0
    buffer_load_dwordx4 v23, s[8:11], s64 offen lds
    v_mfma_f32_32x32x16_bf16 a[48:63], a[112:115], v[184:187], a[48:63]
    ds_read_b64_tr_b16 a[104:105], v16 offset:10240
    s_waitcnt lgkmcnt(14)
    ds_read_b64_tr_b16 a[106:107], v16 offset:10752
    s_add_u32 m0, s61, 31744
    s_add_u32 s63, s64, 16384
    buffer_load_dwordx4 v23, s[8:11], s63 offen lds
    v_mfma_f32_32x32x16_bf16 a[32:47], a[116:119], v[188:191], a[32:47]
    s_waitcnt lgkmcnt(14)
    ds_read_b64_tr_b16 a[108:109], v18 offset:10240
    s_waitcnt lgkmcnt(14)
    ds_read_b64_tr_b16 a[110:111], v18 offset:10752
    v_bfe_u32 v13, v0, 8, 1
    v_mul_u32_u24 v13, 40960, v13
    v_and_b32 v12, 0xf0, v0
    v_add_u32 v12, v12, v13
    s_waitcnt lgkmcnt(7)
    v_mfma_f32_32x32x16_bf16 a[48:63], a[120:123], v[188:191], a[48:63]
    ds_read_b128 a[72:75], v28 offset:37376
    ds_read_b64_tr_b16 a[112:113], v3 offset:8192
    ds_read_b64_tr_b16 a[114:115], v3 offset:8704
    ds_read_b64_tr_b16 a[226:227], v26 offset:33792
    v_lshrrev_b32 v13, 9, v0
    v_mfma_f32_16x16x32_bf16 a[68:71], a[124:127], a[76:79], a[68:71]
    ds_read_b64_tr_b16 a[116:117], v16 offset:12288
    ds_read_b64_tr_b16 a[118:119], v16 offset:12800
    v_mfma_f32_32x32x16_bf16 a[32:47], a[96:99], v[192:195], a[32:47]
    ds_read_b64_tr_b16 a[120:121], v18 offset:12288
    ds_read_b64_tr_b16 a[122:123], v18 offset:12800
    v_lshl_add_u32 v12, v13, 3, v12
    s_and_b32 s72, s3, 1
    s_mul_i32 s72, s72, 81920
    s_lshr_b32 s73, s3, 1
    s_waitcnt lgkmcnt(8)
    v_mfma_f32_32x32x16_bf16 a[48:63], a[100:103], v[192:195], a[48:63]
    ds_read_b64_tr_b16 a[124:125], v16 offset:14336
    ds_read_b64_tr_b16 a[126:127], v16 offset:14848
    ds_read_b64_tr_b16 a[228:229], v27 offset:32768
    s_mul_i32 s73, s73, 2304
    s_add_u32 s72, s72, s73
    v_mfma_f32_32x32x16_bf16 a[32:47], a[104:107], v[196:199], a[32:47]
    ds_read_b64_tr_b16 a[96:97], v18 offset:14336
    ds_read_b64_tr_b16 a[98:99], v18 offset:14848
    ds_read_b64_tr_b16 a[230:231], v27 offset:33792
    v_add_u32 v14, s72, v12
    v_cvt_pk_bf16_f32 v104, v104, v105
    v_cvt_pk_bf16_f32 v105, v106, v107
    v_mfma_f32_32x32x16_bf16 a[48:63], a[108:111], v[196:199], a[48:63]
    ds_read_b128 a[76:79], v29 offset:37376
    s_waitcnt lgkmcnt(14)
    ds_read_b64_tr_b16 a[100:101], v3 offset:12288
    s_waitcnt lgkmcnt(14)
    ds_read_b64_tr_b16 a[102:103], v3 offset:12800
    s_waitcnt vmcnt(4)
    s_waitcnt lgkmcnt(9)
    v_mfma_f32_16x16x32_bf16 a[68:71], a[112:115], a[72:75], a[68:71]
    ds_read_b64_tr_b16 a[104:105], v17 offset:8192
    ds_read_b64_tr_b16 a[106:107], v17 offset:8704
    v_mfma_f32_32x32x16_bf16 a[32:47], a[116:119], v[200:203], a[32:47]
    ds_read_b64_tr_b16 a[108:109], v19 offset:8192
    ds_read_b64_tr_b16 a[110:111], v19 offset:8704
    ds_read_b64_tr_b16 a[232:233], v26 offset:34816
    ds_write_b64 v14, v[104:105] offset:16384
    v_cvt_pk_bf16_f32 v64, v64, v65
    v_cvt_pk_bf16_f32 v65, v66, v67
    v_mfma_f32_32x32x16_bf16 a[48:63], a[120:123], v[200:203], a[48:63]
    s_waitcnt lgkmcnt(14)
    ds_read_b64_tr_b16 a[112:113], v17 offset:10240
    s_waitcnt lgkmcnt(14)
    ds_read_b64_tr_b16 a[114:115], v17 offset:10752
    v_cvt_pk_bf16_f32 v66, v68, v69
    v_cvt_pk_bf16_f32 v67, v70, v71
    v_cvt_pk_bf16_f32 v68, v72, v73
    v_cvt_pk_bf16_f32 v69, v74, v75
    s_waitcnt lgkmcnt(8)
    v_mfma_f32_32x32x16_bf16 a[32:47], a[124:127], v[204:207], a[32:47]
    ds_read_b64_tr_b16 a[116:117], v19 offset:10240
    ds_read_b64_tr_b16 a[118:119], v19 offset:10752
    ds_read_b64_tr_b16 a[234:235], v26 offset:35840
    v_cvt_pk_bf16_f32 v70, v76, v77
    v_cvt_pk_bf16_f32 v71, v78, v79
    v_mfma_f32_32x32x16_bf16 a[48:63], a[96:99], v[204:207], a[48:63]
    ds_read_b128 a[72:75], v28 offset:37504
    ds_read_b64_tr_b16 a[120:121], v4 offset:8192
    ds_read_b64_tr_b16 a[122:123], v4 offset:8704
    ds_read_b64_tr_b16 a[236:237], v27 offset:34816
    v_cvt_pk_bf16_f32 v80, v80, v81
    v_cvt_pk_bf16_f32 v81, v82, v83
    v_mfma_f32_16x16x32_bf16 a[68:71], a[100:103], a[76:79], a[68:71]
    s_waitcnt lgkmcnt(14)
    ds_read_b64_tr_b16 a[124:125], v17 offset:12288
    s_waitcnt lgkmcnt(14)
    ds_read_b64_tr_b16 a[126:127], v17 offset:12800
    s_waitcnt lgkmcnt(9)
    v_mfma_f32_32x32x16_bf16 a[32:47], a[104:107], v[208:211], a[32:47]
    ds_read_b64_tr_b16 a[96:97], v19 offset:12288
    ds_read_b64_tr_b16 a[98:99], v19 offset:12800
    ds_read_b64_tr_b16 a[238:239], v27 offset:35840
    s_waitcnt lgkmcnt(0)
    s_add_u32 m0, s61, 32768
    v_mfma_f32_32x32x16_bf16 a[48:63], a[108:111], v[208:211], a[48:63]
    ds_read_b64_tr_b16 a[100:101], v17 offset:14336
    ds_read_b64_tr_b16 a[102:103], v17 offset:14848
    s_lshl_b32 s63, s78, 4
    s_add_u32 s63, s63, s53
    s_add_u32 s63, s63, 32768
    buffer_load_dwordx4 v24, s[20:23], s63 offen offset:0 lds
    v_mfma_f32_32x32x16_bf16 a[32:47], a[112:115], v[212:215], a[32:47]
    ds_read_b64_tr_b16 a[104:105], v19 offset:14336
    ds_read_b64_tr_b16 a[106:107], v19 offset:14848
    buffer_load_dwordx4 v25, s[20:23], s63 offen offset:1024 lds
    v_cvt_pk_bf16_f32 v82, v84, v85
    v_cvt_pk_bf16_f32 v83, v86, v87
    v_mfma_f32_32x32x16_bf16 a[48:63], a[116:119], v[212:215], a[48:63]
    ds_read_b128 a[76:79], v29 offset:37504
    ds_read_b64_tr_b16 a[108:109], v4 offset:12288
    ds_read_b64_tr_b16 a[110:111], v4 offset:12800
    s_add_u32 s63, s63, 14336
    buffer_load_dwordx4 v24, s[20:23], s63 offen offset:2048 lds
    v_mfma_f32_16x16x32_bf16 a[68:71], a[120:123], a[72:75], a[68:71]
    ds_read_b64_tr_b16 a[112:113], v5 offset:8192
    ds_read_b64_tr_b16 a[114:115], v5 offset:8704
    v_mfma_f32_32x32x16_bf16 a[32:47], a[124:127], v[216:219], a[32:47]
    ds_read_b64_tr_b16 a[116:117], v6 offset:8192
    ds_read_b64_tr_b16 a[118:119], v6 offset:8704
    s_waitcnt vmcnt(5)
    buffer_store_dword v10, v20, s[28:31], 0 offen sc1
    buffer_load_dwordx4 v25, s[20:23], s63 offen offset:3072 lds
    s_waitcnt lgkmcnt(7)
    v_mfma_f32_32x32x16_bf16 a[48:63], a[96:99], v[216:219], a[48:63]
    ds_read_b64_tr_b16 a[120:121], v5 offset:10240
    ds_read_b64_tr_b16 a[122:123], v5 offset:10752
    v_cvt_pk_bf16_f32 v84, v88, v89
    v_cvt_pk_bf16_f32 v85, v90, v91
    v_cvt_pk_bf16_f32 v86, v92, v93
    v_mfma_f32_32x32x16_bf16 a[32:47], a[100:103], v[220:223], a[32:47]
    ds_read_b64_tr_b16 a[124:125], v6 offset:10240
    ds_read_b64_tr_b16 a[126:127], v6 offset:10752
    v_cvt_pk_bf16_f32 v87, v94, v95
    v_permlane32_swap_b32 v64, v68
    v_permlane32_swap_b32 v65, v69
    v_permlane32_swap_b32 v66, v70
    v_mfma_f32_32x32x16_bf16 a[48:63], a[104:107], v[220:223], a[48:63]
    ds_read_b128 a[72:75], v28 offset:37632
    ds_read_b64_tr_b16 a[96:97], v31 offset:8192
    ds_read_b64_tr_b16 a[98:99], v31 offset:8704
    v_permlane32_swap_b32 v67, v71
    v_permlane32_swap_b32 v80, v84
    v_permlane32_swap_b32 v81, v85
    s_waitcnt lgkmcnt(7)
    v_mfma_f32_16x16x32_bf16 a[68:71], a[108:111], a[76:79], a[68:71]
    ds_read_b64_tr_b16 a[100:101], v5 offset:12288
    ds_read_b64_tr_b16 a[102:103], v5 offset:12800
    v_mfma_f32_32x32x16_bf16 a[32:47], a[112:115], v[224:227], a[32:47]
    ds_read_b64_tr_b16 a[104:105], v6 offset:12288
    ds_read_b64_tr_b16 a[106:107], v6 offset:12800
    v_permlane32_swap_b32 v82, v86
    v_permlane32_swap_b32 v83, v87
    v_mfma_f32_32x32x16_bf16 a[48:63], a[116:119], v[224:227], a[48:63]
    ds_read_b64_tr_b16 a[108:109], v5 offset:14336
    ds_read_b64_tr_b16 a[110:111], v5 offset:14848
    s_waitcnt lgkmcnt(6)
    v_mfma_f32_32x32x16_bf16 a[32:47], a[120:123], v[228:231], a[32:47]
    ds_read_b64_tr_b16 a[112:113], v6 offset:14336
    ds_read_b64_tr_b16 a[114:115], v6 offset:14848
    v_mfma_f32_32x32x16_bf16 a[48:63], a[124:127], v[228:231], a[48:63]
    ds_read_b128 a[76:79], v29 offset:37632
    ds_read_b64_tr_b16 a[116:117], v31 offset:12288
    ds_read_b64_tr_b16 a[118:119], v31 offset:12800
    v_mfma_f32_16x16x32_bf16 a[68:71], a[96:99], a[72:75], a[68:71]
    ds_read_b64_tr_b16 a[120:121], v7 offset:8192
    ds_read_b64_tr_b16 a[122:123], v7 offset:8704
    s_waitcnt lgkmcnt(7)
    v_mfma_f32_32x32x16_bf16 a[32:47], a[100:103], v[232:235], a[32:47]
    ds_read_b64_tr_b16 a[124:125], v8 offset:8192
    ds_read_b64_tr_b16 a[126:127], v8 offset:8704
    v_mfma_f32_32x32x16_bf16 a[48:63], a[104:107], v[232:235], a[48:63]
    ds_read_b64_tr_b16 a[96:97], v7 offset:10240
    ds_read_b64_tr_b16 a[98:99], v7 offset:10752
    s_waitcnt vmcnt(3)
    ds_read_b64_tr_b16 a[240:241], v26 offset:32768
    v_mfma_f32_32x32x16_bf16 a[32:47], a[108:111], v[236:239], a[32:47]
    ds_read_b64_tr_b16 a[100:101], v8 offset:10240
    ds_read_b64_tr_b16 a[102:103], v8 offset:10752
    ds_read_b64_tr_b16 a[242:243], v26 offset:33792
    s_waitcnt lgkmcnt(8)
    v_mfma_f32_32x32x16_bf16 a[48:63], a[112:115], v[236:239], a[48:63]
    ds_read_b128 a[72:75], v28 offset:37760
    ds_read_b64_tr_b16 a[104:105], v9 offset:8192
    ds_read_b64_tr_b16 a[106:107], v9 offset:8704
    ds_read_b64_tr_b16 a[244:245], v27 offset:32768
    v_mfma_f32_16x16x32_bf16 a[68:71], a[116:119], a[76:79], a[68:71]
    ds_read_b64_tr_b16 a[108:109], v7 offset:12288
    ds_read_b64_tr_b16 a[110:111], v7 offset:12800
    v_mfma_f32_32x32x16_bf16 a[32:47], a[120:123], v[240:243], a[32:47]
    ds_read_b64_tr_b16 a[112:113], v8 offset:12288
    s_waitcnt lgkmcnt(14)
    ds_read_b64_tr_b16 a[114:115], v8 offset:12800
    s_waitcnt lgkmcnt(9)
    v_mfma_f32_32x32x16_bf16 a[48:63], a[124:127], v[240:243], a[48:63]
    ds_read_b64_tr_b16 a[116:117], v7 offset:14336
    ds_read_b64_tr_b16 a[118:119], v7 offset:14848
    ds_read_b64_tr_b16 a[246:247], v27 offset:33792
    v_mfma_f32_32x32x16_bf16 a[32:47], a[96:99], v[244:247], a[32:47]
    ds_read_b64_tr_b16 a[120:121], v8 offset:14336
    ds_read_b64_tr_b16 a[122:123], v8 offset:14848
    s_waitcnt vmcnt(0)
    ds_read_b64_tr_b16 a[248:249], v26 offset:34816
    v_mfma_f32_32x32x16_bf16 a[48:63], a[100:103], v[244:247], a[48:63]
    s_waitcnt lgkmcnt(14)
    ds_read_b128 a[76:79], v29 offset:37760
    s_waitcnt lgkmcnt(14)
    ds_read_b64_tr_b16 a[124:125], v9 offset:12288
    s_waitcnt lgkmcnt(14)
    ds_read_b64_tr_b16 a[126:127], v9 offset:12800
    s_waitcnt lgkmcnt(9)
    v_mfma_f32_16x16x32_bf16 a[68:71], a[104:107], a[72:75], a[68:71]
    v_mfma_f32_32x32x16_bf16 a[32:47], a[108:111], v[248:251], a[32:47]
    ds_read_b64_tr_b16 a[250:251], v26 offset:35840
    v_mfma_f32_32x32x16_bf16 a[48:63], a[112:115], v[248:251], a[48:63]
    ds_read_b64_tr_b16 a[252:253], v27 offset:34816
    s_waitcnt lgkmcnt(2)
    v_mfma_f32_32x32x16_bf16 a[32:47], a[116:119], v[252:255], a[32:47]
    ds_read_b64_tr_b16 a[254:255], v27 offset:35840
    s_waitcnt lgkmcnt(0)
    s_add_u32 m0, s61, 32768
    s_lshl_b32 s63, s79, 4
    s_add_u32 s63, s63, s53
    buffer_load_dwordx4 v24, s[20:23], s63 offen offset:0 lds
    v_mfma_f32_32x32x16_bf16 a[48:63], a[120:123], v[252:255], a[48:63]
    buffer_load_dwordx4 v25, s[20:23], s63 offen offset:1024 lds
    v_mfma_f32_16x16x32_bf16 a[68:71], a[124:127], a[76:79], a[68:71]
    v_and_b32 v12, 0x1f0, v0
    v_lshrrev_b32 v13, 9, v0
    s_lshl_b32 s72, s3, 9
    v_add_u32 v12, s72, v12
    v_mul_u32_u24 v14, 40960, v13
    v_add_u32 v16, v14, v12
    v_add_u32 v17, 81920, v16
    v_mul_u32_u24 v14, 2304, v13
    v_add_u32 v18, v14, v12
    v_add_u32 v19, 102912, v18
    v_add_u32 v18, 20992, v18
    v_lshrrev_b32 v13, 8, v0
    s_add_u32 s63, s63, 14336
    buffer_load_dwordx4 v24, s[20:23], s63 offen offset:2048 lds
    v_mul_u32_u24 v13, 40960, v13
    v_and_b32 v14, 0xf0, v0
    s_mul_i32 s72, s3, 2304
    v_add3_u32 v1, v13, v14, s72
    s_nop 0
    ds_write_b128 v16, a[32:35] offset:21248
    ds_write_b128 v17, a[36:39] offset:21248
    ds_write_b128 v16, a[40:43] offset:23552
    ds_write_b128 v17, a[44:47] offset:23552
    ds_write_b128 v16, a[48:51] offset:25856
    ds_write_b128 v17, a[52:55] offset:25856
    ds_write_b128 v16, a[56:59] offset:28160
    buffer_load_dwordx4 v25, s[20:23], s63 offen offset:3072 lds
    ds_write_b128 v17, a[60:63] offset:28160
    ds_write_b128 v1, a[68:71] offset:20992
    s_waitcnt lgkmcnt(0)
    s_barrier
    ds_read_b128 v[128:131], v22 offset:16640
    ds_read_b128 v[132:135], v22 offset:57600
    ds_read_b128 v[136:139], v22 offset:16608
    ds_read_b128 v[140:143], v22 offset:57568
    ds_read_b128 v[144:147], v22 offset:16576
    ds_read_b128 v[148:151], v22 offset:57536
    ds_read_b128 v[152:155], v22 offset:16544
    ds_read_b128 v[156:159], v22 offset:57504
    ds_read_b128 v[160:163], v22 offset:16512
    ds_read_b128 v[164:167], v22 offset:57472
    ds_read_b128 v[168:171], v22 offset:16480
    ds_read_b128 v[172:175], v22 offset:57440
    s_add_u32 m0, s61, 0
    s_lshl_b32 s63, s79, 4
    s_add_u32 s63, s63, s53
    s_add_u32 s63, s63, 32768
    buffer_load_dwordx4 v24, s[20:23], s63 offen offset:0 lds
    ds_read_b128 v[176:179], v22 offset:16448
    ds_read_b128 v[180:183], v22 offset:57408
    ds_read_b128 v[184:187], v22 offset:16416
    s_waitcnt lgkmcnt(14)
    ds_read_b128 v[188:191], v22 offset:57376
    s_lshl_b32 s72, s4, 7
    s_lshl_b32 s73, s3, 5
    s_add_u32 s72, s72, s73
    v_bfe_u32 v12, v0, 4, 5
    v_add_u32 v12, s72, v12
    v_mov_b32 v13, 0xcf6e6b28
    s_mov_b32 s74, 0x3eb8aa3b
    buffer_load_dwordx4 v25, s[20:23], s63 offen offset:1024 lds
    v_cmp_le_u32 vcc, 14, v12
    v_cmp_le_u32 s[50:51], 12, v12
    v_cmp_le_u32 s[48:49], 10, v12
    v_cmp_le_u32 s[46:47], 8, v12
    v_cmp_le_u32 s[44:45], 6, v12
    v_cmp_le_u32 s[42:43], 4, v12
    v_cmp_le_u32 s[40:41], 2, v12
    s_waitcnt lgkmcnt(12)
    v_dot2_f32_bf16 v32, v64, v128, 0
    v_dot2_f32_bf16 v33, v64, v136, 0
    v_dot2_f32_bf16 v32, v65, v129, v32
    v_dot2_f32_bf16 v33, v65, v137, v33
    v_dot2_f32_bf16 v32, v66, v130, v32
    v_dot2_f32_bf16 v33, v66, v138, v33
    v_dot2_f32_bf16 v32, v67, v131, v32
    v_dot2_f32_bf16 v33, v67, v139, v33
    v_dot2_f32_bf16 v32, v68, v132, v32
    v_dot2_f32_bf16 v33, v68, v140, v33
    v_dot2_f32_bf16 v32, v69, v133, v32
    s_add_u32 s63, s63, 14336
    buffer_load_dwordx4 v24, s[20:23], s63 offen offset:2048 lds
    v_dot2_f32_bf16 v33, v69, v141, v33
    v_dot2_f32_bf16 v32, v70, v134, v32
    v_dot2_f32_bf16 v33, v70, v142, v33
    v_dot2_f32_bf16 v32, v71, v135, v32
    v_dot2_f32_bf16 v33, v71, v143, v33
    ds_read_b128 v[128:131], v22 offset:18944
    ds_read_b128 v[132:135], v22 offset:59904
    ds_read_b128 v[136:139], v22 offset:18912
    s_waitcnt lgkmcnt(14)
    ds_read_b128 v[140:143], v22 offset:59872
    s_waitcnt lgkmcnt(12)
    v_dot2_f32_bf16 v34, v64, v144, 0
    buffer_load_dwordx4 v25, s[20:23], s63 offen offset:3072 lds
    v_dot2_f32_bf16 v35, v64, v152, 0
    v_dot2_f32_bf16 v34, v65, v145, v34
    v_dot2_f32_bf16 v35, v65, v153, v35
    v_dot2_f32_bf16 v34, v66, v146, v34
    v_dot2_f32_bf16 v35, v66, v154, v35
    v_dot2_f32_bf16 v34, v67, v147, v34
    v_dot2_f32_bf16 v35, v67, v155, v35
    v_dot2_f32_bf16 v34, v68, v148, v34
    v_dot2_f32_bf16 v35, v68, v156, v35
    v_dot2_f32_bf16 v34, v69, v149, v34
    v_dot2_f32_bf16 v35, v69, v157, v35
    v_dot2_f32_bf16 v34, v70, v150, v34
    s_add_u32 m0, s61, 4096
    s_add_u32 s63, s53, 131072
    buffer_load_dwordx4 v24, s[20:23], s63 offen offset:0 lds
    v_dot2_f32_bf16 v35, v70, v158, v35
    v_dot2_f32_bf16 v34, v71, v151, v34
    v_dot2_f32_bf16 v35, v71, v159, v35
    ds_read_b128 v[144:147], v22 offset:18880
    ds_read_b128 v[148:151], v22 offset:59840
    ds_read_b128 v[152:155], v22 offset:18848
    s_waitcnt lgkmcnt(14)
    ds_read_b128 v[156:159], v22 offset:59808
    s_waitcnt lgkmcnt(12)
    v_dot2_f32_bf16 v36, v64, v160, 0
    v_dot2_f32_bf16 v37, v64, v168, 0
    v_dot2_f32_bf16 v36, v65, v161, v36
    buffer_load_dwordx4 v25, s[20:23], s63 offen offset:1024 lds
    v_dot2_f32_bf16 v37, v65, v169, v37
    v_dot2_f32_bf16 v36, v66, v162, v36
    v_dot2_f32_bf16 v37, v66, v170, v37
    v_dot2_f32_bf16 v36, v67, v163, v36
    v_dot2_f32_bf16 v37, v67, v171, v37
    v_dot2_f32_bf16 v36, v68, v164, v36
    v_dot2_f32_bf16 v37, v68, v172, v37
    v_dot2_f32_bf16 v36, v69, v165, v36
    v_dot2_f32_bf16 v37, v69, v173, v37
    v_dot2_f32_bf16 v36, v70, v166, v36
    v_dot2_f32_bf16 v37, v70, v174, v37
    v_dot2_f32_bf16 v36, v71, v167, v36
    s_add_u32 s63, s63, 14336
    buffer_load_dwordx4 v24, s[20:23], s63 offen offset:2048 lds
    v_dot2_f32_bf16 v37, v71, v175, v37
    ds_read_b128 v[160:163], v22 offset:18816
    ds_read_b128 v[164:167], v22 offset:59776
    ds_read_b128 v[168:171], v22 offset:18784
    s_waitcnt lgkmcnt(14)
    ds_read_b128 v[172:175], v22 offset:59744
    s_waitcnt lgkmcnt(12)
    v_dot2_f32_bf16 v38, v64, v176, 0
    v_dot2_f32_bf16 v39, v64, v184, 0
    v_dot2_f32_bf16 v38, v65, v177, v38
    v_dot2_f32_bf16 v39, v65, v185, v39
    v_dot2_f32_bf16 v38, v66, v178, v38
    buffer_load_dwordx4 v25, s[20:23], s63 offen offset:3072 lds
    v_dot2_f32_bf16 v39, v66, v186, v39
    v_dot2_f32_bf16 v38, v67, v179, v38
    v_dot2_f32_bf16 v39, v67, v187, v39
    v_dot2_f32_bf16 v38, v68, v180, v38
    v_dot2_f32_bf16 v39, v68, v188, v39
    v_dot2_f32_bf16 v38, v69, v181, v38
    v_dot2_f32_bf16 v39, v69, v189, v39
    v_dot2_f32_bf16 v38, v70, v182, v38
    v_dot2_f32_bf16 v39, v70, v190, v39
    v_dot2_f32_bf16 v38, v71, v183, v38
    v_dot2_f32_bf16 v39, v71, v191, v39
    ds_read_b128 v[176:179], v22 offset:18752
    s_add_u32 m0, s61, 8192
    s_add_u32 s63, s53, 163840
    buffer_load_dwordx4 v24, s[20:23], s63 offen offset:0 lds
    ds_read_b128 v[180:183], v22 offset:59712
    ds_read_b128 v[184:187], v22 offset:18720
    s_waitcnt lgkmcnt(14)
    ds_read_b128 v[188:191], v22 offset:59680
    s_waitcnt lgkmcnt(12)
    v_dot2_f32_bf16 v40, v80, v128, 0
    v_dot2_f32_bf16 v41, v80, v136, 0
    v_dot2_f32_bf16 v40, v81, v129, v40
    v_dot2_f32_bf16 v41, v81, v137, v41
    v_dot2_f32_bf16 v40, v82, v130, v40
    v_dot2_f32_bf16 v41, v82, v138, v41
    v_dot2_f32_bf16 v40, v83, v131, v40
    v_dot2_f32_bf16 v41, v83, v139, v41
    v_dot2_f32_bf16 v40, v84, v132, v40
    v_dot2_f32_bf16 v41, v84, v140, v41
    v_dot2_f32_bf16 v40, v85, v133, v40
    buffer_load_dwordx4 v25, s[20:23], s63 offen offset:1024 lds
    v_dot2_f32_bf16 v41, v85, v141, v41
    v_dot2_f32_bf16 v40, v86, v134, v40
    v_dot2_f32_bf16 v41, v86, v142, v41
    v_dot2_f32_bf16 v40, v87, v135, v40
    v_dot2_f32_bf16 v41, v87, v143, v41
    ds_read_b128 v[128:131], v18 offset:256
    ds_read_b128 v[132:135], v18 offset:41216
    ds_read_b128 v[136:139], v19 offset:256
    s_waitcnt lgkmcnt(14)
    ds_read_b128 v[140:143], v19 offset:41216
    s_waitcnt lgkmcnt(12)
    v_dot2_f32_bf16 v42, v80, v144, 0
    s_add_u32 s63, s63, 14336
    buffer_load_dwordx4 v24, s[20:23], s63 offen offset:2048 lds
    v_dot2_f32_bf16 v43, v80, v152, 0
    v_dot2_f32_bf16 v42, v81, v145, v42
    v_dot2_f32_bf16 v43, v81, v153, v43
    v_dot2_f32_bf16 v42, v82, v146, v42
    v_dot2_f32_bf16 v43, v82, v154, v43
    v_dot2_f32_bf16 v42, v83, v147, v42
    v_dot2_f32_bf16 v43, v83, v155, v43
    v_dot2_f32_bf16 v42, v84, v148, v42
    v_dot2_f32_bf16 v43, v84, v156, v43
    v_dot2_f32_bf16 v42, v85, v149, v42
    v_dot2_f32_bf16 v43, v85, v157, v43
    v_dot2_f32_bf16 v42, v86, v150, v42
    buffer_load_dwordx4 v25, s[20:23], s63 offen offset:3072 lds
    v_dot2_f32_bf16 v43, v86, v158, v43
    v_dot2_f32_bf16 v42, v87, v151, v42
    v_dot2_f32_bf16 v43, v87, v159, v43
    ds_read_b128 v[144:147], v18 offset:224
    ds_read_b128 v[148:151], v18 offset:41184
    ds_read_b128 v[152:155], v19 offset:224
    s_waitcnt lgkmcnt(14)
    ds_read_b128 v[156:159], v19 offset:41184
    s_waitcnt lgkmcnt(12)
    v_dot2_f32_bf16 v44, v80, v160, 0
    v_dot2_f32_bf16 v45, v80, v168, 0
    v_dot2_f32_bf16 v44, v81, v161, v44
    s_add_u32 m0, s61, 12288
    s_add_u32 s63, s53, 327680
    buffer_load_dwordx4 v24, s[20:23], s63 offen offset:0 lds
    v_dot2_f32_bf16 v45, v81, v169, v45
    v_dot2_f32_bf16 v44, v82, v162, v44
    v_dot2_f32_bf16 v45, v82, v170, v45
    v_dot2_f32_bf16 v44, v83, v163, v44
    v_dot2_f32_bf16 v45, v83, v171, v45
    v_dot2_f32_bf16 v44, v84, v164, v44
    v_dot2_f32_bf16 v45, v84, v172, v45
    v_dot2_f32_bf16 v44, v85, v165, v44
    v_dot2_f32_bf16 v45, v85, v173, v45
    v_dot2_f32_bf16 v44, v86, v166, v44
    v_dot2_f32_bf16 v45, v86, v174, v45
    v_dot2_f32_bf16 v44, v87, v167, v44
    buffer_load_dwordx4 v25, s[20:23], s63 offen offset:1024 lds
    v_dot2_f32_bf16 v45, v87, v175, v45
    ds_read_b128 v[160:163], v18 offset:192
    ds_read_b128 v[164:167], v18 offset:41152
    ds_read_b128 v[168:171], v19 offset:192
    s_waitcnt lgkmcnt(14)
    ds_read_b128 v[172:175], v19 offset:41152
    s_waitcnt lgkmcnt(12)
    v_dot2_f32_bf16 v46, v80, v176, 0
    v_dot2_f32_bf16 v47, v80, v184, 0
    v_dot2_f32_bf16 v46, v81, v177, v46
    v_dot2_f32_bf16 v47, v81, v185, v47
    v_dot2_f32_bf16 v46, v82, v178, v46
    s_add_u32 s63, s63, 14336
    buffer_load_dwordx4 v24, s[20:23], s63 offen offset:2048 lds
    v_dot2_f32_bf16 v47, v82, v186, v47
    v_dot2_f32_bf16 v46, v83, v179, v46
    v_dot2_f32_bf16 v47, v83, v187, v47
    v_dot2_f32_bf16 v46, v84, v180, v46
    v_dot2_f32_bf16 v47, v84, v188, v47
    v_dot2_f32_bf16 v46, v85, v181, v46
    v_dot2_f32_bf16 v47, v85, v189, v47
    v_dot2_f32_bf16 v46, v86, v182, v46
    v_dot2_f32_bf16 v47, v86, v190, v47
    v_dot2_f32_bf16 v46, v87, v183, v46
    v_dot2_f32_bf16 v47, v87, v191, v47
    ds_read_b128 v[176:179], v18 offset:160
    buffer_load_dwordx4 v25, s[20:23], s63 offen offset:3072 lds
    ds_read_b128 v[180:183], v18 offset:41120
    ds_read_b128 v[184:187], v19 offset:160
    s_waitcnt lgkmcnt(14)
    ds_read_b128 v[188:191], v19 offset:41120
    s_nop 1
    v_cndmask_b32 v33, v13, v33, s[40:41]
    v_cndmask_b32 v34, v13, v34, s[42:43]
    v_cndmask_b32 v35, v13, v35, s[44:45]
    v_cndmask_b32 v36, v13, v36, s[46:47]
    v_cndmask_b32 v37, v13, v37, s[48:49]
    v_cndmask_b32 v38, v13, v38, s[50:51]
    v_cndmask_b32 v39, v13, v39, vcc
    v_max3_f32 v14, v32, v33, v34
    v_max3_f32 v15, v35, v36, v37
    v_max3_f32 v14, v14, v38, v39
    v_max_f32 v14, v14, v15
    v_mul_f32 v14, s74, v14
    s_add_u32 m0, s61, 36864
    s_add_u32 s63, s53, 360448
    buffer_load_dwordx4 v24, s[20:23], s63 offen offset:0 lds
    v_fma_f32 v32, v32, s74, -v14
    v_fma_f32 v33, v33, s74, -v14
    v_fma_f32 v34, v34, s74, -v14
    v_fma_f32 v35, v35, s74, -v14
    v_fma_f32 v36, v36, s74, -v14
    v_fma_f32 v37, v37, s74, -v14
    v_fma_f32 v38, v38, s74, -v14
    v_fma_f32 v39, v39, s74, -v14
    v_exp_f32 v32, v32
    v_exp_f32 v33, v33
    v_exp_f32 v34, v34
    v_exp_f32 v35, v35
    buffer_load_dwordx4 v25, s[20:23], s63 offen offset:1024 lds
    v_exp_f32 v36, v36
    v_exp_f32 v37, v37
    v_exp_f32 v38, v38
    v_exp_f32 v39, v39
    s_nop 0
    v_pk_add_f32 v[48:49], v[32:33], v[34:35]
    v_pk_add_f32 v[50:51], v[36:37], v[38:39]
    v_pk_add_f32 v[48:49], v[48:49], v[50:51]
    v_add_f32 v48, v48, v49
    v_rcp_f32 v48, v48
    s_nop 0
    v_pk_mul_f32 v[32:33], v[32:33], v[48:49] op_sel_hi:[1,0]
    s_add_u32 s63, s63, 14336
    buffer_load_dwordx4 v24, s[20:23], s63 offen offset:2048 lds
    v_pk_mul_f32 v[34:35], v[34:35], v[48:49] op_sel_hi:[1,0]
    v_pk_mul_f32 v[36:37], v[36:37], v[48:49] op_sel_hi:[1,0]
    v_pk_mul_f32 v[38:39], v[38:39], v[48:49] op_sel_hi:[1,0]
    v_cndmask_b32 v41, v13, v41, s[40:41]
    v_cndmask_b32 v42, v13, v42, s[42:43]
    v_cndmask_b32 v43, v13, v43, s[44:45]
    v_cndmask_b32 v44, v13, v44, s[46:47]
    v_cndmask_b32 v45, v13, v45, s[48:49]
    v_cndmask_b32 v46, v13, v46, s[50:51]
    v_cndmask_b32 v47, v13, v47, vcc
    v_max3_f32 v14, v40, v41, v42
    v_max3_f32 v15, v43, v44, v45
    buffer_load_dwordx4 v25, s[20:23], s63 offen offset:3072 lds
    v_max3_f32 v14, v14, v46, v47
    v_max_f32 v14, v14, v15
    v_mul_f32 v14, s74, v14
    v_fma_f32 v40, v40, s74, -v14
    v_fma_f32 v41, v41, s74, -v14
    v_fma_f32 v42, v42, s74, -v14
    v_fma_f32 v43, v43, s74, -v14
    v_fma_f32 v44, v44, s74, -v14
    v_fma_f32 v45, v45, s74, -v14
    v_fma_f32 v46, v46, s74, -v14
    v_fma_f32 v47, v47, s74, -v14
    v_exp_f32 v40, v40
    v_exp_f32 v41, v41
    v_exp_f32 v42, v42
    v_exp_f32 v43, v43
    v_exp_f32 v44, v44
    v_exp_f32 v45, v45
    v_exp_f32 v46, v46
    v_exp_f32 v47, v47
    s_nop 0
    v_pk_add_f32 v[48:49], v[40:41], v[42:43]
    v_pk_add_f32 v[50:51], v[44:45], v[46:47]
    v_pk_add_f32 v[48:49], v[48:49], v[50:51]
    v_add_f32 v48, v48, v49
    v_rcp_f32 v48, v48
    s_nop 0
    v_pk_mul_f32 v[40:41], v[40:41], v[48:49] op_sel_hi:[1,0]
    v_pk_mul_f32 v[42:43], v[42:43], v[48:49] op_sel_hi:[1,0]
    v_pk_mul_f32 v[44:45], v[44:45], v[48:49] op_sel_hi:[1,0]
    v_pk_mul_f32 v[46:47], v[46:47], v[48:49] op_sel_hi:[1,0]
    s_waitcnt lgkmcnt(12)
    v_pk_mul_f32 v[96:97], v[128:129], v[32:33] op_sel:[0,0] op_sel_hi:[1,0]
    v_pk_mul_f32 v[98:99], v[130:131], v[32:33] op_sel:[0,0] op_sel_hi:[1,0]
    v_pk_mul_f32 v[100:101], v[132:133], v[32:33] op_sel:[0,0] op_sel_hi:[1,0]
    v_pk_mul_f32 v[102:103], v[134:135], v[32:33] op_sel:[0,0] op_sel_hi:[1,0]
    v_pk_mul_f32 v[104:105], v[136:137], v[32:33] op_sel:[0,0] op_sel_hi:[1,0]
    v_pk_mul_f32 v[106:107], v[138:139], v[32:33] op_sel:[0,0] op_sel_hi:[1,0]
    v_pk_mul_f32 v[108:109], v[140:141], v[32:33] op_sel:[0,0] op_sel_hi:[1,0]
    v_pk_mul_f32 v[110:111], v[142:143], v[32:33] op_sel:[0,0] op_sel_hi:[1,0]
    ds_read_b128 v[128:131], v18 offset:128
    ds_read_b128 v[132:135], v18 offset:41088
    ds_read_b128 v[136:139], v19 offset:128
    buffer_load_dword v11, v21, s[28:31], 0 offen sc1
    s_waitcnt lgkmcnt(14)
    ds_read_b128 v[140:143], v19 offset:41088
    s_waitcnt lgkmcnt(12)
    v_pk_fma_f32 v[96:97], v[144:145], v[32:33], v[96:97] op_sel:[0,1,0] op_sel_hi:[1,1,1]
    v_pk_fma_f32 v[98:99], v[146:147], v[32:33], v[98:99] op_sel:[0,1,0] op_sel_hi:[1,1,1]
    v_pk_fma_f32 v[100:101], v[148:149], v[32:33], v[100:101] op_sel:[0,1,0] op_sel_hi:[1,1,1]
    v_pk_fma_f32 v[102:103], v[150:151], v[32:33], v[102:103] op_sel:[0,1,0] op_sel_hi:[1,1,1]
    v_pk_fma_f32 v[104:105], v[152:153], v[32:33], v[104:105] op_sel:[0,1,0] op_sel_hi:[1,1,1]
    v_pk_fma_f32 v[106:107], v[154:155], v[32:33], v[106:107] op_sel:[0,1,0] op_sel_hi:[1,1,1]
    v_pk_fma_f32 v[108:109], v[156:157], v[32:33], v[108:109] op_sel:[0,1,0] op_sel_hi:[1,1,1]
    v_pk_fma_f32 v[110:111], v[158:159], v[32:33], v[110:111] op_sel:[0,1,0] op_sel_hi:[1,1,1]
    ds_read_b128 v[144:147], v18 offset:96
    ds_read_b128 v[148:151], v18 offset:41056
    ds_read_b128 v[152:155], v19 offset:96
    s_waitcnt lgkmcnt(14)
    ds_read_b128 v[156:159], v19 offset:41056
    s_waitcnt lgkmcnt(12)
    v_pk_fma_f32 v[96:97], v[160:161], v[34:35], v[96:97] op_sel:[0,0,0] op_sel_hi:[1,0,1]
    v_pk_fma_f32 v[98:99], v[162:163], v[34:35], v[98:99] op_sel:[0,0,0] op_sel_hi:[1,0,1]
    v_pk_fma_f32 v[100:101], v[164:165], v[34:35], v[100:101] op_sel:[0,0,0] op_sel_hi:[1,0,1]
    v_pk_fma_f32 v[102:103], v[166:167], v[34:35], v[102:103] op_sel:[0,0,0] op_sel_hi:[1,0,1]
    v_pk_fma_f32 v[104:105], v[168:169], v[34:35], v[104:105] op_sel:[0,0,0] op_sel_hi:[1,0,1]
    v_pk_fma_f32 v[106:107], v[170:171], v[34:35], v[106:107] op_sel:[0,0,0] op_sel_hi:[1,0,1]
    v_pk_fma_f32 v[108:109], v[172:173], v[34:35], v[108:109] op_sel:[0,0,0] op_sel_hi:[1,0,1]
    v_pk_fma_f32 v[110:111], v[174:175], v[34:35], v[110:111] op_sel:[0,0,0] op_sel_hi:[1,0,1]
    ds_read_b128 v[160:163], v18 offset:64
    ds_read_b128 v[164:167], v18 offset:41024
    ds_read_b128 v[168:171], v19 offset:64
    s_waitcnt lgkmcnt(14)
    ds_read_b128 v[172:175], v19 offset:41024
    s_waitcnt lgkmcnt(12)
    v_pk_fma_f32 v[96:97], v[176:177], v[34:35], v[96:97] op_sel:[0,1,0] op_sel_hi:[1,1,1]
    v_pk_fma_f32 v[98:99], v[178:179], v[34:35], v[98:99] op_sel:[0,1,0] op_sel_hi:[1,1,1]
    v_pk_fma_f32 v[100:101], v[180:181], v[34:35], v[100:101] op_sel:[0,1,0] op_sel_hi:[1,1,1]
    v_pk_fma_f32 v[102:103], v[182:183], v[34:35], v[102:103] op_sel:[0,1,0] op_sel_hi:[1,1,1]
    v_pk_fma_f32 v[104:105], v[184:185], v[34:35], v[104:105] op_sel:[0,1,0] op_sel_hi:[1,1,1]
    v_pk_fma_f32 v[106:107], v[186:187], v[34:35], v[106:107] op_sel:[0,1,0] op_sel_hi:[1,1,1]
    v_pk_fma_f32 v[108:109], v[188:189], v[34:35], v[108:109] op_sel:[0,1,0] op_sel_hi:[1,1,1]
    v_pk_fma_f32 v[110:111], v[190:191], v[34:35], v[110:111] op_sel:[0,1,0] op_sel_hi:[1,1,1]
    ds_read_b128 v[176:179], v18 offset:32
    ds_read_b128 v[180:183], v18 offset:40992
    ds_read_b128 v[184:187], v19 offset:32
    s_waitcnt lgkmcnt(14)
    ds_read_b128 v[188:191], v19 offset:40992
    s_waitcnt lgkmcnt(12)
    v_pk_fma_f32 v[96:97], v[128:129], v[36:37], v[96:97] op_sel:[0,0,0] op_sel_hi:[1,0,1]
    v_pk_fma_f32 v[98:99], v[130:131], v[36:37], v[98:99] op_sel:[0,0,0] op_sel_hi:[1,0,1]
    v_pk_fma_f32 v[100:101], v[132:133], v[36:37], v[100:101] op_sel:[0,0,0] op_sel_hi:[1,0,1]
    v_pk_fma_f32 v[102:103], v[134:135], v[36:37], v[102:103] op_sel:[0,0,0] op_sel_hi:[1,0,1]
    v_pk_fma_f32 v[104:105], v[136:137], v[36:37], v[104:105] op_sel:[0,0,0] op_sel_hi:[1,0,1]
    v_pk_fma_f32 v[106:107], v[138:139], v[36:37], v[106:107] op_sel:[0,0,0] op_sel_hi:[1,0,1]
    v_pk_fma_f32 v[108:109], v[140:141], v[36:37], v[108:109] op_sel:[0,0,0] op_sel_hi:[1,0,1]
    v_pk_fma_f32 v[110:111], v[142:143], v[36:37], v[110:111] op_sel:[0,0,0] op_sel_hi:[1,0,1]
    ds_read_b128 v[128:131], v18 offset:4864
    ds_read_b128 v[132:135], v18 offset:45824
    ds_read_b128 v[136:139], v19 offset:4864
    s_waitcnt lgkmcnt(14)
    ds_read_b128 v[140:143], v19 offset:45824
    s_waitcnt lgkmcnt(12)
    v_pk_fma_f32 v[96:97], v[144:145], v[36:37], v[96:97] op_sel:[0,1,0] op_sel_hi:[1,1,1]
    v_pk_fma_f32 v[98:99], v[146:147], v[36:37], v[98:99] op_sel:[0,1,0] op_sel_hi:[1,1,1]
    v_pk_fma_f32 v[100:101], v[148:149], v[36:37], v[100:101] op_sel:[0,1,0] op_sel_hi:[1,1,1]
    v_pk_fma_f32 v[102:103], v[150:151], v[36:37], v[102:103] op_sel:[0,1,0] op_sel_hi:[1,1,1]
    v_pk_fma_f32 v[104:105], v[152:153], v[36:37], v[104:105] op_sel:[0,1,0] op_sel_hi:[1,1,1]
    v_pk_fma_f32 v[106:107], v[154:155], v[36:37], v[106:107] op_sel:[0,1,0] op_sel_hi:[1,1,1]
    v_pk_fma_f32 v[108:109], v[156:157], v[36:37], v[108:109] op_sel:[0,1,0] op_sel_hi:[1,1,1]
    v_pk_fma_f32 v[110:111], v[158:159], v[36:37], v[110:111] op_sel:[0,1,0] op_sel_hi:[1,1,1]
    ds_read_b128 v[144:147], v18 offset:4832
    ds_read_b128 v[148:151], v18 offset:45792
    ds_read_b128 v[152:155], v19 offset:4832
    s_waitcnt lgkmcnt(14)
    ds_read_b128 v[156:159], v19 offset:45792
    s_waitcnt lgkmcnt(12)
    v_pk_fma_f32 v[96:97], v[160:161], v[38:39], v[96:97] op_sel:[0,0,0] op_sel_hi:[1,0,1]
    v_pk_fma_f32 v[98:99], v[162:163], v[38:39], v[98:99] op_sel:[0,0,0] op_sel_hi:[1,0,1]
    v_pk_fma_f32 v[100:101], v[164:165], v[38:39], v[100:101] op_sel:[0,0,0] op_sel_hi:[1,0,1]
    v_pk_fma_f32 v[102:103], v[166:167], v[38:39], v[102:103] op_sel:[0,0,0] op_sel_hi:[1,0,1]
    v_pk_fma_f32 v[104:105], v[168:169], v[38:39], v[104:105] op_sel:[0,0,0] op_sel_hi:[1,0,1]
    v_pk_fma_f32 v[106:107], v[170:171], v[38:39], v[106:107] op_sel:[0,0,0] op_sel_hi:[1,0,1]
    v_pk_fma_f32 v[108:109], v[172:173], v[38:39], v[108:109] op_sel:[0,0,0] op_sel_hi:[1,0,1]
    v_pk_fma_f32 v[110:111], v[174:175], v[38:39], v[110:111] op_sel:[0,0,0] op_sel_hi:[1,0,1]
    ds_read_b128 v[160:163], v18 offset:4800
    ds_read_b128 v[164:167], v18 offset:45760
    ds_read_b128 v[168:171], v19 offset:4800
    s_waitcnt lgkmcnt(14)
    ds_read_b128 v[172:175], v19 offset:45760
    s_waitcnt lgkmcnt(12)
    v_pk_fma_f32 v[96:97], v[176:177], v[38:39], v[96:97] op_sel:[0,1,0] op_sel_hi:[1,1,1]
    v_pk_fma_f32 v[98:99], v[178:179], v[38:39], v[98:99] op_sel:[0,1,0] op_sel_hi:[1,1,1]
    v_pk_fma_f32 v[100:101], v[180:181], v[38:39], v[100:101] op_sel:[0,1,0] op_sel_hi:[1,1,1]
    v_pk_fma_f32 v[102:103], v[182:183], v[38:39], v[102:103] op_sel:[0,1,0] op_sel_hi:[1,1,1]
    v_pk_fma_f32 v[104:105], v[184:185], v[38:39], v[104:105] op_sel:[0,1,0] op_sel_hi:[1,1,1]
    v_pk_fma_f32 v[106:107], v[186:187], v[38:39], v[106:107] op_sel:[0,1,0] op_sel_hi:[1,1,1]
    v_pk_fma_f32 v[108:109], v[188:189], v[38:39], v[108:109] op_sel:[0,1,0] op_sel_hi:[1,1,1]
    v_pk_fma_f32 v[110:111], v[190:191], v[38:39], v[110:111] op_sel:[0,1,0] op_sel_hi:[1,1,1]
    ds_read_b128 v[176:179], v18 offset:4768
    ds_read_b128 v[180:183], v18 offset:45728
    ds_read_b128 v[184:187], v19 offset:4768
    s_waitcnt lgkmcnt(14)
    ds_read_b128 v[188:191], v19 offset:45728
    v_cvt_pk_bf16_f32 v112, v96, v97
    v_cvt_pk_bf16_f32 v113, v98, v99
    v_cvt_pk_bf16_f32 v116, v100, v101
    v_cvt_pk_bf16_f32 v117, v102, v103
    v_cvt_pk_bf16_f32 v114, v104, v105
    v_cvt_pk_bf16_f32 v115, v106, v107
    v_cvt_pk_bf16_f32 v118, v108, v109
    v_cvt_pk_bf16_f32 v119, v110, v111
    s_nop 1
    v_permlane32_swap_b32 v112, v116
    v_permlane32_swap_b32 v113, v117
    v_permlane32_swap_b32 v114, v118
    v_permlane32_swap_b32 v115, v119
    s_waitcnt lgkmcnt(12)
    v_pk_mul_f32 v[96:97], v[128:129], v[40:41] op_sel:[0,0] op_sel_hi:[1,0]
    v_pk_mul_f32 v[98:99], v[130:131], v[40:41] op_sel:[0,0] op_sel_hi:[1,0]
    v_pk_mul_f32 v[100:101], v[132:133], v[40:41] op_sel:[0,0] op_sel_hi:[1,0]
    v_pk_mul_f32 v[102:103], v[134:135], v[40:41] op_sel:[0,0] op_sel_hi:[1,0]
    v_pk_mul_f32 v[104:105], v[136:137], v[40:41] op_sel:[0,0] op_sel_hi:[1,0]
    v_pk_mul_f32 v[106:107], v[138:139], v[40:41] op_sel:[0,0] op_sel_hi:[1,0]
    v_pk_mul_f32 v[108:109], v[140:141], v[40:41] op_sel:[0,0] op_sel_hi:[1,0]
    v_pk_mul_f32 v[110:111], v[142:143], v[40:41] op_sel:[0,0] op_sel_hi:[1,0]
    ds_read_b128 v[128:131], v18 offset:4736
    ds_read_b128 v[132:135], v18 offset:45696
    ds_read_b128 v[136:139], v19 offset:4736
    s_waitcnt lgkmcnt(14)
    ds_read_b128 v[140:143], v19 offset:45696
    s_waitcnt lgkmcnt(12)
    v_pk_fma_f32 v[96:97], v[144:145], v[40:41], v[96:97] op_sel:[0,1,0] op_sel_hi:[1,1,1]
    v_pk_fma_f32 v[98:99], v[146:147], v[40:41], v[98:99] op_sel:[0,1,0] op_sel_hi:[1,1,1]
    v_pk_fma_f32 v[100:101], v[148:149], v[40:41], v[100:101] op_sel:[0,1,0] op_sel_hi:[1,1,1]
    v_pk_fma_f32 v[102:103], v[150:151], v[40:41], v[102:103] op_sel:[0,1,0] op_sel_hi:[1,1,1]
    v_pk_fma_f32 v[104:105], v[152:153], v[40:41], v[104:105] op_sel:[0,1,0] op_sel_hi:[1,1,1]
    v_pk_fma_f32 v[106:107], v[154:155], v[40:41], v[106:107] op_sel:[0,1,0] op_sel_hi:[1,1,1]
    v_pk_fma_f32 v[108:109], v[156:157], v[40:41], v[108:109] op_sel:[0,1,0] op_sel_hi:[1,1,1]
    v_pk_fma_f32 v[110:111], v[158:159], v[40:41], v[110:111] op_sel:[0,1,0] op_sel_hi:[1,1,1]
    ds_read_b128 v[144:147], v18 offset:4704
    ds_read_b128 v[148:151], v18 offset:45664
    ds_read_b128 v[152:155], v19 offset:4704
    s_waitcnt lgkmcnt(14)
    ds_read_b128 v[156:159], v19 offset:45664
    s_waitcnt lgkmcnt(12)
    v_pk_fma_f32 v[96:97], v[160:161], v[42:43], v[96:97] op_sel:[0,0,0] op_sel_hi:[1,0,1]
    v_pk_fma_f32 v[98:99], v[162:163], v[42:43], v[98:99] op_sel:[0,0,0] op_sel_hi:[1,0,1]
    v_pk_fma_f32 v[100:101], v[164:165], v[42:43], v[100:101] op_sel:[0,0,0] op_sel_hi:[1,0,1]
    v_pk_fma_f32 v[102:103], v[166:167], v[42:43], v[102:103] op_sel:[0,0,0] op_sel_hi:[1,0,1]
    v_pk_fma_f32 v[104:105], v[168:169], v[42:43], v[104:105] op_sel:[0,0,0] op_sel_hi:[1,0,1]
    v_pk_fma_f32 v[106:107], v[170:171], v[42:43], v[106:107] op_sel:[0,0,0] op_sel_hi:[1,0,1]
    v_pk_fma_f32 v[108:109], v[172:173], v[42:43], v[108:109] op_sel:[0,0,0] op_sel_hi:[1,0,1]
    v_pk_fma_f32 v[110:111], v[174:175], v[42:43], v[110:111] op_sel:[0,0,0] op_sel_hi:[1,0,1]
    ds_read_b128 v[160:163], v18 offset:4672
    ds_read_b128 v[164:167], v18 offset:45632
    ds_read_b128 v[168:171], v19 offset:4672
    s_waitcnt lgkmcnt(14)
    ds_read_b128 v[172:175], v19 offset:45632
    s_waitcnt lgkmcnt(12)
    v_pk_fma_f32 v[96:97], v[176:177], v[42:43], v[96:97] op_sel:[0,1,0] op_sel_hi:[1,1,1]
    v_pk_fma_f32 v[98:99], v[178:179], v[42:43], v[98:99] op_sel:[0,1,0] op_sel_hi:[1,1,1]
    v_pk_fma_f32 v[100:101], v[180:181], v[42:43], v[100:101] op_sel:[0,1,0] op_sel_hi:[1,1,1]
    v_pk_fma_f32 v[102:103], v[182:183], v[42:43], v[102:103] op_sel:[0,1,0] op_sel_hi:[1,1,1]
    v_pk_fma_f32 v[104:105], v[184:185], v[42:43], v[104:105] op_sel:[0,1,0] op_sel_hi:[1,1,1]
    v_pk_fma_f32 v[106:107], v[186:187], v[42:43], v[106:107] op_sel:[0,1,0] op_sel_hi:[1,1,1]
    v_pk_fma_f32 v[108:109], v[188:189], v[42:43], v[108:109] op_sel:[0,1,0] op_sel_hi:[1,1,1]
    v_pk_fma_f32 v[110:111], v[190:191], v[42:43], v[110:111] op_sel:[0,1,0] op_sel_hi:[1,1,1]
    ds_read_b128 v[176:179], v18 offset:4640
    ds_read_b128 v[180:183], v18 offset:45600
    ds_read_b128 v[184:187], v19 offset:4640
    s_waitcnt lgkmcnt(14)
    ds_read_b128 v[188:191], v19 offset:45600
    s_waitcnt lgkmcnt(12)
    v_pk_fma_f32 v[96:97], v[128:129], v[44:45], v[96:97] op_sel:[0,0,0] op_sel_hi:[1,0,1]
    v_pk_fma_f32 v[98:99], v[130:131], v[44:45], v[98:99] op_sel:[0,0,0] op_sel_hi:[1,0,1]
    v_pk_fma_f32 v[100:101], v[132:133], v[44:45], v[100:101] op_sel:[0,0,0] op_sel_hi:[1,0,1]
    v_pk_fma_f32 v[102:103], v[134:135], v[44:45], v[102:103] op_sel:[0,0,0] op_sel_hi:[1,0,1]
    v_pk_fma_f32 v[104:105], v[136:137], v[44:45], v[104:105] op_sel:[0,0,0] op_sel_hi:[1,0,1]
    v_pk_fma_f32 v[106:107], v[138:139], v[44:45], v[106:107] op_sel:[0,0,0] op_sel_hi:[1,0,1]
    v_pk_fma_f32 v[108:109], v[140:141], v[44:45], v[108:109] op_sel:[0,0,0] op_sel_hi:[1,0,1]
    v_pk_fma_f32 v[110:111], v[142:143], v[44:45], v[110:111] op_sel:[0,0,0] op_sel_hi:[1,0,1]
    s_waitcnt lgkmcnt(8)
    v_pk_fma_f32 v[96:97], v[144:145], v[44:45], v[96:97] op_sel:[0,1,0] op_sel_hi:[1,1,1]
    v_pk_fma_f32 v[98:99], v[146:147], v[44:45], v[98:99] op_sel:[0,1,0] op_sel_hi:[1,1,1]
    v_pk_fma_f32 v[100:101], v[148:149], v[44:45], v[100:101] op_sel:[0,1,0] op_sel_hi:[1,1,1]
    v_pk_fma_f32 v[102:103], v[150:151], v[44:45], v[102:103] op_sel:[0,1,0] op_sel_hi:[1,1,1]
    v_pk_fma_f32 v[104:105], v[152:153], v[44:45], v[104:105] op_sel:[0,1,0] op_sel_hi:[1,1,1]
    v_pk_fma_f32 v[106:107], v[154:155], v[44:45], v[106:107] op_sel:[0,1,0] op_sel_hi:[1,1,1]
    v_pk_fma_f32 v[108:109], v[156:157], v[44:45], v[108:109] op_sel:[0,1,0] op_sel_hi:[1,1,1]
    v_pk_fma_f32 v[110:111], v[158:159], v[44:45], v[110:111] op_sel:[0,1,0] op_sel_hi:[1,1,1]
    s_waitcnt lgkmcnt(4)
    v_pk_fma_f32 v[96:97], v[160:161], v[46:47], v[96:97] op_sel:[0,0,0] op_sel_hi:[1,0,1]
    v_pk_fma_f32 v[98:99], v[162:163], v[46:47], v[98:99] op_sel:[0,0,0] op_sel_hi:[1,0,1]
    v_pk_fma_f32 v[100:101], v[164:165], v[46:47], v[100:101] op_sel:[0,0,0] op_sel_hi:[1,0,1]
    v_pk_fma_f32 v[102:103], v[166:167], v[46:47], v[102:103] op_sel:[0,0,0] op_sel_hi:[1,0,1]
    v_pk_fma_f32 v[104:105], v[168:169], v[46:47], v[104:105] op_sel:[0,0,0] op_sel_hi:[1,0,1]
    v_pk_fma_f32 v[106:107], v[170:171], v[46:47], v[106:107] op_sel:[0,0,0] op_sel_hi:[1,0,1]
    v_pk_fma_f32 v[108:109], v[172:173], v[46:47], v[108:109] op_sel:[0,0,0] op_sel_hi:[1,0,1]
    v_pk_fma_f32 v[110:111], v[174:175], v[46:47], v[110:111] op_sel:[0,0,0] op_sel_hi:[1,0,1]
    s_waitcnt lgkmcnt(0)
    v_pk_fma_f32 v[96:97], v[176:177], v[46:47], v[96:97] op_sel:[0,1,0] op_sel_hi:[1,1,1]
    v_pk_fma_f32 v[98:99], v[178:179], v[46:47], v[98:99] op_sel:[0,1,0] op_sel_hi:[1,1,1]
    v_pk_fma_f32 v[100:101], v[180:181], v[46:47], v[100:101] op_sel:[0,1,0] op_sel_hi:[1,1,1]
    v_pk_fma_f32 v[102:103], v[182:183], v[46:47], v[102:103] op_sel:[0,1,0] op_sel_hi:[1,1,1]
    v_pk_fma_f32 v[104:105], v[184:185], v[46:47], v[104:105] op_sel:[0,1,0] op_sel_hi:[1,1,1]
    v_pk_fma_f32 v[106:107], v[186:187], v[46:47], v[106:107] op_sel:[0,1,0] op_sel_hi:[1,1,1]
    v_pk_fma_f32 v[108:109], v[188:189], v[46:47], v[108:109] op_sel:[0,1,0] op_sel_hi:[1,1,1]
    v_pk_fma_f32 v[110:111], v[190:191], v[46:47], v[110:111] op_sel:[0,1,0] op_sel_hi:[1,1,1]
    v_cvt_pk_bf16_f32 v120, v96, v97
    v_cvt_pk_bf16_f32 v121, v98, v99
    v_cvt_pk_bf16_f32 v124, v100, v101
    v_cvt_pk_bf16_f32 v125, v102, v103
    v_cvt_pk_bf16_f32 v122, v104, v105
    v_cvt_pk_bf16_f32 v123, v106, v107
    v_cvt_pk_bf16_f32 v126, v108, v109
    v_cvt_pk_bf16_f32 v127, v110, v111
    s_nop 1
    v_permlane32_swap_b32 v120, v124
    v_permlane32_swap_b32 v121, v125
    v_permlane32_swap_b32 v122, v126
    v_permlane32_swap_b32 v123, v127
    buffer_store_dwordx4 v[112:115], v0, s[28:31], s59 offen offset:0 sc1
    buffer_store_dwordx4 v[116:119], v0, s[28:31], s59 offen offset:1024 sc1
    buffer_store_dwordx4 v[120:123], v0, s[28:31], s59 offen offset:2048 sc1
    buffer_store_dwordx4 v[124:127], v0, s[28:31], s59 offen offset:3072 sc1
    s_waitcnt vmcnt(4)
    v_cmp_ne_u32 vcc, 1, v11
    s_nop 4
    s_cbranch_vccnz L_hspinA
L_hokA:
    v_and_b32 v12, 0x1f0, v0
    v_lshlrev_b32 v12, 2, v12
    v_lshrrev_b32 v13, 9, v0
    v_lshl_add_u32 v12, v13, 3, v12
    v_bfe_u32 v13, v0, 6, 2
    v_lshl_add_u32 v12, v13, 4, v12
    v_add_u32 v12, s61, v12
    v_xor_b32 v13, 16, v12
    v_xor_b32 v14, 32, v12
    v_xor_b32 v15, 48, v12
    ds_read_b64 v[64:65], v12 offset:30720
    ds_read_b64 v[66:67], v13 offset:30720
    ds_read_b64 v[68:69], v14 offset:30720
    ds_read_b64 v[70:71], v15 offset:30720
    s_add_u32 s65, s55, s75
    s_add_u32 s66, s56, s75
    buffer_load_dwordx4 a[32:35], v0, s[28:31], s65 offen offset:0 sc1
    buffer_load_dwordx4 a[36:39], v0, s[28:31], s66 offen offset:0 sc1
    buffer_load_dwordx4 a[40:43], v0, s[28:31], s65 offen offset:1024 sc1
    buffer_load_dwordx4 a[44:47], v0, s[28:31], s66 offen offset:1024 sc1
    s_waitcnt lgkmcnt(0)
    v_lshlrev_b32 v32, 16, v64
    v_and_b32 v33, s62, v64
    v_lshlrev_b32 v34, 16, v65
    v_and_b32 v35, s62, v65
    v_lshlrev_b32 v36, 16, v66
    v_and_b32 v37, s62, v66
    v_lshlrev_b32 v38, 16, v67
    v_and_b32 v39, s62, v67
    v_lshlrev_b32 v40, 16, v68
    v_and_b32 v41, s62, v68
    v_lshlrev_b32 v42, 16, v69
    v_and_b32 v43, s62, v69
    v_lshlrev_b32 v44, 16, v70
    v_and_b32 v45, s62, v70
    v_lshlrev_b32 v46, 16, v71
    v_and_b32 v47, s62, v71
    s_nop 1
    buffer_load_dwordx4 a[48:51], v0, s[28:31], s65 offen offset:2048 sc1
    buffer_load_dwordx4 a[52:55], v0, s[28:31], s66 offen offset:2048 sc1
    buffer_load_dwordx4 a[56:59], v0, s[28:31], s65 offen offset:3072 sc1
    buffer_load_dwordx4 a[60:63], v0, s[28:31], s66 offen offset:3072 sc1
    s_add_u32 s65, s55, s76
    s_add_u32 s66, s56, s76
    buffer_load_dwordx4 a[64:67], v0, s[28:31], s65 offen offset:0 sc1
    buffer_load_dwordx4 a[68:71], v0, s[28:31], s66 offen offset:0 sc1
    s_waitcnt vmcnt(8)
    v_mfma_f32_32x32x16_bf16 v[32:47], a[128:131], a[32:35], v[32:47]
    v_mfma_f32_32x32x16_bf16 v[48:63], a[132:135], a[32:35], 0
    buffer_store_dword v10, v20, s[28:31], 0 offen offset:128 sc1
    v_mfma_f32_32x32x16_bf16 v[64:79], a[128:131], a[36:39], 0
    v_mfma_f32_32x32x16_bf16 v[80:95], a[132:135], a[36:39], 0
    buffer_load_dwordx4 a[72:75], v0, s[28:31], s65 offen offset:1024 sc1
    buffer_load_dwordx4 a[76:79], v0, s[28:31], s66 offen offset:1024 sc1
    s_waitcnt vmcnt(9)
    v_mfma_f32_32x32x16_bf16 v[32:47], a[136:139], a[40:43], v[32:47]
    buffer_load_dwordx4 v[192:195], v0, s[28:31], s65 offen offset:2048 sc1
    v_mfma_f32_32x32x16_bf16 v[48:63], a[140:143], a[40:43], v[48:63]
    v_mfma_f32_32x32x16_bf16 v[64:79], a[136:139], a[44:47], v[64:79]
    buffer_load_dwordx4 v[196:199], v0, s[28:31], s66 offen offset:2048 sc1
    v_mfma_f32_32x32x16_bf16 v[80:95], a[140:143], a[44:47], v[80:95]
    buffer_load_dwordx4 v[200:203], v0, s[28:31], s65 offen offset:3072 sc1
    s_waitcnt vmcnt(10)
    v_mfma_f32_32x32x16_bf16 v[32:47], a[144:147], a[48:51], v[32:47]
    v_mfma_f32_32x32x16_bf16 v[48:63], a[148:151], a[48:51], v[48:63]
    buffer_load_dwordx4 v[204:207], v0, s[28:31], s66 offen offset:3072 sc1
    v_mfma_f32_32x32x16_bf16 v[64:79], a[144:147], a[52:55], v[64:79]
    s_add_u32 s65, s55, s77
    s_add_u32 s66, s56, s77
    buffer_load_dwordx4 v[208:211], v0, s[28:31], s65 offen offset:0 sc1
    v_mfma_f32_32x32x16_bf16 v[80:95], a[148:151], a[52:55], v[80:95]
    s_waitcnt vmcnt(10)
    v_mfma_f32_32x32x16_bf16 v[32:47], a[152:155], a[56:59], v[32:47]
    buffer_load_dwordx4 v[212:215], v0, s[28:31], s66 offen offset:0 sc1
    v_mfma_f32_32x32x16_bf16 v[48:63], a[156:159], a[56:59], v[48:63]
    buffer_load_dwordx4 v[216:219], v0, s[28:31], s65 offen offset:1024 sc1
    v_mfma_f32_32x32x16_bf16 v[64:79], a[152:155], a[60:63], v[64:79]
    v_mfma_f32_32x32x16_bf16 v[80:95], a[156:159], a[60:63], v[80:95]
    buffer_load_dwordx4 v[220:223], v0, s[28:31], s66 offen offset:1024 sc1
    s_waitcnt vmcnt(11)
    v_mfma_f32_32x32x16_bf16 v[32:47], a[160:163], a[64:67], v[32:47]
    buffer_load_dwordx4 v[224:227], v0, s[28:31], s65 offen offset:2048 sc1
    v_mfma_f32_32x32x16_bf16 v[48:63], a[164:167], a[64:67], v[48:63]
    v_mfma_f32_32x32x16_bf16 v[64:79], a[160:163], a[68:71], v[64:79]
    buffer_load_dwordx4 v[228:231], v0, s[28:31], s66 offen offset:2048 sc1
    v_mfma_f32_32x32x16_bf16 v[80:95], a[164:167], a[68:71], v[80:95]
    buffer_load_dwordx4 v[232:235], v0, s[28:31], s65 offen offset:3072 sc1
    s_waitcnt vmcnt(11)
    v_mfma_f32_32x32x16_bf16 v[32:47], a[168:171], a[72:75], v[32:47]
    v_mfma_f32_32x32x16_bf16 v[48:63], a[172:175], a[72:75], v[48:63]
    buffer_load_dwordx4 v[236:239], v0, s[28:31], s66 offen offset:3072 sc1
    v_mfma_f32_32x32x16_bf16 v[64:79], a[168:171], a[76:79], v[64:79]
    v_mfma_f32_32x32x16_bf16 v[80:95], a[172:175], a[76:79], v[80:95]
    s_add_u32 s65, s55, s78
    s_add_u32 s66, s56, s78
    buffer_load_dwordx4 v[240:243], v0, s[28:31], s65 offen offset:0 sc1
    s_waitcnt vmcnt(11)
    v_mfma_f32_32x32x16_bf16 v[32:47], a[176:179], v[192:195], v[32:47]
    buffer_load_dwordx4 v[244:247], v0, s[28:31], s66 offen offset:0 sc1
    v_mfma_f32_32x32x16_bf16 v[48:63], a[180:183], v[192:195], v[48:63]
    v_mfma_f32_32x32x16_bf16 v[64:79], a[176:179], v[196:199], v[64:79]
    buffer_load_dwordx4 v[248:251], v0, s[28:31], s65 offen offset:1024 sc1
    v_mfma_f32_32x32x16_bf16 v[80:95], a[180:183], v[196:199], v[80:95]
    buffer_load_dwordx4 v[252:255], v0, s[28:31], s66 offen offset:1024 sc1
    s_waitcnt vmcnt(12)
    v_mfma_f32_32x32x16_bf16 v[32:47], a[184:187], v[200:203], v[32:47]
    v_mfma_f32_32x32x16_bf16 v[48:63], a[188:191], v[200:203], v[48:63]
    buffer_load_dwordx4 v[96:99], v0, s[28:31], s65 offen offset:2048 sc1
    v_mfma_f32_32x32x16_bf16 v[64:79], a[184:187], v[204:207], v[64:79]
    buffer_load_dwordx4 v[100:103], v0, s[28:31], s66 offen offset:2048 sc1
    v_mfma_f32_32x32x16_bf16 v[80:95], a[188:191], v[204:207], v[80:95]
    s_waitcnt vmcnt(12)
    v_mfma_f32_32x32x16_bf16 v[32:47], a[192:195], v[208:211], v[32:47]
    buffer_load_dwordx4 v[104:107], v0, s[28:31], s65 offen offset:3072 sc1
    v_mfma_f32_32x32x16_bf16 v[48:63], a[196:199], v[208:211], v[48:63]
    buffer_load_dwordx4 v[108:111], v0, s[28:31], s66 offen offset:3072 sc1
    v_mfma_f32_32x32x16_bf16 v[64:79], a[192:195], v[212:215], v[64:79]
    v_mfma_f32_32x32x16_bf16 v[80:95], a[196:199], v[212:215], v[80:95]
    s_add_u32 s65, s55, s79
    s_add_u32 s66, s56, s79
    buffer_load_dwordx4 v[112:115], v0, s[28:31], s65 offen offset:0 sc1
    s_waitcnt vmcnt(13)
    v_mfma_f32_32x32x16_bf16 v[32:47], a[200:203], v[216:219], v[32:47]
    buffer_load_dwordx4 v[116:119], v0, s[28:31], s66 offen offset:0 sc1
    v_mfma_f32_32x32x16_bf16 v[48:63], a[204:207], v[216:219], v[48:63]
    v_mfma_f32_32x32x16_bf16 v[64:79], a[200:203], v[220:223], v[64:79]
    buffer_load_dwordx4 v[120:123], v0, s[28:31], s65 offen offset:1024 sc1
    v_mfma_f32_32x32x16_bf16 v[80:95], a[204:207], v[220:223], v[80:95]
    buffer_load_dwordx4 v[124:127], v0, s[28:31], s66 offen offset:1024 sc1
    s_waitcnt vmcnt(14)
    v_mfma_f32_32x32x16_bf16 v[32:47], a[208:211], v[224:227], v[32:47]
    v_mfma_f32_32x32x16_bf16 v[48:63], a[212:215], v[224:227], v[48:63]
    buffer_load_dword v11, v21, s[28:31], 0 offen offset:128 sc1
    v_mfma_f32_32x32x16_bf16 v[64:79], a[208:211], v[228:231], v[64:79]
    v_mfma_f32_32x32x16_bf16 v[80:95], a[212:215], v[228:231], v[80:95]
    buffer_load_dwordx4 v[128:131], v0, s[28:31], s65 offen offset:2048 sc1
    s_waitcnt vmcnt(14)
    v_mfma_f32_32x32x16_bf16 v[32:47], a[216:219], v[232:235], v[32:47]
    buffer_load_dwordx4 v[132:135], v0, s[28:31], s66 offen offset:2048 sc1
    v_mfma_f32_32x32x16_bf16 v[48:63], a[220:223], v[232:235], v[48:63]
    v_mfma_f32_32x32x16_bf16 v[64:79], a[216:219], v[236:239], v[64:79]
    buffer_load_dwordx4 v[136:139], v0, s[28:31], s65 offen offset:3072 sc1
    v_mfma_f32_32x32x16_bf16 v[80:95], a[220:223], v[236:239], v[80:95]
    buffer_load_dwordx4 v[140:143], v0, s[28:31], s66 offen offset:3072 sc1
    s_waitcnt vmcnt(15)
    v_mfma_f32_32x32x16_bf16 v[32:47], a[224:227], v[240:243], v[32:47]
    v_mfma_f32_32x32x16_bf16 v[48:63], a[228:231], v[240:243], v[48:63]
    v_mfma_f32_32x32x16_bf16 v[64:79], a[224:227], v[244:247], v[64:79]
    v_mfma_f32_32x32x16_bf16 v[80:95], a[228:231], v[244:247], v[80:95]
    s_waitcnt vmcnt(13)
    v_mfma_f32_32x32x16_bf16 v[32:47], a[232:235], v[248:251], v[32:47]
    v_mfma_f32_32x32x16_bf16 v[48:63], a[236:239], v[248:251], v[48:63]
    v_mfma_f32_32x32x16_bf16 v[64:79], a[232:235], v[252:255], v[64:79]
    v_mfma_f32_32x32x16_bf16 v[80:95], a[236:239], v[252:255], v[80:95]
    s_waitcnt vmcnt(4)
    v_cmp_ne_u32 vcc, 1, v11
    s_nop 4
    s_and_b32 vcc_lo, vcc_lo, 0x0f0f0f0f
    s_cbranch_scc1 L_mspinA
L_mokA:
    v_mfma_f32_32x32x16_bf16 v[32:47], a[240:243], v[96:99], v[32:47]
    ds_read_b64_tr_b16 a[96:97], v26 offset:32768
    ds_read_b64_tr_b16 a[98:99], v26 offset:33792
    ds_read_b64_tr_b16 a[100:101], v27 offset:32768
    ds_read_b64_tr_b16 a[102:103], v27 offset:33792
    v_mfma_f32_32x32x16_bf16 v[48:63], a[244:247], v[96:99], v[48:63]
    s_add_u32 s65, s55, 8192
    s_add_u32 s66, s56, 8192
    buffer_load_dwordx4 v[144:147], v0, s[28:31], s65 offen offset:0 sc1
    v_mfma_f32_32x32x16_bf16 v[64:79], a[240:243], v[100:103], v[64:79]
    buffer_load_dwordx4 v[148:151], v0, s[28:31], s66 offen offset:0 sc1
    v_mfma_f32_32x32x16_bf16 v[80:95], a[244:247], v[100:103], v[80:95]
    buffer_load_dwordx4 v[152:155], v0, s[28:31], s65 offen offset:1024 sc1
    v_mfma_f32_32x32x16_bf16 v[32:47], a[248:251], v[104:107], v[32:47]
    ds_read_b64_tr_b16 a[104:105], v26 offset:34816
    ds_read_b64_tr_b16 a[106:107], v26 offset:35840
    ds_read_b64_tr_b16 a[108:109], v27 offset:34816
    ds_read_b64_tr_b16 a[110:111], v27 offset:35840
    v_mfma_f32_32x32x16_bf16 v[48:63], a[252:255], v[104:107], v[48:63]
    buffer_load_dwordx4 v[156:159], v0, s[28:31], s66 offen offset:1024 sc1
    v_mfma_f32_32x32x16_bf16 v[64:79], a[248:251], v[108:111], v[64:79]
    buffer_load_dwordx4 v[160:163], v0, s[28:31], s65 offen offset:2048 sc1
    v_mfma_f32_32x32x16_bf16 v[80:95], a[252:255], v[108:111], v[80:95]
    buffer_load_dwordx4 v[164:167], v0, s[28:31], s66 offen offset:2048 sc1
    s_waitcnt lgkmcnt(4)
    v_mfma_f32_32x32x16_bf16 v[32:47], a[96:99], v[112:115], v[32:47]
    ds_read_b64_tr_b16 a[112:113], v26 offset:0
    ds_read_b64_tr_b16 a[114:115], v26 offset:1024
    ds_read_b64_tr_b16 a[116:117], v27 offset:0
    ds_read_b64_tr_b16 a[118:119], v27 offset:1024
    v_mfma_f32_32x32x16_bf16 v[48:63], a[100:103], v[112:115], v[48:63]
    buffer_load_dwordx4 v[168:171], v0, s[28:31], s65 offen offset:3072 sc1
    v_mfma_f32_32x32x16_bf16 v[64:79], a[96:99], v[116:119], v[64:79]
    buffer_load_dwordx4 v[172:175], v0, s[28:31], s66 offen offset:3072 sc1
    v_mfma_f32_32x32x16_bf16 v[80:95], a[100:103], v[116:119], v[80:95]
    s_waitcnt lgkmcnt(4)
    v_mfma_f32_32x32x16_bf16 v[32:47], a[104:107], v[120:123], v[32:47]
    ds_read_b64_tr_b16 a[120:121], v26 offset:2048
    ds_read_b64_tr_b16 a[122:123], v26 offset:3072
    ds_read_b64_tr_b16 a[124:125], v27 offset:2048
    ds_read_b64_tr_b16 a[126:127], v27 offset:3072
    v_mfma_f32_32x32x16_bf16 v[48:63], a[108:111], v[120:123], v[48:63]
    s_add_u32 s65, s55, 20480
    s_add_u32 s66, s56, 20480
    buffer_load_dwordx4 v[176:179], v0, s[28:31], s65 offen offset:0 sc1
    v_mfma_f32_32x32x16_bf16 v[64:79], a[104:107], v[124:127], v[64:79]
    buffer_load_dwordx4 v[180:183], v0, s[28:31], s66 offen offset:0 sc1
    v_mfma_f32_32x32x16_bf16 v[80:95], a[108:111], v[124:127], v[80:95]
    buffer_load_dwordx4 v[184:187], v0, s[28:31], s65 offen offset:1024 sc1
    s_waitcnt vmcnt(13) lgkmcnt(4)
    v_mfma_f32_32x32x16_bf16 v[32:47], a[112:115], v[128:131], v[32:47]
    ds_read_b64_tr_b16 a[96:97], v26 offset:4096
    ds_read_b64_tr_b16 a[98:99], v26 offset:5120
    ds_read_b64_tr_b16 a[100:101], v27 offset:4096
    ds_read_b64_tr_b16 a[102:103], v27 offset:5120
    v_mfma_f32_32x32x16_bf16 v[48:63], a[116:119], v[128:131], v[48:63]
    buffer_load_dwordx4 v[188:191], v0, s[28:31], s66 offen offset:1024 sc1
    v_mfma_f32_32x32x16_bf16 v[64:79], a[112:115], v[132:135], v[64:79]
    buffer_load_dwordx4 a[32:35], v0, s[28:31], s65 offen offset:2048 sc1
    v_mfma_f32_32x32x16_bf16 v[80:95], a[116:119], v[132:135], v[80:95]
    s_waitcnt vmcnt(13) lgkmcnt(4)
    v_mfma_f32_32x32x16_bf16 v[32:47], a[120:123], v[136:139], v[32:47]
    ds_read_b64_tr_b16 a[104:105], v26 offset:6144
    ds_read_b64_tr_b16 a[106:107], v26 offset:7168
    ds_read_b64_tr_b16 a[108:109], v27 offset:6144
    ds_read_b64_tr_b16 a[110:111], v27 offset:7168
    v_mfma_f32_32x32x16_bf16 v[48:63], a[124:127], v[136:139], v[48:63]
    buffer_load_dword v11, v21, s[28:31], 0 offen offset:128 sc1
    v_mfma_f32_32x32x16_bf16 v[64:79], a[120:123], v[140:143], v[64:79]
    buffer_load_dwordx4 a[36:39], v0, s[28:31], s66 offen offset:2048 sc1
    v_mfma_f32_32x32x16_bf16 v[80:95], a[124:127], v[140:143], v[80:95]
    s_add_u32 m0, s61, 32768
    s_add_u32 s63, s54, 0
    buffer_load_dwordx4 v24, s[24:27], s63 offen offset:0 lds
    s_waitcnt vmcnt(14) lgkmcnt(4)
    v_mfma_f32_32x32x16_bf16 v[32:47], a[96:99], v[144:147], v[32:47]
    ds_read_b64_tr_b16 a[112:113], v26 offset:8192
    ds_read_b64_tr_b16 a[114:115], v26 offset:9216
    ds_read_b64_tr_b16 a[116:117], v27 offset:8192
    ds_read_b64_tr_b16 a[118:119], v27 offset:9216
    v_mfma_f32_32x32x16_bf16 v[48:63], a[100:103], v[144:147], v[48:63]
    buffer_load_dwordx4 v25, s[24:27], s63 offen offset:1024 lds
    v_mfma_f32_32x32x16_bf16 v[64:79], a[96:99], v[148:151], v[64:79]
    buffer_load_dwordx4 a[40:43], v0, s[28:31], s65 offen offset:3072 sc1
    v_mfma_f32_32x32x16_bf16 v[80:95], a[100:103], v[148:151], v[80:95]
    buffer_load_dwordx4 a[44:47], v0, s[28:31], s66 offen offset:3072 sc1
    s_waitcnt vmcnt(15) lgkmcnt(4)
    v_mfma_f32_32x32x16_bf16 v[32:47], a[104:107], v[152:155], v[32:47]
    ds_read_b64_tr_b16 a[120:121], v26 offset:10240
    ds_read_b64_tr_b16 a[122:123], v26 offset:11264
    ds_read_b64_tr_b16 a[124:125], v27 offset:10240
    ds_read_b64_tr_b16 a[126:127], v27 offset:11264
    v_mfma_f32_32x32x16_bf16 v[48:63], a[108:111], v[152:155], v[48:63]
    s_add_u32 s63, s63, 14336
    buffer_load_dwordx4 v24, s[24:27], s63 offen offset:2048 lds
    v_mfma_f32_32x32x16_bf16 v[64:79], a[104:107], v[156:159], v[64:79]
    buffer_load_dwordx4 v25, s[24:27], s63 offen offset:3072 lds
    v_mfma_f32_32x32x16_bf16 v[80:95], a[108:111], v[156:159], v[80:95]
    s_waitcnt vmcnt(15) lgkmcnt(4)
    v_mfma_f32_32x32x16_bf16 v[32:47], a[112:115], v[160:163], v[32:47]
    ds_read_b64_tr_b16 a[96:97], v26 offset:12288
    ds_read_b64_tr_b16 a[98:99], v26 offset:13312
    ds_read_b64_tr_b16 a[100:101], v27 offset:12288
    ds_read_b64_tr_b16 a[102:103], v27 offset:13312
    v_mfma_f32_32x32x16_bf16 v[48:63], a[116:119], v[160:163], v[48:63]
    s_add_u32 m0, s61, 0
    s_add_u32 s63, s54, 32768
    buffer_load_dwordx4 v24, s[24:27], s63 offen offset:0 lds
    v_mfma_f32_32x32x16_bf16 v[64:79], a[112:115], v[164:167], v[64:79]
    buffer_load_dwordx4 v25, s[24:27], s63 offen offset:1024 lds
    v_mfma_f32_32x32x16_bf16 v[80:95], a[116:119], v[164:167], v[80:95]
    s_add_u32 s63, s63, 14336
    buffer_load_dwordx4 v24, s[24:27], s63 offen offset:2048 lds
    s_waitcnt vmcnt(10)
    v_cmp_ne_u32 vcc, 1, v11
    s_nop 4
    s_and_b32 vcc_lo, vcc_lo, 0xf0f0f0f0
    s_cbranch_scc1 L_ospinA
L_ookA:
    s_waitcnt lgkmcnt(4)
    v_mfma_f32_32x32x16_bf16 v[32:47], a[120:123], v[168:171], v[32:47]
    ds_read_b64_tr_b16 a[104:105], v26 offset:14336
    ds_read_b64_tr_b16 a[106:107], v26 offset:15360
    ds_read_b64_tr_b16 a[108:109], v27 offset:14336
    ds_read_b64_tr_b16 a[110:111], v27 offset:15360
    v_mfma_f32_32x32x16_bf16 v[48:63], a[124:127], v[168:171], v[48:63]
    buffer_load_dwordx4 a[48:51], v0, s[28:31], s57 offen offset:0 sc1
    v_mfma_f32_32x32x16_bf16 v[64:79], a[120:123], v[172:175], v[64:79]
    buffer_load_dwordx4 a[52:55], v0, s[28:31], s58 offen offset:0 sc1
    v_mfma_f32_32x32x16_bf16 v[80:95], a[124:127], v[172:175], v[80:95]
    s_waitcnt lgkmcnt(4)
    v_mfma_f32_32x32x16_bf16 v[32:47], a[96:99], v[176:179], v[32:47]
    ds_read_b64_tr_b16 a[112:113], v26 offset:36864
    ds_read_b64_tr_b16 a[114:115], v26 offset:37888
    ds_read_b64_tr_b16 a[116:117], v27 offset:36864
    ds_read_b64_tr_b16 a[118:119], v27 offset:37888
    v_mfma_f32_32x32x16_bf16 v[48:63], a[100:103], v[176:179], v[48:63]
    buffer_load_dwordx4 a[56:59], v0, s[28:31], s57 offen offset:1024 sc1
    v_mfma_f32_32x32x16_bf16 v[64:79], a[96:99], v[180:183], v[64:79]
    buffer_load_dwordx4 a[60:63], v0, s[28:31], s58 offen offset:1024 sc1
    v_mfma_f32_32x32x16_bf16 v[80:95], a[100:103], v[180:183], v[80:95]
    buffer_load_dwordx4 v25, s[24:27], s63 offen offset:3072 lds
    s_waitcnt lgkmcnt(4)
    v_mfma_f32_32x32x16_bf16 v[32:47], a[104:107], v[184:187], v[32:47]
    ds_read_b64_tr_b16 a[120:121], v26 offset:38912
    ds_read_b64_tr_b16 a[122:123], v26 offset:39936
    ds_read_b64_tr_b16 a[124:125], v27 offset:38912
    ds_read_b64_tr_b16 a[126:127], v27 offset:39936
    v_mfma_f32_32x32x16_bf16 v[48:63], a[108:111], v[184:187], v[48:63]
    buffer_load_dwordx4 a[64:67], v0, s[28:31], s57 offen offset:2048 sc1
    v_mfma_f32_32x32x16_bf16 v[64:79], a[104:107], v[188:191], v[64:79]
    buffer_load_dwordx4 a[68:71], v0, s[28:31], s58 offen offset:2048 sc1
    v_mfma_f32_32x32x16_bf16 v[80:95], a[108:111], v[188:191], v[80:95]
    s_add_u32 m0, s61, 4096
    s_add_u32 s63, s54, 65536
    buffer_load_dwordx4 v24, s[24:27], s63 offen offset:0 lds
    s_waitcnt vmcnt(17) lgkmcnt(4)
    v_mfma_f32_32x32x16_bf16 v[32:47], a[112:115], a[32:35], v[32:47]
    s_waitcnt vmcnt(15)
    ds_read_b64_tr_b16 a[96:97], v26 offset:32768
    ds_read_b64_tr_b16 a[98:99], v26 offset:33792
    ds_read_b64_tr_b16 a[100:101], v27 offset:32768
    ds_read_b64_tr_b16 a[102:103], v27 offset:33792
    v_add_u32 v12, s61, v0
    s_xor_b32 s72, s3, 1
    s_mul_i32 s72, s72, 40960
    v_mfma_f32_32x32x16_bf16 v[48:63], a[116:119], a[32:35], v[48:63]
    buffer_load_dwordx4 v25, s[24:27], s63 offen offset:1024 lds
    v_add_u32 v13, s72, v0
    s_xor_b32 s72, s3, 2
    s_mul_i32 s72, s72, 40960
    v_mfma_f32_32x32x16_bf16 v[64:79], a[112:115], a[36:39], v[64:79]
    buffer_load_dwordx4 a[72:75], v0, s[28:31], s57 offen offset:3072 sc1
    v_add_u32 v14, s72, v0
    s_xor_b32 s72, s3, 3
    s_mul_i32 s72, s72, 40960
    v_mfma_f32_32x32x16_bf16 v[80:95], a[116:119], a[36:39], v[80:95]
    v_add_u32 v15, s72, v0
    v_and_b32 v17, 0x1f0, v0
    v_lshlrev_b32 v17, 6, v17
    buffer_load_dwordx4 a[76:79], v0, s[28:31], s58 offen offset:3072 sc1
    s_waitcnt vmcnt(16) lgkmcnt(4)
    v_mfma_f32_32x32x16_bf16 v[32:47], a[120:123], a[40:43], v[32:47]
    s_waitcnt vmcnt(14)
    ds_read_b64_tr_b16 a[104:105], v26 offset:34816
    ds_read_b64_tr_b16 a[106:107], v26 offset:35840
    ds_read_b64_tr_b16 a[108:109], v27 offset:34816
    ds_read_b64_tr_b16 a[110:111], v27 offset:35840
    v_lshrrev_b32 v18, 9, v0
    v_lshl_add_u32 v16, v18, 4, v17
    v_mfma_f32_32x32x16_bf16 v[48:63], a[124:127], a[40:43], v[48:63]
    s_add_u32 s63, s63, 14336
    buffer_load_dwordx4 v24, s[24:27], s63 offen offset:2048 lds
    v_mfma_f32_32x32x16_bf16 v[64:79], a[120:123], a[44:47], v[64:79]
    buffer_load_dwordx4 v25, s[24:27], s63 offen offset:3072 lds
    v_mfma_f32_32x32x16_bf16 v[80:95], a[124:127], a[44:47], v[80:95]
    s_add_u32 s57, s57, 4096
    s_add_u32 s58, s58, 4096
    buffer_load_dwordx4 v[192:195], v0, s[28:31], s57 offen offset:0 sc1
    buffer_load_dwordx4 v[196:199], v0, s[28:31], s58 offen offset:0 sc1
    s_waitcnt vmcnt(13) lgkmcnt(4)
    v_mfma_f32_32x32x16_bf16 v[32:47], a[96:99], a[48:51], v[32:47]
    ds_read_b64_tr_b16 a[112:113], v26 offset:0
    ds_read_b64_tr_b16 a[114:115], v26 offset:1024
    ds_read_b64_tr_b16 a[116:117], v27 offset:0
    ds_read_b64_tr_b16 a[118:119], v27 offset:1024
    v_mfma_f32_32x32x16_bf16 v[48:63], a[100:103], a[48:51], v[48:63]
    s_add_u32 m0, s61, 8192
    s_add_u32 s63, s54, 98304
    buffer_load_dwordx4 v24, s[24:27], s63 offen offset:0 lds
    v_mfma_f32_32x32x16_bf16 v[64:79], a[96:99], a[52:55], v[64:79]
    buffer_load_dwordx4 v25, s[24:27], s63 offen offset:1024 lds
    v_mfma_f32_32x32x16_bf16 v[80:95], a[100:103], a[52:55], v[80:95]
    buffer_load_dwordx4 v[200:203], v0, s[28:31], s57 offen offset:1024 sc1
    buffer_load_dwordx4 v[204:207], v0, s[28:31], s58 offen offset:1024 sc1
    s_waitcnt vmcnt(15) lgkmcnt(4)
    v_mfma_f32_32x32x16_bf16 v[32:47], a[104:107], a[56:59], v[32:47]
    s_waitcnt vmcnt(14)
    ds_read_b64_tr_b16 a[120:121], v26 offset:2048
    ds_read_b64_tr_b16 a[122:123], v26 offset:3072
    ds_read_b64_tr_b16 a[124:125], v27 offset:2048
    ds_read_b64_tr_b16 a[126:127], v27 offset:3072
    v_mfma_f32_32x32x16_bf16 v[48:63], a[108:111], a[56:59], v[48:63]
    s_add_u32 s63, s63, 14336
    buffer_load_dwordx4 v24, s[24:27], s63 offen offset:2048 lds
    v_mfma_f32_32x32x16_bf16 v[64:79], a[104:107], a[60:63], v[64:79]
    buffer_load_dwordx4 v25, s[24:27], s63 offen offset:3072 lds
    v_mfma_f32_32x32x16_bf16 v[80:95], a[108:111], a[60:63], v[80:95]
    buffer_load_dwordx4 v[208:211], v0, s[28:31], s57 offen offset:2048 sc1
    buffer_load_dwordx4 v[212:215], v0, s[28:31], s58 offen offset:2048 sc1
    s_waitcnt vmcnt(16) lgkmcnt(4)
    v_mfma_f32_32x32x16_bf16 v[32:47], a[112:115], a[64:67], v[32:47]
    s_waitcnt vmcnt(14)
    ds_read_b64_tr_b16 a[96:97], v26 offset:4096
    ds_read_b64_tr_b16 a[98:99], v26 offset:5120
    ds_read_b64_tr_b16 a[100:101], v27 offset:4096
    ds_read_b64_tr_b16 a[102:103], v27 offset:5120
    v_mfma_f32_32x32x16_bf16 v[48:63], a[116:119], a[64:67], v[48:63]
    buffer_load_dwordx4 v[216:219], v0, s[28:31], s57 offen offset:3072 sc1
    v_mfma_f32_32x32x16_bf16 v[64:79], a[112:115], a[68:71], v[64:79]
    buffer_load_dwordx4 v[220:223], v0, s[28:31], s58 offen offset:3072 sc1
    v_mfma_f32_32x32x16_bf16 v[80:95], a[116:119], a[68:71], v[80:95]
    s_waitcnt vmcnt(14) lgkmcnt(4)
    v_mfma_f32_32x32x16_bf16 v[32:47], a[120:123], a[72:75], v[32:47]
    s_waitcnt vmcnt(12)
    ds_read_b64_tr_b16 a[104:105], v26 offset:6144
    ds_read_b64_tr_b16 a[106:107], v26 offset:7168
    ds_read_b64_tr_b16 a[108:109], v27 offset:6144
    ds_read_b64_tr_b16 a[110:111], v27 offset:7168
    v_mfma_f32_32x32x16_bf16 v[48:63], a[124:127], a[72:75], v[48:63]
    v_mfma_f32_32x32x16_bf16 v[64:79], a[120:123], a[76:79], v[64:79]
    v_mfma_f32_32x32x16_bf16 v[80:95], a[124:127], a[76:79], v[80:95]
    s_waitcnt vmcnt(10) lgkmcnt(4)
    v_mfma_f32_32x32x16_bf16 v[32:47], a[96:99], v[192:195], v[32:47]
    s_waitcnt vmcnt(8)
    ds_read_b64_tr_b16 a[112:113], v26 offset:8192
    ds_read_b64_tr_b16 a[114:115], v26 offset:9216
    ds_read_b64_tr_b16 a[116:117], v27 offset:8192
    ds_read_b64_tr_b16 a[118:119], v27 offset:9216
    v_mfma_f32_32x32x16_bf16 v[48:63], a[100:103], v[192:195], v[48:63]
    v_mfma_f32_32x32x16_bf16 v[64:79], a[96:99], v[196:199], v[64:79]
    v_mfma_f32_32x32x16_bf16 v[80:95], a[100:103], v[196:199], v[80:95]
    s_waitcnt vmcnt(6) lgkmcnt(4)
    v_mfma_f32_32x32x16_bf16 v[32:47], a[104:107], v[200:203], v[32:47]
    s_waitcnt vmcnt(4)
    ds_read_b64_tr_b16 a[120:121], v26 offset:10240
    ds_read_b64_tr_b16 a[122:123], v26 offset:11264
    ds_read_b64_tr_b16 a[124:125], v27 offset:10240
    ds_read_b64_tr_b16 a[126:127], v27 offset:11264
    v_mfma_f32_32x32x16_bf16 v[48:63], a[108:111], v[200:203], v[48:63]
    v_mfma_f32_32x32x16_bf16 v[64:79], a[104:107], v[204:207], v[64:79]
    v_mfma_f32_32x32x16_bf16 v[80:95], a[108:111], v[204:207], v[80:95]
    s_waitcnt vmcnt(2) lgkmcnt(4)
    v_mfma_f32_32x32x16_bf16 v[32:47], a[112:115], v[208:211], v[32:47]
    v_mfma_f32_32x32x16_bf16 v[48:63], a[116:119], v[208:211], v[48:63]
    v_mfma_f32_32x32x16_bf16 v[64:79], a[112:115], v[212:215], v[64:79]
    v_mfma_f32_32x32x16_bf16 v[80:95], a[116:119], v[212:215], v[80:95]
    s_waitcnt vmcnt(0) lgkmcnt(0)
    v_mfma_f32_32x32x16_bf16 v[48:63], a[124:127], v[216:219], v[48:63]
    v_mfma_f32_32x32x16_bf16 v[64:79], a[120:123], v[220:223], v[64:79]
    v_mfma_f32_32x32x16_bf16 v[80:95], a[124:127], v[220:223], v[80:95]
    v_mfma_f32_32x32x16_bf16 v[32:47], a[120:123], v[216:219], v[32:47]
    s_nop 8
    ds_write_b128 v12, v[48:51] offset:0
    ds_write_b128 v12, v[52:55] offset:1024
    ds_write_b128 v12, v[56:59] offset:2048
    ds_write_b128 v12, v[60:63] offset:3072
    ds_write_b128 v12, v[64:67] offset:4096
    ds_write_b128 v12, v[68:71] offset:5120
    ds_write_b128 v12, v[72:75] offset:6144
    ds_write_b128 v12, v[76:79] offset:7168
    ds_write_b128 v12, v[80:83] offset:8192
    ds_write_b128 v12, v[84:87] offset:9216
    ds_write_b128 v12, v[88:91] offset:10240
    ds_write_b128 v12, v[92:95] offset:11264
    s_waitcnt lgkmcnt(0)
    s_barrier
    ds_read_b128 v[96:99], v13 offset:0
    ds_read_b128 v[100:103], v13 offset:1024
    ds_read_b128 v[104:107], v13 offset:2048
    ds_read_b128 v[108:111], v13 offset:3072
    ds_read_b128 v[112:115], v14 offset:4096
    ds_read_b128 v[116:119], v14 offset:5120
    ds_read_b128 v[120:123], v14 offset:6144
    ds_read_b128 v[124:127], v14 offset:7168
    ds_read_b128 v[128:131], v15 offset:8192
    ds_read_b128 v[132:135], v15 offset:9216
    ds_read_b128 v[136:139], v15 offset:10240
    ds_read_b128 v[140:143], v15 offset:11264
    s_waitcnt lgkmcnt(11)
    v_pk_add_f32 v[32:33], v[32:33], v[96:97]
    v_pk_add_f32 v[34:35], v[34:35], v[98:99]
    s_waitcnt lgkmcnt(10)
    v_pk_add_f32 v[36:37], v[36:37], v[100:101]
    v_pk_add_f32 v[38:39], v[38:39], v[102:103]
    s_waitcnt lgkmcnt(9)
    v_pk_add_f32 v[40:41], v[40:41], v[104:105]
    v_pk_add_f32 v[42:43], v[42:43], v[106:107]
    s_waitcnt lgkmcnt(8)
    v_pk_add_f32 v[44:45], v[44:45], v[108:109]
    v_pk_add_f32 v[46:47], v[46:47], v[110:111]
    s_waitcnt lgkmcnt(7)
    v_pk_add_f32 v[32:33], v[32:33], v[112:113]
    v_pk_add_f32 v[34:35], v[34:35], v[114:115]
    s_waitcnt lgkmcnt(6)
    v_pk_add_f32 v[36:37], v[36:37], v[116:117]
    v_pk_add_f32 v[38:39], v[38:39], v[118:119]
    s_waitcnt lgkmcnt(5)
    v_pk_add_f32 v[40:41], v[40:41], v[120:121]
    v_pk_add_f32 v[42:43], v[42:43], v[122:123]
    s_waitcnt lgkmcnt(4)
    v_pk_add_f32 v[44:45], v[44:45], v[124:125]
    v_pk_add_f32 v[46:47], v[46:47], v[126:127]
    s_waitcnt lgkmcnt(3)
    v_pk_add_f32 v[32:33], v[32:33], v[128:129]
    v_pk_add_f32 v[34:35], v[34:35], v[130:131]
    s_waitcnt lgkmcnt(2)
    v_pk_add_f32 v[36:37], v[36:37], v[132:133]
    v_pk_add_f32 v[38:39], v[38:39], v[134:135]
    s_waitcnt lgkmcnt(1)
    v_pk_add_f32 v[40:41], v[40:41], v[136:137]
    v_pk_add_f32 v[42:43], v[42:43], v[138:139]
    s_waitcnt lgkmcnt(0)
    v_pk_add_f32 v[44:45], v[44:45], v[140:141]
    v_pk_add_f32 v[46:47], v[46:47], v[142:143]
    v_cvt_pk_bf16_f32 v48, v32, v33
    v_cvt_pk_bf16_f32 v49, v34, v35
    v_cvt_pk_bf16_f32 v50, v36, v37
    v_cvt_pk_bf16_f32 v51, v38, v39
    v_cvt_pk_bf16_f32 v52, v40, v41
    v_cvt_pk_bf16_f32 v53, v42, v43
    v_cvt_pk_bf16_f32 v54, v44, v45
    v_cvt_pk_bf16_f32 v55, v46, v47
    s_nop 0
    v_permlane32_swap_b32 v48, v50
    v_permlane32_swap_b32 v49, v51
    v_permlane32_swap_b32 v52, v54
    v_permlane32_swap_b32 v53, v55
    buffer_store_dwordx4 v[48:51], v16, s[32:35], s64 offen offset:0
    buffer_store_dwordx4 v[52:55], v16, s[32:35], s64 offen offset:32
    s_endpgm
L_dbgspinA:
    s_add_u32 s100, s100, 1
    s_cmp_gt_u32 s100, 100000
    s_cbranch_scc1 L_dbgokA
    s_sleep 2
    buffer_load_dword v30, off, s[36:39], s1 sc1
    s_waitcnt vmcnt(0)
    v_readfirstlane_b32 s2, v30
    s_cmp_lg_u32 s2, 0
    s_cbranch_scc0 L_dbgspinA
    s_branch L_dbgokA
L_hspinA:
    s_add_u32 s100, s100, 1
    s_cmp_gt_u32 s100, 100000
    s_cbranch_scc1 L_hokA
    s_sleep 1
    buffer_load_dword v11, v21, s[28:31], 0 offen offset:0 sc1
    s_waitcnt vmcnt(0)
    v_cmp_ne_u32 vcc, 1, v11
    s_nop 4
    s_and_b32 vcc_lo, vcc_lo, 0xffffffff
    s_cbranch_scc1 L_hspinA
    s_branch L_hokA
L_mspinA:
    s_add_u32 s100, s100, 1
    s_cmp_gt_u32 s100, 100000
    s_cbranch_scc1 L_mokA
    s_sleep 1
    buffer_load_dword v11, v21, s[28:31], 0 offen offset:128 sc1
    s_waitcnt vmcnt(0)
    v_cmp_ne_u32 vcc, 1, v11
    s_nop 4
    s_and_b32 vcc_lo, vcc_lo, 0x0f0f0f0f
    s_cbranch_scc1 L_mspinA
    s_branch L_mokA
L_ospinA:
    s_add_u32 s100, s100, 1
    s_cmp_gt_u32 s100, 100000
    s_cbranch_scc1 L_ookA
    s_sleep 1
    buffer_load_dword v11, v21, s[28:31], 0 offen offset:128 sc1
    s_waitcnt vmcnt(0)
    v_cmp_ne_u32 vcc, 1, v11
    s_nop 4
    s_and_b32 vcc_lo, vcc_lo, 0xf0f0f0f0
    s_cbranch_scc1 L_ospinA
    s_branch L_ookA
L_end:
    s_endpgm
L_codeend:
.section .rodata,"a"
.p2align 6
.amdhsa_kernel parallel_sum__sliding_local_dilated__glu_gated_reglu__prompt_kernel
  .amdhsa_next_free_vgpr 512
  .amdhsa_next_free_sgpr 102
  .amdhsa_accum_offset 256
  .amdhsa_group_segment_fixed_size 0
  .amdhsa_kernarg_size 80
  .amdhsa_user_sgpr_count 2
  .amdhsa_user_sgpr_kernarg_segment_ptr 1
  .amdhsa_system_sgpr_workgroup_id_x 1
.end_amdhsa_kernel
```
